```python
import torch

def _softmax(x, axis=-1):
    return torch.softmax(x, dim=axis)
def _gelu(x):
    return torch.nn.functional.gelu(x, approximate="tanh")
def _silu(x):
    return torch.nn.functional.silu(x)
def _sigmoid(x):
    return torch.sigmoid(x)
def _layernorm(x, axis=-1, eps=1e-5):
    m = x.mean(dim=axis, keepdim=True)
    v = x.var(dim=axis, keepdim=True, unbiased=False)
    return (x - m) / torch.sqrt(v + eps)
def _scatter_add(tgt, idx, src, axis=0):
    return tgt.clone().index_add_(axis, idx, src)
def _segment_sum(src, seg, n):
    out = torch.zeros((n,) + src.shape[1:], dtype=src.dtype)
    return out.index_add_(0, seg, src)
def _pad(x, pw):
    flat = tuple(v for pair in reversed(pw) for v in pair)
    return torch.nn.functional.pad(x, flat)

kernel_name = 'standalone__gqa_block_cached__near_ridge'

def setup_inputs():

    _w = (lambda a: (lambda t: t.to(torch.bfloat16) if t.is_floating_point() else t)(torch.as_tensor(a)))
    B, Sq, D = 16, 96, 640
    Hq, Hkv, Sk, Dh = 32, 32, 512, 128
    assert Hq % Hkv == 0, (Hq, Hkv)
    return {
        "x": _w((lambda *s: torch.randn(*s, dtype=torch.bfloat16) * 0.8)(B, Sq, D)),
        "k_cache": _w((lambda *s: torch.randn(*s, dtype=torch.bfloat16) * 0.8)(B, Hkv, Sk, Dh)),
        "v_cache": _w((lambda *s: torch.randn(*s, dtype=torch.bfloat16) * 0.05)(B, Hkv, Sk, Dh)),
        "wq": _w((lambda *s: torch.randn(*s, dtype=torch.bfloat16) * 0.8)(D, Hq * Dh) * (D ** -0.5)),
        "wo": _w((lambda *s: torch.randn(*s, dtype=torch.bfloat16) * 0.05)(Hq * Dh, D) * ((Hq * Dh) ** -0.5)),
    }

def reference(x, k_cache, v_cache, wq, wo):
    B, Sq, D = x.shape
    Hq, Dh = 32, 128
    Hkv = k_cache.shape[1]
    rep = Hq // Hkv
    q = (lambda x, *d: x.permute(*d))((x @ wq).reshape(B, Sq, Hq, Dh), 0, 2, 1, 3)
    k = (lambda x, n, axis: torch.repeat_interleave(x, n, dim=axis))(k_cache, rep, axis=1)
    v = (lambda x, n, axis: torch.repeat_interleave(x, n, dim=axis))(v_cache, rep, axis=1)
    scores = torch.einsum("bhqd,bhkd->bhqk", q, k) * (Dh ** -0.5)
    p = _softmax(scores, axis=-1)
    o = torch.einsum("bhqk,bhkd->bhqd", p, v)
    return (lambda x, *d: x.permute(*d))(o, 0, 2, 1, 3).reshape(B, Sq, Hq * Dh) @ wo
```

```asm
; @launch grid=(256,1,1) block=(512,1,1) lds=163840
.amdgcn_target "amdgcn-amd-amdhsa--gfx950"
.text
.globl standalone__gqa_block_cached__near_ridge_kernel
.p2align 12
.p2align 8
.type standalone__gqa_block_cached__near_ridge_kernel,@function
standalone__gqa_block_cached__near_ridge_kernel:
    s_cmp_lt_u32 s2, 256
    s_cbranch_scc1 K_go
    s_endpgm
K_go:
    s_load_dwordx16 s[4:19], s[0:1], 0
    s_and_b32 s52, s2, 7
    s_lshr_b32 s49, s52, 1
    s_and_b32 s52, s52, 1
    s_lshr_b32 s53, s2, 3
    s_and_b32 s50, s53, 3
    s_lshr_b32 s53, s53, 2
    s_lshl_b32 s48, s52, 3
    s_add_u32 s48, s48, s53
    s_lshl_b32 s51, s49, 3
    s_lshl_b32 s52, s50, 1
    s_add_u32 s51, s51, s52
    v_lshrrev_b32 v1, 6, v0
    v_and_b32 v0, 63, v0
    v_readfirstlane_b32 s3, v1
    s_cmp_eq_u32 s3, 7
    s_cbranch_scc1 K_ld
    s_cmp_eq_u32 s3, 0
    s_cbranch_scc1 K_notld
    s_cmp_eq_u32 s3, 1
    s_cbranch_scc1 PAD8
    s_cmp_eq_u32 s3, 2
    s_cbranch_scc1 PAD10
    s_cmp_eq_u32 s3, 3
    s_cbranch_scc1 PAD0
    s_cmp_eq_u32 s3, 4
    s_cbranch_scc1 PAD5
    s_cmp_eq_u32 s3, 5
    s_cbranch_scc1 PAD6
    s_branch PAD1
K_ld:
    s_setprio 3
    v_lshrrev_b32 v1, 3, v0
    v_and_b32 v2, 7, v0
    v_lshrrev_b32 v3, 4, v0
    v_xor_b32 v4, v2, v3
    v_xor_b32 v5, 4, v4
    v_mul_u32_u24 v1, 1280, v1
    v_lshl_add_u32 v12, v4, 4, v1
    v_lshl_add_u32 v13, v5, 4, v1
    v_add_u32 v14, 18432, v12
    v_add_u32 v15, 27648, v13
    v_add_u32 v13, 9216, v13
    v_and_b32 v2, 15, v0
    v_lshlrev_b32 v4, 17, v3
    v_lshl_add_u32 v8, v2, 4, v4
    v_add_u32 v9, 7104, v8
    v_add_u32 v10, 14208, v8
    v_add_u32 v11, 21312, v8
    s_and_b32 s52, s48, 7
    s_lshr_b32 s53, s52, 2
    s_add_u32 s52, s52, s53
    s_mul_i32 s53, s50, 5
    s_lshr_b32 s53, s53, 1
    s_add_u32 s56, s52, s53
    s_sub_u32 s52, s56, 10
    s_cmp_ge_u32 s56, 10
    s_cselect_b32 s56, s52, s56
    s_lshl_b32 s57, s56, 19
    s_lshl_b32 s56, s56, 7
    s_mul_i32 s52, s48, 122880
    s_lshl_b32 s53, s51, 8
    s_sub_u32 s54, 5242880, s53
    s_waitcnt lgkmcnt(0)
    s_add_u32 s20, s4, s52
    s_addc_u32 s21, s5, 0
    s_mov_b32 s22, 122880
    s_mov_b32 s23, 0x20000
    s_add_u32 s24, s10, s53
    s_addc_u32 s25, s11, 0
    s_mov_b32 s26, s54
    s_mov_b32 s27, 0x20000
    s_mov_b32 m0, 137984
    s_add_u32 s52, s56, 0
    buffer_load_dwordx4 v12, s[20:23], s52 offen offset:0 lds
    buffer_load_dwordx4 v13, s[20:23], s52 offen offset:1024 lds
    buffer_load_dwordx4 v14, s[20:23], s52 offen offset:2048 lds
    buffer_load_dwordx4 v15, s[20:23], s52 offen offset:3072 lds
    s_mov_b32 m0, 142080
    s_add_u32 s52, s56, 40960
    buffer_load_dwordx4 v12, s[20:23], s52 offen offset:0 lds
    buffer_load_dwordx4 v13, s[20:23], s52 offen offset:1024 lds
    buffer_load_dwordx4 v14, s[20:23], s52 offen offset:2048 lds
    buffer_load_dwordx4 v15, s[20:23], s52 offen offset:3072 lds
    s_mov_b32 m0, 146176
    s_add_u32 s52, s56, 81920
    buffer_load_dwordx4 v12, s[20:23], s52 offen offset:0 lds
    buffer_load_dwordx4 v13, s[20:23], s52 offen offset:1024 lds
    buffer_load_dwordx4 v14, s[20:23], s52 offen offset:2048 lds
    buffer_load_dwordx4 v15, s[20:23], s52 offen offset:3072 lds
    s_add_u32 s56, s56, 128
    s_cmp_eq_u32 s56, 1280
    s_cselect_b32 s56, 0, s56
    s_mov_b32 m0, 120576
    s_add_u32 s52, s57, 0
    buffer_load_dwordx4 v8, s[24:27], s52 offen offset:0 lds
    buffer_load_dwordx4 v9, s[24:27], s52 offen offset:1088 lds
    buffer_load_dwordx4 v10, s[24:27], s52 offen offset:2176 lds
    buffer_load_dwordx4 v11, s[24:27], s52 offen offset:3264 lds
    s_mov_b32 m0, 124928
    s_add_u32 s52, s57, 32768
    buffer_load_dwordx4 v8, s[24:27], s52 offen offset:0 lds
    buffer_load_dwordx4 v9, s[24:27], s52 offen offset:1088 lds
    buffer_load_dwordx4 v10, s[24:27], s52 offen offset:2176 lds
    buffer_load_dwordx4 v11, s[24:27], s52 offen offset:3264 lds
    s_mov_b32 m0, 129280
    s_add_u32 s52, s57, 65536
    buffer_load_dwordx4 v8, s[24:27], s52 offen offset:0 lds
    buffer_load_dwordx4 v9, s[24:27], s52 offen offset:1088 lds
    buffer_load_dwordx4 v10, s[24:27], s52 offen offset:2176 lds
    buffer_load_dwordx4 v11, s[24:27], s52 offen offset:3264 lds
    s_mov_b32 m0, 133632
    s_add_u32 s52, s57, 98304
    buffer_load_dwordx4 v8, s[24:27], s52 offen offset:0 lds
    buffer_load_dwordx4 v9, s[24:27], s52 offen offset:1088 lds
    buffer_load_dwordx4 v10, s[24:27], s52 offen offset:2176 lds
    buffer_load_dwordx4 v11, s[24:27], s52 offen offset:3264 lds
    s_add_u32 s57, s57, 524288
    s_cmp_eq_u32 s57, 5242880
    s_cselect_b32 s57, 0, s57
    s_mov_b32 m0, 150272
    s_add_u32 s52, s56, 0
    buffer_load_dwordx4 v12, s[20:23], s52 offen offset:0 lds
    buffer_load_dwordx4 v13, s[20:23], s52 offen offset:1024 lds
    buffer_load_dwordx4 v14, s[20:23], s52 offen offset:2048 lds
    buffer_load_dwordx4 v15, s[20:23], s52 offen offset:3072 lds
    s_mov_b32 m0, 154368
    s_add_u32 s52, s56, 40960
    buffer_load_dwordx4 v12, s[20:23], s52 offen offset:0 lds
    buffer_load_dwordx4 v13, s[20:23], s52 offen offset:1024 lds
    buffer_load_dwordx4 v14, s[20:23], s52 offen offset:2048 lds
    buffer_load_dwordx4 v15, s[20:23], s52 offen offset:3072 lds
    s_mov_b32 m0, 158464
    s_add_u32 s52, s56, 81920
    buffer_load_dwordx4 v12, s[20:23], s52 offen offset:0 lds
    buffer_load_dwordx4 v13, s[20:23], s52 offen offset:1024 lds
    buffer_load_dwordx4 v14, s[20:23], s52 offen offset:2048 lds
    buffer_load_dwordx4 v15, s[20:23], s52 offen offset:3072 lds
    s_add_u32 s56, s56, 128
    s_cmp_eq_u32 s56, 1280
    s_cselect_b32 s56, 0, s56
    s_mov_b32 m0, 85760
    s_add_u32 s52, s57, 0
    buffer_load_dwordx4 v8, s[24:27], s52 offen offset:0 lds
    buffer_load_dwordx4 v9, s[24:27], s52 offen offset:1088 lds
    buffer_load_dwordx4 v10, s[24:27], s52 offen offset:2176 lds
    buffer_load_dwordx4 v11, s[24:27], s52 offen offset:3264 lds
    s_mov_b32 m0, 90112
    s_add_u32 s52, s57, 32768
    buffer_load_dwordx4 v8, s[24:27], s52 offen offset:0 lds
    buffer_load_dwordx4 v9, s[24:27], s52 offen offset:1088 lds
    buffer_load_dwordx4 v10, s[24:27], s52 offen offset:2176 lds
    buffer_load_dwordx4 v11, s[24:27], s52 offen offset:3264 lds
    s_mov_b32 m0, 94464
    s_add_u32 s52, s57, 65536
    buffer_load_dwordx4 v8, s[24:27], s52 offen offset:0 lds
    buffer_load_dwordx4 v9, s[24:27], s52 offen offset:1088 lds
    buffer_load_dwordx4 v10, s[24:27], s52 offen offset:2176 lds
    buffer_load_dwordx4 v11, s[24:27], s52 offen offset:3264 lds
    s_mov_b32 m0, 98816
    s_add_u32 s52, s57, 98304
    buffer_load_dwordx4 v8, s[24:27], s52 offen offset:0 lds
    buffer_load_dwordx4 v9, s[24:27], s52 offen offset:1088 lds
    buffer_load_dwordx4 v10, s[24:27], s52 offen offset:2176 lds
    buffer_load_dwordx4 v11, s[24:27], s52 offen offset:3264 lds
    s_add_u32 s57, s57, 524288
    s_cmp_eq_u32 s57, 5242880
    s_cselect_b32 s57, 0, s57
    s_waitcnt vmcnt(28)
    s_barrier
    s_mov_b32 m0, 42240
    s_add_u32 s52, s56, 0
    buffer_load_dwordx4 v12, s[20:23], s52 offen offset:0 lds
    buffer_load_dwordx4 v13, s[20:23], s52 offen offset:1024 lds
    buffer_load_dwordx4 v14, s[20:23], s52 offen offset:2048 lds
    buffer_load_dwordx4 v15, s[20:23], s52 offen offset:3072 lds
    s_mov_b32 m0, 46336
    s_add_u32 s52, s56, 40960
    buffer_load_dwordx4 v12, s[20:23], s52 offen offset:0 lds
    buffer_load_dwordx4 v13, s[20:23], s52 offen offset:1024 lds
    buffer_load_dwordx4 v14, s[20:23], s52 offen offset:2048 lds
    buffer_load_dwordx4 v15, s[20:23], s52 offen offset:3072 lds
    s_mov_b32 m0, 50432
    s_add_u32 s52, s56, 81920
    buffer_load_dwordx4 v12, s[20:23], s52 offen offset:0 lds
    buffer_load_dwordx4 v13, s[20:23], s52 offen offset:1024 lds
    buffer_load_dwordx4 v14, s[20:23], s52 offen offset:2048 lds
    buffer_load_dwordx4 v15, s[20:23], s52 offen offset:3072 lds
    s_add_u32 s56, s56, 128
    s_cmp_eq_u32 s56, 1280
    s_cselect_b32 s56, 0, s56
    s_mov_b32 m0, 103168
    s_add_u32 s52, s57, 0
    buffer_load_dwordx4 v8, s[24:27], s52 offen offset:0 lds
    buffer_load_dwordx4 v9, s[24:27], s52 offen offset:1088 lds
    buffer_load_dwordx4 v10, s[24:27], s52 offen offset:2176 lds
    buffer_load_dwordx4 v11, s[24:27], s52 offen offset:3264 lds
    s_mov_b32 m0, 107520
    s_add_u32 s52, s57, 32768
    buffer_load_dwordx4 v8, s[24:27], s52 offen offset:0 lds
    buffer_load_dwordx4 v9, s[24:27], s52 offen offset:1088 lds
    buffer_load_dwordx4 v10, s[24:27], s52 offen offset:2176 lds
    buffer_load_dwordx4 v11, s[24:27], s52 offen offset:3264 lds
    s_mov_b32 m0, 111872
    s_add_u32 s52, s57, 65536
    buffer_load_dwordx4 v8, s[24:27], s52 offen offset:0 lds
    buffer_load_dwordx4 v9, s[24:27], s52 offen offset:1088 lds
    buffer_load_dwordx4 v10, s[24:27], s52 offen offset:2176 lds
    buffer_load_dwordx4 v11, s[24:27], s52 offen offset:3264 lds
    s_mov_b32 m0, 116224
    s_add_u32 s52, s57, 98304
    buffer_load_dwordx4 v8, s[24:27], s52 offen offset:0 lds
    buffer_load_dwordx4 v9, s[24:27], s52 offen offset:1088 lds
    buffer_load_dwordx4 v10, s[24:27], s52 offen offset:2176 lds
    buffer_load_dwordx4 v11, s[24:27], s52 offen offset:3264 lds
    s_add_u32 s57, s57, 524288
    s_cmp_eq_u32 s57, 5242880
    s_cselect_b32 s57, 0, s57
    v_lshrrev_b32 v1, 5, v0
    v_xor_b32 v1, v2, v1
    v_lshlrev_b32 v4, 15, v3
    v_add_u32 v4, 4096, v4
    v_lshl_add_u32 v16, v1, 4, v4
    v_lshl_add_u32 v20, v2, 4, v4
    v_add_u32 v17, 3040, v16
    v_add_u32 v21, 3008, v20
    v_add_u32 v18, 6080, v16
    v_add_u32 v22, 6016, v20
    v_add_u32 v19, 9120, v16
    v_add_u32 v23, 9024, v20
    s_lshr_b32 s68, s2, 3
    s_and_b32 s68, s68, 15
    s_lshl_b32 s68, s68, 8
    s_lshl_b32 s55, s48, 5
    s_add_u32 s55, s55, s51
    s_lshl_b32 s55, s55, 17
    s_add_u32 s28, s6, s55
    s_addc_u32 s29, s7, 0
    s_mov_b32 s30, 266240
    s_mov_b32 s31, 0x20000
    s_sub_u32 s28, s28, 4096
    s_subb_u32 s29, s29, 0
    s_add_u32 s32, s8, s55
    s_addc_u32 s33, s9, 0
    s_mov_b32 s34, 266240
    s_mov_b32 s35, 0x20000
    s_sub_u32 s32, s32, 4096
    s_subb_u32 s33, s33, 0
    s_mov_b32 m0, 54528
    s_add_u32 s52, s56, 0
    buffer_load_dwordx4 v12, s[20:23], s52 offen offset:0 lds
    buffer_load_dwordx4 v13, s[20:23], s52 offen offset:1024 lds
    buffer_load_dwordx4 v14, s[20:23], s52 offen offset:2048 lds
    buffer_load_dwordx4 v15, s[20:23], s52 offen offset:3072 lds
    s_mov_b32 m0, 58624
    s_add_u32 s52, s56, 40960
    buffer_load_dwordx4 v12, s[20:23], s52 offen offset:0 lds
    buffer_load_dwordx4 v13, s[20:23], s52 offen offset:1024 lds
    buffer_load_dwordx4 v14, s[20:23], s52 offen offset:2048 lds
    buffer_load_dwordx4 v15, s[20:23], s52 offen offset:3072 lds
    s_mov_b32 m0, 62720
    s_add_u32 s52, s56, 81920
    buffer_load_dwordx4 v12, s[20:23], s52 offen offset:0 lds
    buffer_load_dwordx4 v13, s[20:23], s52 offen offset:1024 lds
    buffer_load_dwordx4 v14, s[20:23], s52 offen offset:2048 lds
    buffer_load_dwordx4 v15, s[20:23], s52 offen offset:3072 lds
    s_add_u32 s56, s56, 128
    s_cmp_eq_u32 s56, 1280
    s_cselect_b32 s56, 0, s56
    s_waitcnt vmcnt(40)
    s_barrier
    s_mov_b32 m0, 120576
    s_add_u32 s52, s57, 0
    buffer_load_dwordx4 v8, s[24:27], s52 offen offset:0 lds
    buffer_load_dwordx4 v9, s[24:27], s52 offen offset:1088 lds
    buffer_load_dwordx4 v10, s[24:27], s52 offen offset:2176 lds
    buffer_load_dwordx4 v11, s[24:27], s52 offen offset:3264 lds
    s_mov_b32 m0, 124928
    s_add_u32 s52, s57, 32768
    buffer_load_dwordx4 v8, s[24:27], s52 offen offset:0 lds
    buffer_load_dwordx4 v9, s[24:27], s52 offen offset:1088 lds
    buffer_load_dwordx4 v10, s[24:27], s52 offen offset:2176 lds
    buffer_load_dwordx4 v11, s[24:27], s52 offen offset:3264 lds
    s_mov_b32 m0, 129280
    s_add_u32 s52, s57, 65536
    buffer_load_dwordx4 v8, s[24:27], s52 offen offset:0 lds
    buffer_load_dwordx4 v9, s[24:27], s52 offen offset:1088 lds
    buffer_load_dwordx4 v10, s[24:27], s52 offen offset:2176 lds
    buffer_load_dwordx4 v11, s[24:27], s52 offen offset:3264 lds
    s_mov_b32 m0, 133632
    s_add_u32 s52, s57, 98304
    buffer_load_dwordx4 v8, s[24:27], s52 offen offset:0 lds
    buffer_load_dwordx4 v9, s[24:27], s52 offen offset:1088 lds
    buffer_load_dwordx4 v10, s[24:27], s52 offen offset:2176 lds
    buffer_load_dwordx4 v11, s[24:27], s52 offen offset:3264 lds
    s_add_u32 s57, s57, 524288
    s_cmp_eq_u32 s57, 5242880
    s_cselect_b32 s57, 0, s57
    s_mov_b32 m0, 137984
    s_add_u32 s52, s56, 0
    buffer_load_dwordx4 v12, s[20:23], s52 offen offset:0 lds
    buffer_load_dwordx4 v13, s[20:23], s52 offen offset:1024 lds
    buffer_load_dwordx4 v14, s[20:23], s52 offen offset:2048 lds
    buffer_load_dwordx4 v15, s[20:23], s52 offen offset:3072 lds
    s_mov_b32 m0, 142080
    s_add_u32 s52, s56, 40960
    buffer_load_dwordx4 v12, s[20:23], s52 offen offset:0 lds
    buffer_load_dwordx4 v13, s[20:23], s52 offen offset:1024 lds
    buffer_load_dwordx4 v14, s[20:23], s52 offen offset:2048 lds
    buffer_load_dwordx4 v15, s[20:23], s52 offen offset:3072 lds
    s_mov_b32 m0, 146176
    s_add_u32 s52, s56, 81920
    buffer_load_dwordx4 v12, s[20:23], s52 offen offset:0 lds
    buffer_load_dwordx4 v13, s[20:23], s52 offen offset:1024 lds
    buffer_load_dwordx4 v14, s[20:23], s52 offen offset:2048 lds
    buffer_load_dwordx4 v15, s[20:23], s52 offen offset:3072 lds
    s_add_u32 s56, s56, 128
    s_cmp_eq_u32 s56, 1280
    s_cselect_b32 s56, 0, s56
    s_mov_b32 m0, 25344
    s_add_u32 s52, s68, 0
    s_and_b32 s52, s52, 0xfff
    buffer_load_dwordx4 v16, s[28:31], s52 offen offset:0 nt lds
    buffer_load_dwordx4 v17, s[28:31], s52 offen offset:1056 nt lds
    buffer_load_dwordx4 v18, s[28:31], s52 offen offset:2112 nt lds
    buffer_load_dwordx4 v19, s[28:31], s52 offen offset:3168 nt lds
    s_mov_b32 m0, 29568
    s_add_u32 s52, s52, 16384
    buffer_load_dwordx4 v16, s[28:31], s52 offen offset:0 nt lds
    buffer_load_dwordx4 v17, s[28:31], s52 offen offset:1056 nt lds
    buffer_load_dwordx4 v18, s[28:31], s52 offen offset:2112 nt lds
    buffer_load_dwordx4 v19, s[28:31], s52 offen offset:3168 nt lds
    s_waitcnt vmcnt(48)
    s_barrier
    s_mov_b32 m0, 85760
    s_add_u32 s52, s57, 0
    buffer_load_dwordx4 v8, s[24:27], s52 offen offset:0 lds
    buffer_load_dwordx4 v9, s[24:27], s52 offen offset:1088 lds
    buffer_load_dwordx4 v10, s[24:27], s52 offen offset:2176 lds
    buffer_load_dwordx4 v11, s[24:27], s52 offen offset:3264 lds
    s_mov_b32 m0, 90112
    s_add_u32 s52, s57, 32768
    buffer_load_dwordx4 v8, s[24:27], s52 offen offset:0 lds
    buffer_load_dwordx4 v9, s[24:27], s52 offen offset:1088 lds
    buffer_load_dwordx4 v10, s[24:27], s52 offen offset:2176 lds
    buffer_load_dwordx4 v11, s[24:27], s52 offen offset:3264 lds
    s_mov_b32 m0, 94464
    s_add_u32 s52, s57, 65536
    buffer_load_dwordx4 v8, s[24:27], s52 offen offset:0 lds
    buffer_load_dwordx4 v9, s[24:27], s52 offen offset:1088 lds
    buffer_load_dwordx4 v10, s[24:27], s52 offen offset:2176 lds
    buffer_load_dwordx4 v11, s[24:27], s52 offen offset:3264 lds
    s_mov_b32 m0, 98816
    s_add_u32 s52, s57, 98304
    buffer_load_dwordx4 v8, s[24:27], s52 offen offset:0 lds
    buffer_load_dwordx4 v9, s[24:27], s52 offen offset:1088 lds
    buffer_load_dwordx4 v10, s[24:27], s52 offen offset:2176 lds
    buffer_load_dwordx4 v11, s[24:27], s52 offen offset:3264 lds
    s_add_u32 s57, s57, 524288
    s_cmp_eq_u32 s57, 5242880
    s_cselect_b32 s57, 0, s57
    s_mov_b32 m0, 150272
    s_add_u32 s52, s56, 0
    buffer_load_dwordx4 v12, s[20:23], s52 offen offset:0 lds
    buffer_load_dwordx4 v13, s[20:23], s52 offen offset:1024 lds
    buffer_load_dwordx4 v14, s[20:23], s52 offen offset:2048 lds
    buffer_load_dwordx4 v15, s[20:23], s52 offen offset:3072 lds
    s_mov_b32 m0, 154368
    s_add_u32 s52, s56, 40960
    buffer_load_dwordx4 v12, s[20:23], s52 offen offset:0 lds
    buffer_load_dwordx4 v13, s[20:23], s52 offen offset:1024 lds
    buffer_load_dwordx4 v14, s[20:23], s52 offen offset:2048 lds
    buffer_load_dwordx4 v15, s[20:23], s52 offen offset:3072 lds
    s_mov_b32 m0, 158464
    s_add_u32 s52, s56, 81920
    buffer_load_dwordx4 v12, s[20:23], s52 offen offset:0 lds
    buffer_load_dwordx4 v13, s[20:23], s52 offen offset:1024 lds
    buffer_load_dwordx4 v14, s[20:23], s52 offen offset:2048 lds
    buffer_load_dwordx4 v15, s[20:23], s52 offen offset:3072 lds
    s_add_u32 s56, s56, 128
    s_cmp_eq_u32 s56, 1280
    s_cselect_b32 s56, 0, s56
    s_mov_b32 m0, 33792
    s_add_u32 s52, s68, 256
    s_and_b32 s52, s52, 0xfff
    buffer_load_dwordx4 v16, s[28:31], s52 offen offset:0 nt lds
    buffer_load_dwordx4 v17, s[28:31], s52 offen offset:1056 nt lds
    buffer_load_dwordx4 v18, s[28:31], s52 offen offset:2112 nt lds
    buffer_load_dwordx4 v19, s[28:31], s52 offen offset:3168 nt lds
    s_mov_b32 m0, 38016
    s_add_u32 s52, s52, 16384
    buffer_load_dwordx4 v16, s[28:31], s52 offen offset:0 nt lds
    buffer_load_dwordx4 v17, s[28:31], s52 offen offset:1056 nt lds
    buffer_load_dwordx4 v18, s[28:31], s52 offen offset:2112 nt lds
    buffer_load_dwordx4 v19, s[28:31], s52 offen offset:3168 nt lds
    s_waitcnt vmcnt(56)
    s_barrier
    s_mov_b32 m0, 103168
    s_add_u32 s52, s57, 0
    buffer_load_dwordx4 v8, s[24:27], s52 offen offset:0 lds
    buffer_load_dwordx4 v9, s[24:27], s52 offen offset:1088 lds
    buffer_load_dwordx4 v10, s[24:27], s52 offen offset:2176 lds
    buffer_load_dwordx4 v11, s[24:27], s52 offen offset:3264 lds
    s_mov_b32 m0, 107520
    s_add_u32 s52, s57, 32768
    buffer_load_dwordx4 v8, s[24:27], s52 offen offset:0 lds
    buffer_load_dwordx4 v9, s[24:27], s52 offen offset:1088 lds
    buffer_load_dwordx4 v10, s[24:27], s52 offen offset:2176 lds
    buffer_load_dwordx4 v11, s[24:27], s52 offen offset:3264 lds
    s_mov_b32 m0, 111872
    s_add_u32 s52, s57, 65536
    buffer_load_dwordx4 v8, s[24:27], s52 offen offset:0 lds
    buffer_load_dwordx4 v9, s[24:27], s52 offen offset:1088 lds
    buffer_load_dwordx4 v10, s[24:27], s52 offen offset:2176 lds
    buffer_load_dwordx4 v11, s[24:27], s52 offen offset:3264 lds
    s_mov_b32 m0, 116224
    s_add_u32 s52, s57, 98304
    buffer_load_dwordx4 v8, s[24:27], s52 offen offset:0 lds
    buffer_load_dwordx4 v9, s[24:27], s52 offen offset:1088 lds
    buffer_load_dwordx4 v10, s[24:27], s52 offen offset:2176 lds
    buffer_load_dwordx4 v11, s[24:27], s52 offen offset:3264 lds
    s_add_u32 s57, s57, 524288
    s_cmp_eq_u32 s57, 5242880
    s_cselect_b32 s57, 0, s57
    s_mov_b32 m0, 42240
    s_add_u32 s52, s56, 0
    buffer_load_dwordx4 v12, s[20:23], s52 offen offset:0 lds
    buffer_load_dwordx4 v13, s[20:23], s52 offen offset:1024 lds
    buffer_load_dwordx4 v14, s[20:23], s52 offen offset:2048 lds
    buffer_load_dwordx4 v15, s[20:23], s52 offen offset:3072 lds
    s_mov_b32 m0, 46336
    s_add_u32 s52, s56, 40960
    buffer_load_dwordx4 v12, s[20:23], s52 offen offset:0 lds
    buffer_load_dwordx4 v13, s[20:23], s52 offen offset:1024 lds
    buffer_load_dwordx4 v14, s[20:23], s52 offen offset:2048 lds
    buffer_load_dwordx4 v15, s[20:23], s52 offen offset:3072 lds
    s_mov_b32 m0, 50432
    s_add_u32 s52, s56, 81920
    buffer_load_dwordx4 v12, s[20:23], s52 offen offset:0 lds
    buffer_load_dwordx4 v13, s[20:23], s52 offen offset:1024 lds
    buffer_load_dwordx4 v14, s[20:23], s52 offen offset:2048 lds
    buffer_load_dwordx4 v15, s[20:23], s52 offen offset:3072 lds
    s_add_u32 s56, s56, 128
    s_cmp_eq_u32 s56, 1280
    s_cselect_b32 s56, 0, s56
    s_mov_b32 m0, 0
    s_add_u32 s52, s68, 512
    s_and_b32 s52, s52, 0xfff
    buffer_load_dwordx4 v16, s[28:31], s52 offen offset:0 nt lds
    buffer_load_dwordx4 v17, s[28:31], s52 offen offset:1056 nt lds
    buffer_load_dwordx4 v18, s[28:31], s52 offen offset:2112 nt lds
    buffer_load_dwordx4 v19, s[28:31], s52 offen offset:3168 nt lds
    s_mov_b32 m0, 4224
    s_add_u32 s52, s52, 16384
    buffer_load_dwordx4 v16, s[28:31], s52 offen offset:0 nt lds
    buffer_load_dwordx4 v17, s[28:31], s52 offen offset:1056 nt lds
    buffer_load_dwordx4 v18, s[28:31], s52 offen offset:2112 nt lds
    buffer_load_dwordx4 v19, s[28:31], s52 offen offset:3168 nt lds
    s_waitcnt vmcnt(56)
    s_barrier
    s_mov_b32 m0, 120576
    s_add_u32 s52, s57, 0
    buffer_load_dwordx4 v8, s[24:27], s52 offen offset:0 lds
    buffer_load_dwordx4 v9, s[24:27], s52 offen offset:1088 lds
    buffer_load_dwordx4 v10, s[24:27], s52 offen offset:2176 lds
    buffer_load_dwordx4 v11, s[24:27], s52 offen offset:3264 lds
    s_mov_b32 m0, 124928
    s_add_u32 s52, s57, 32768
    buffer_load_dwordx4 v8, s[24:27], s52 offen offset:0 lds
    buffer_load_dwordx4 v9, s[24:27], s52 offen offset:1088 lds
    buffer_load_dwordx4 v10, s[24:27], s52 offen offset:2176 lds
    buffer_load_dwordx4 v11, s[24:27], s52 offen offset:3264 lds
    s_mov_b32 m0, 129280
    s_add_u32 s52, s57, 65536
    buffer_load_dwordx4 v8, s[24:27], s52 offen offset:0 lds
    buffer_load_dwordx4 v9, s[24:27], s52 offen offset:1088 lds
    buffer_load_dwordx4 v10, s[24:27], s52 offen offset:2176 lds
    buffer_load_dwordx4 v11, s[24:27], s52 offen offset:3264 lds
    s_mov_b32 m0, 133632
    s_add_u32 s52, s57, 98304
    buffer_load_dwordx4 v8, s[24:27], s52 offen offset:0 lds
    buffer_load_dwordx4 v9, s[24:27], s52 offen offset:1088 lds
    buffer_load_dwordx4 v10, s[24:27], s52 offen offset:2176 lds
    buffer_load_dwordx4 v11, s[24:27], s52 offen offset:3264 lds
    s_add_u32 s57, s57, 524288
    s_cmp_eq_u32 s57, 5242880
    s_cselect_b32 s57, 0, s57
    s_mov_b32 m0, 54528
    s_add_u32 s52, s56, 0
    buffer_load_dwordx4 v12, s[20:23], s52 offen offset:0 lds
    buffer_load_dwordx4 v13, s[20:23], s52 offen offset:1024 lds
    buffer_load_dwordx4 v14, s[20:23], s52 offen offset:2048 lds
    buffer_load_dwordx4 v15, s[20:23], s52 offen offset:3072 lds
    s_mov_b32 m0, 58624
    s_add_u32 s52, s56, 40960
    buffer_load_dwordx4 v12, s[20:23], s52 offen offset:0 lds
    buffer_load_dwordx4 v13, s[20:23], s52 offen offset:1024 lds
    buffer_load_dwordx4 v14, s[20:23], s52 offen offset:2048 lds
    buffer_load_dwordx4 v15, s[20:23], s52 offen offset:3072 lds
    s_mov_b32 m0, 62720
    s_add_u32 s52, s56, 81920
    buffer_load_dwordx4 v12, s[20:23], s52 offen offset:0 lds
    buffer_load_dwordx4 v13, s[20:23], s52 offen offset:1024 lds
    buffer_load_dwordx4 v14, s[20:23], s52 offen offset:2048 lds
    buffer_load_dwordx4 v15, s[20:23], s52 offen offset:3072 lds
    s_add_u32 s56, s56, 128
    s_cmp_eq_u32 s56, 1280
    s_cselect_b32 s56, 0, s56
    s_mov_b32 m0, 68352
    s_add_u32 s52, s68, 0
    s_and_b32 s52, s52, 0xfff
    buffer_load_dwordx4 v20, s[32:35], s52 offen offset:0 nt lds
    buffer_load_dwordx4 v21, s[32:35], s52 offen offset:1088 nt lds
    buffer_load_dwordx4 v22, s[32:35], s52 offen offset:2176 nt lds
    buffer_load_dwordx4 v23, s[32:35], s52 offen offset:3264 nt lds
    s_mov_b32 m0, 72704
    s_add_u32 s52, s52, 16384
    buffer_load_dwordx4 v20, s[32:35], s52 offen offset:0 nt lds
    buffer_load_dwordx4 v21, s[32:35], s52 offen offset:1088 nt lds
    buffer_load_dwordx4 v22, s[32:35], s52 offen offset:2176 nt lds
    buffer_load_dwordx4 v23, s[32:35], s52 offen offset:3264 nt lds
    s_waitcnt vmcnt(56)
    s_barrier
    s_mov_b32 m0, 85760
    s_add_u32 s52, s57, 0
    buffer_load_dwordx4 v8, s[24:27], s52 offen offset:0 lds
    buffer_load_dwordx4 v9, s[24:27], s52 offen offset:1088 lds
    buffer_load_dwordx4 v10, s[24:27], s52 offen offset:2176 lds
    buffer_load_dwordx4 v11, s[24:27], s52 offen offset:3264 lds
    s_mov_b32 m0, 90112
    s_add_u32 s52, s57, 32768
    buffer_load_dwordx4 v8, s[24:27], s52 offen offset:0 lds
    buffer_load_dwordx4 v9, s[24:27], s52 offen offset:1088 lds
    buffer_load_dwordx4 v10, s[24:27], s52 offen offset:2176 lds
    buffer_load_dwordx4 v11, s[24:27], s52 offen offset:3264 lds
    s_mov_b32 m0, 94464
    s_add_u32 s52, s57, 65536
    buffer_load_dwordx4 v8, s[24:27], s52 offen offset:0 lds
    buffer_load_dwordx4 v9, s[24:27], s52 offen offset:1088 lds
    buffer_load_dwordx4 v10, s[24:27], s52 offen offset:2176 lds
    buffer_load_dwordx4 v11, s[24:27], s52 offen offset:3264 lds
    s_mov_b32 m0, 98816
    s_add_u32 s52, s57, 98304
    buffer_load_dwordx4 v8, s[24:27], s52 offen offset:0 lds
    buffer_load_dwordx4 v9, s[24:27], s52 offen offset:1088 lds
    buffer_load_dwordx4 v10, s[24:27], s52 offen offset:2176 lds
    buffer_load_dwordx4 v11, s[24:27], s52 offen offset:3264 lds
    s_add_u32 s57, s57, 524288
    s_cmp_eq_u32 s57, 5242880
    s_cselect_b32 s57, 0, s57
    s_mov_b32 m0, 137984
    s_add_u32 s52, s56, 0
    buffer_load_dwordx4 v12, s[20:23], s52 offen offset:0 lds
    buffer_load_dwordx4 v13, s[20:23], s52 offen offset:1024 lds
    buffer_load_dwordx4 v14, s[20:23], s52 offen offset:2048 lds
    buffer_load_dwordx4 v15, s[20:23], s52 offen offset:3072 lds
    s_mov_b32 m0, 142080
    s_add_u32 s52, s56, 40960
    buffer_load_dwordx4 v12, s[20:23], s52 offen offset:0 lds
    buffer_load_dwordx4 v13, s[20:23], s52 offen offset:1024 lds
    buffer_load_dwordx4 v14, s[20:23], s52 offen offset:2048 lds
    buffer_load_dwordx4 v15, s[20:23], s52 offen offset:3072 lds
    s_mov_b32 m0, 146176
    s_add_u32 s52, s56, 81920
    buffer_load_dwordx4 v12, s[20:23], s52 offen offset:0 lds
    buffer_load_dwordx4 v13, s[20:23], s52 offen offset:1024 lds
    buffer_load_dwordx4 v14, s[20:23], s52 offen offset:2048 lds
    buffer_load_dwordx4 v15, s[20:23], s52 offen offset:3072 lds
    s_add_u32 s56, s56, 128
    s_cmp_eq_u32 s56, 1280
    s_branch SK0
PAD0:
    s_branch BK0
SK0:
    s_cselect_b32 s56, 0, s56
    s_mov_b32 m0, 8448
    s_add_u32 s52, s68, 768
    s_and_b32 s52, s52, 0xfff
    buffer_load_dwordx4 v16, s[28:31], s52 offen offset:0 nt lds
    buffer_load_dwordx4 v17, s[28:31], s52 offen offset:1056 nt lds
    buffer_load_dwordx4 v18, s[28:31], s52 offen offset:2112 nt lds
    buffer_load_dwordx4 v19, s[28:31], s52 offen offset:3168 nt lds
    s_mov_b32 m0, 12672
    s_add_u32 s52, s52, 16384
    buffer_load_dwordx4 v16, s[28:31], s52 offen offset:0 nt lds
    buffer_load_dwordx4 v17, s[28:31], s52 offen offset:1056 nt lds
    buffer_load_dwordx4 v18, s[28:31], s52 offen offset:2112 nt lds
    buffer_load_dwordx4 v19, s[28:31], s52 offen offset:3168 nt lds
    s_waitcnt vmcnt(56)
    s_barrier
    s_mov_b32 s58, s57
    s_mov_b32 m0, 103168
    s_add_u32 s52, s57, 0
    buffer_load_dwordx4 v8, s[24:27], s52 offen offset:0 lds
    buffer_load_dwordx4 v9, s[24:27], s52 offen offset:1088 lds
    buffer_load_dwordx4 v10, s[24:27], s52 offen offset:2176 lds
    buffer_load_dwordx4 v11, s[24:27], s52 offen offset:3264 lds
    s_mov_b32 m0, 107520
    s_add_u32 s52, s57, 32768
    buffer_load_dwordx4 v8, s[24:27], s52 offen offset:0 lds
    buffer_load_dwordx4 v9, s[24:27], s52 offen offset:1088 lds
    buffer_load_dwordx4 v10, s[24:27], s52 offen offset:2176 lds
    buffer_load_dwordx4 v11, s[24:27], s52 offen offset:3264 lds
    s_mov_b32 m0, 111872
    s_add_u32 s52, s57, 65536
    buffer_load_dwordx4 v8, s[24:27], s52 offen offset:0 lds
    buffer_load_dwordx4 v9, s[24:27], s52 offen offset:1088 lds
    buffer_load_dwordx4 v10, s[24:27], s52 offen offset:2176 lds
    buffer_load_dwordx4 v11, s[24:27], s52 offen offset:3264 lds
    s_mov_b32 m0, 116224
    s_add_u32 s52, s57, 98304
    buffer_load_dwordx4 v8, s[24:27], s52 offen offset:0 lds
    buffer_load_dwordx4 v9, s[24:27], s52 offen offset:1088 lds
    buffer_load_dwordx4 v10, s[24:27], s52 offen offset:2176 lds
    buffer_load_dwordx4 v11, s[24:27], s52 offen offset:3264 lds
    s_add_u32 s57, s57, 524288
    s_cmp_eq_u32 s57, 5242880
    s_cselect_b32 s57, 0, s57
    s_mov_b32 m0, 150272
    s_add_u32 s52, s56, 0
    buffer_load_dwordx4 v12, s[20:23], s52 offen offset:0 lds
    buffer_load_dwordx4 v13, s[20:23], s52 offen offset:1024 lds
    buffer_load_dwordx4 v14, s[20:23], s52 offen offset:2048 lds
    buffer_load_dwordx4 v15, s[20:23], s52 offen offset:3072 lds
    s_mov_b32 m0, 154368
    s_add_u32 s52, s56, 40960
    buffer_load_dwordx4 v12, s[20:23], s52 offen offset:0 lds
    buffer_load_dwordx4 v13, s[20:23], s52 offen offset:1024 lds
    buffer_load_dwordx4 v14, s[20:23], s52 offen offset:2048 lds
    buffer_load_dwordx4 v15, s[20:23], s52 offen offset:3072 lds
    s_mov_b32 m0, 158464
    s_add_u32 s52, s56, 81920
    buffer_load_dwordx4 v12, s[20:23], s52 offen offset:0 lds
    buffer_load_dwordx4 v13, s[20:23], s52 offen offset:1024 lds
    buffer_load_dwordx4 v14, s[20:23], s52 offen offset:2048 lds
    buffer_load_dwordx4 v15, s[20:23], s52 offen offset:3072 lds
    s_add_u32 s56, s56, 128
    s_cmp_eq_u32 s56, 1280
    s_cselect_b32 s56, 0, s56
    s_mov_b32 m0, 77056
    s_add_u32 s52, s68, 256
    s_and_b32 s52, s52, 0xfff
    buffer_load_dwordx4 v20, s[32:35], s52 offen offset:0 nt lds
    buffer_load_dwordx4 v21, s[32:35], s52 offen offset:1088 nt lds
    buffer_load_dwordx4 v22, s[32:35], s52 offen offset:2176 nt lds
    buffer_load_dwordx4 v23, s[32:35], s52 offen offset:3264 nt lds
    s_mov_b32 m0, 81408
    s_add_u32 s52, s52, 16384
    buffer_load_dwordx4 v20, s[32:35], s52 offen offset:0 nt lds
    buffer_load_dwordx4 v21, s[32:35], s52 offen offset:1088 nt lds
    buffer_load_dwordx4 v22, s[32:35], s52 offen offset:2176 nt lds
    buffer_load_dwordx4 v23, s[32:35], s52 offen offset:3264 nt lds
    s_waitcnt vmcnt(56)
    s_barrier
    s_mov_b32 m0, 120576
    s_add_u32 s52, s57, 0
    buffer_load_dwordx4 v8, s[24:27], s52 offen offset:0 lds
    buffer_load_dwordx4 v9, s[24:27], s52 offen offset:1088 lds
    buffer_load_dwordx4 v10, s[24:27], s52 offen offset:2176 lds
    buffer_load_dwordx4 v11, s[24:27], s52 offen offset:3264 lds
    s_mov_b32 m0, 124928
    s_add_u32 s52, s57, 32768
    buffer_load_dwordx4 v8, s[24:27], s52 offen offset:0 lds
    buffer_load_dwordx4 v9, s[24:27], s52 offen offset:1088 lds
    buffer_load_dwordx4 v10, s[24:27], s52 offen offset:2176 lds
    buffer_load_dwordx4 v11, s[24:27], s52 offen offset:3264 lds
    s_mov_b32 m0, 129280
    s_add_u32 s52, s57, 65536
    buffer_load_dwordx4 v8, s[24:27], s52 offen offset:0 lds
    buffer_load_dwordx4 v9, s[24:27], s52 offen offset:1088 lds
    buffer_load_dwordx4 v10, s[24:27], s52 offen offset:2176 lds
    buffer_load_dwordx4 v11, s[24:27], s52 offen offset:3264 lds
    s_mov_b32 m0, 133632
    s_add_u32 s52, s57, 98304
    buffer_load_dwordx4 v8, s[24:27], s52 offen offset:0 lds
    buffer_load_dwordx4 v9, s[24:27], s52 offen offset:1088 lds
    buffer_load_dwordx4 v10, s[24:27], s52 offen offset:2176 lds
    buffer_load_dwordx4 v11, s[24:27], s52 offen offset:3264 lds
    s_add_u32 s57, s57, 524288
    s_cmp_eq_u32 s57, 5242880
    s_cselect_b32 s57, 0, s57
    s_mov_b32 m0, 16896
    s_add_u32 s52, s68, 1024
    s_and_b32 s52, s52, 0xfff
    buffer_load_dwordx4 v16, s[28:31], s52 offen offset:0 nt lds
    buffer_load_dwordx4 v17, s[28:31], s52 offen offset:1056 nt lds
    buffer_load_dwordx4 v18, s[28:31], s52 offen offset:2112 nt lds
    buffer_load_dwordx4 v19, s[28:31], s52 offen offset:3168 nt lds
    s_mov_b32 m0, 21120
    s_add_u32 s52, s52, 16384
    buffer_load_dwordx4 v16, s[28:31], s52 offen offset:0 nt lds
    buffer_load_dwordx4 v17, s[28:31], s52 offen offset:1056 nt lds
    buffer_load_dwordx4 v18, s[28:31], s52 offen offset:2112 nt lds
    buffer_load_dwordx4 v19, s[28:31], s52 offen offset:3168 nt lds
    s_waitcnt vmcnt(44)
    s_barrier
    s_mov_b32 m0, 85760
    s_add_u32 s52, s58, 256
    buffer_load_dwordx4 v8, s[24:27], s52 offen offset:0 lds
    buffer_load_dwordx4 v9, s[24:27], s52 offen offset:1088 lds
    buffer_load_dwordx4 v10, s[24:27], s52 offen offset:2176 lds
    buffer_load_dwordx4 v11, s[24:27], s52 offen offset:3264 lds
    s_mov_b32 m0, 90112
    s_add_u32 s52, s58, 33024
    buffer_load_dwordx4 v8, s[24:27], s52 offen offset:0 lds
    buffer_load_dwordx4 v9, s[24:27], s52 offen offset:1088 lds
    buffer_load_dwordx4 v10, s[24:27], s52 offen offset:2176 lds
    buffer_load_dwordx4 v11, s[24:27], s52 offen offset:3264 lds
    s_mov_b32 m0, 94464
    s_add_u32 s52, s58, 65792
    buffer_load_dwordx4 v8, s[24:27], s52 offen offset:0 lds
    buffer_load_dwordx4 v9, s[24:27], s52 offen offset:1088 lds
    buffer_load_dwordx4 v10, s[24:27], s52 offen offset:2176 lds
    buffer_load_dwordx4 v11, s[24:27], s52 offen offset:3264 lds
    s_mov_b32 m0, 98816
    s_add_u32 s52, s58, 98560
    buffer_load_dwordx4 v8, s[24:27], s52 offen offset:0 lds
    buffer_load_dwordx4 v9, s[24:27], s52 offen offset:1088 lds
    buffer_load_dwordx4 v10, s[24:27], s52 offen offset:2176 lds
    buffer_load_dwordx4 v11, s[24:27], s52 offen offset:3264 lds
    s_add_u32 s58, s58, 524288
    s_cmp_eq_u32 s58, 5242880
    s_cselect_b32 s58, 0, s58
    s_mov_b32 m0, 42240
    s_add_u32 s52, s68, 512
    s_and_b32 s52, s52, 0xfff
    buffer_load_dwordx4 v20, s[32:35], s52 offen offset:0 nt lds
    buffer_load_dwordx4 v21, s[32:35], s52 offen offset:1088 nt lds
    buffer_load_dwordx4 v22, s[32:35], s52 offen offset:2176 nt lds
    buffer_load_dwordx4 v23, s[32:35], s52 offen offset:3264 nt lds
    s_mov_b32 m0, 46592
    s_add_u32 s52, s52, 16384
    buffer_load_dwordx4 v20, s[32:35], s52 offen offset:0 nt lds
    buffer_load_dwordx4 v21, s[32:35], s52 offen offset:1088 nt lds
    buffer_load_dwordx4 v22, s[32:35], s52 offen offset:2176 nt lds
    buffer_load_dwordx4 v23, s[32:35], s52 offen offset:3264 nt lds
    s_waitcnt vmcnt(32)
    s_barrier
    s_mov_b32 m0, 103168
    s_add_u32 s52, s58, 256
    buffer_load_dwordx4 v8, s[24:27], s52 offen offset:0 lds
    buffer_load_dwordx4 v9, s[24:27], s52 offen offset:1088 lds
    buffer_load_dwordx4 v10, s[24:27], s52 offen offset:2176 lds
    buffer_load_dwordx4 v11, s[24:27], s52 offen offset:3264 lds
    s_mov_b32 m0, 107520
    s_add_u32 s52, s58, 33024
    buffer_load_dwordx4 v8, s[24:27], s52 offen offset:0 lds
    buffer_load_dwordx4 v9, s[24:27], s52 offen offset:1088 lds
    buffer_load_dwordx4 v10, s[24:27], s52 offen offset:2176 lds
    buffer_load_dwordx4 v11, s[24:27], s52 offen offset:3264 lds
    s_mov_b32 m0, 111872
    s_add_u32 s52, s58, 65792
    buffer_load_dwordx4 v8, s[24:27], s52 offen offset:0 lds
    buffer_load_dwordx4 v9, s[24:27], s52 offen offset:1088 lds
    buffer_load_dwordx4 v10, s[24:27], s52 offen offset:2176 lds
    buffer_load_dwordx4 v11, s[24:27], s52 offen offset:3264 lds
    s_mov_b32 m0, 116224
    s_add_u32 s52, s58, 98560
    buffer_load_dwordx4 v8, s[24:27], s52 offen offset:0 lds
    buffer_load_dwordx4 v9, s[24:27], s52 offen offset:1088 lds
    buffer_load_dwordx4 v10, s[24:27], s52 offen offset:2176 lds
    buffer_load_dwordx4 v11, s[24:27], s52 offen offset:3264 lds
    s_add_u32 s58, s58, 524288
    s_cmp_eq_u32 s58, 5242880
    s_cselect_b32 s58, 0, s58
    s_barrier
    s_barrier
    s_mov_b32 m0, 120576
    s_add_u32 s52, s58, 256
    buffer_load_dwordx4 v8, s[24:27], s52 offen offset:0 lds
    buffer_load_dwordx4 v9, s[24:27], s52 offen offset:1088 lds
    buffer_load_dwordx4 v10, s[24:27], s52 offen offset:2176 lds
    buffer_load_dwordx4 v11, s[24:27], s52 offen offset:3264 lds
    s_mov_b32 m0, 124928
    s_add_u32 s52, s58, 33024
    buffer_load_dwordx4 v8, s[24:27], s52 offen offset:0 lds
    buffer_load_dwordx4 v9, s[24:27], s52 offen offset:1088 lds
    buffer_load_dwordx4 v10, s[24:27], s52 offen offset:2176 lds
    buffer_load_dwordx4 v11, s[24:27], s52 offen offset:3264 lds
    s_mov_b32 m0, 129280
    s_add_u32 s52, s58, 65792
    buffer_load_dwordx4 v8, s[24:27], s52 offen offset:0 lds
    buffer_load_dwordx4 v9, s[24:27], s52 offen offset:1088 lds
    buffer_load_dwordx4 v10, s[24:27], s52 offen offset:2176 lds
    buffer_load_dwordx4 v11, s[24:27], s52 offen offset:3264 lds
    s_mov_b32 m0, 133632
    s_add_u32 s52, s58, 98560
    buffer_load_dwordx4 v8, s[24:27], s52 offen offset:0 lds
    buffer_load_dwordx4 v9, s[24:27], s52 offen offset:1088 lds
    buffer_load_dwordx4 v10, s[24:27], s52 offen offset:2176 lds
    buffer_load_dwordx4 v11, s[24:27], s52 offen offset:3264 lds
    s_add_u32 s58, s58, 524288
    s_cmp_eq_u32 s58, 5242880
    s_cselect_b32 s58, 0, s58
    s_mov_b32 m0, 25344
    s_add_u32 s52, s68, 1280
    s_and_b32 s52, s52, 0xfff
    buffer_load_dwordx4 v16, s[28:31], s52 offen offset:0 nt lds
    buffer_load_dwordx4 v17, s[28:31], s52 offen offset:1056 nt lds
    buffer_load_dwordx4 v18, s[28:31], s52 offen offset:2112 nt lds
    buffer_load_dwordx4 v19, s[28:31], s52 offen offset:3168 nt lds
    s_mov_b32 m0, 29568
    s_add_u32 s52, s52, 16384
    buffer_load_dwordx4 v16, s[28:31], s52 offen offset:0 nt lds
    buffer_load_dwordx4 v17, s[28:31], s52 offen offset:1056 nt lds
    buffer_load_dwordx4 v18, s[28:31], s52 offen offset:2112 nt lds
    buffer_load_dwordx4 v19, s[28:31], s52 offen offset:3168 nt lds
    s_waitcnt vmcnt(48)
    s_barrier
    s_mov_b32 m0, 50944
    s_add_u32 s52, s68, 768
    s_and_b32 s52, s52, 0xfff
    buffer_load_dwordx4 v20, s[32:35], s52 offen offset:0 nt lds
    buffer_load_dwordx4 v21, s[32:35], s52 offen offset:1088 nt lds
    buffer_load_dwordx4 v22, s[32:35], s52 offen offset:2176 nt lds
    buffer_load_dwordx4 v23, s[32:35], s52 offen offset:3264 nt lds
    s_mov_b32 m0, 55296
    s_add_u32 s52, s52, 16384
    buffer_load_dwordx4 v20, s[32:35], s52 offen offset:0 nt lds
    buffer_load_dwordx4 v21, s[32:35], s52 offen offset:1088 nt lds
    buffer_load_dwordx4 v22, s[32:35], s52 offen offset:2176 nt lds
    buffer_load_dwordx4 v23, s[32:35], s52 offen offset:3264 nt lds
    s_mov_b32 m0, 33792
    s_add_u32 s52, s68, 1536
    s_and_b32 s52, s52, 0xfff
    buffer_load_dwordx4 v16, s[28:31], s52 offen offset:0 nt lds
    buffer_load_dwordx4 v17, s[28:31], s52 offen offset:1056 nt lds
    buffer_load_dwordx4 v18, s[28:31], s52 offen offset:2112 nt lds
    buffer_load_dwordx4 v19, s[28:31], s52 offen offset:3168 nt lds
    s_mov_b32 m0, 38016
    s_add_u32 s52, s52, 16384
    buffer_load_dwordx4 v16, s[28:31], s52 offen offset:0 nt lds
    buffer_load_dwordx4 v17, s[28:31], s52 offen offset:1056 nt lds
    buffer_load_dwordx4 v18, s[28:31], s52 offen offset:2112 nt lds
    buffer_load_dwordx4 v19, s[28:31], s52 offen offset:3168 nt lds
    s_waitcnt vmcnt(40)
    s_barrier
    s_mov_b32 m0, 85760
    s_add_u32 s52, s58, 256
    buffer_load_dwordx4 v8, s[24:27], s52 offen offset:0 lds
    buffer_load_dwordx4 v9, s[24:27], s52 offen offset:1088 lds
    buffer_load_dwordx4 v10, s[24:27], s52 offen offset:2176 lds
    buffer_load_dwordx4 v11, s[24:27], s52 offen offset:3264 lds
    s_mov_b32 m0, 90112
    s_add_u32 s52, s58, 33024
    buffer_load_dwordx4 v8, s[24:27], s52 offen offset:0 lds
    buffer_load_dwordx4 v9, s[24:27], s52 offen offset:1088 lds
    buffer_load_dwordx4 v10, s[24:27], s52 offen offset:2176 lds
    buffer_load_dwordx4 v11, s[24:27], s52 offen offset:3264 lds
    s_mov_b32 m0, 94464
    s_add_u32 s52, s58, 65792
    buffer_load_dwordx4 v8, s[24:27], s52 offen offset:0 lds
    buffer_load_dwordx4 v9, s[24:27], s52 offen offset:1088 lds
    buffer_load_dwordx4 v10, s[24:27], s52 offen offset:2176 lds
    buffer_load_dwordx4 v11, s[24:27], s52 offen offset:3264 lds
    s_mov_b32 m0, 98816
    s_add_u32 s52, s58, 98560
    buffer_load_dwordx4 v8, s[24:27], s52 offen offset:0 lds
    buffer_load_dwordx4 v9, s[24:27], s52 offen offset:1088 lds
    buffer_load_dwordx4 v10, s[24:27], s52 offen offset:2176 lds
    buffer_load_dwordx4 v11, s[24:27], s52 offen offset:3264 lds
    s_add_u32 s58, s58, 524288
    s_cmp_eq_u32 s58, 5242880
    s_cselect_b32 s58, 0, s58
    s_waitcnt vmcnt(40)
    s_barrier
    s_mov_b32 m0, 59648
    s_add_u32 s52, s68, 1024
    s_and_b32 s52, s52, 0xfff
    buffer_load_dwordx4 v20, s[32:35], s52 offen offset:0 nt lds
    buffer_load_dwordx4 v21, s[32:35], s52 offen offset:1088 nt lds
    buffer_load_dwordx4 v22, s[32:35], s52 offen offset:2176 nt lds
    buffer_load_dwordx4 v23, s[32:35], s52 offen offset:3264 nt lds
    s_mov_b32 m0, 64000
    s_add_u32 s52, s52, 16384
    buffer_load_dwordx4 v20, s[32:35], s52 offen offset:0 nt lds
    buffer_load_dwordx4 v21, s[32:35], s52 offen offset:1088 nt lds
    buffer_load_dwordx4 v22, s[32:35], s52 offen offset:2176 nt lds
    buffer_load_dwordx4 v23, s[32:35], s52 offen offset:3264 nt lds
    s_mov_b32 m0, 0
    s_add_u32 s52, s68, 1792
    s_and_b32 s52, s52, 0xfff
    buffer_load_dwordx4 v16, s[28:31], s52 offen offset:0 nt lds
    buffer_load_dwordx4 v17, s[28:31], s52 offen offset:1056 nt lds
    buffer_load_dwordx4 v18, s[28:31], s52 offen offset:2112 nt lds
    buffer_load_dwordx4 v19, s[28:31], s52 offen offset:3168 nt lds
    s_mov_b32 m0, 4224
    s_add_u32 s52, s52, 16384
    buffer_load_dwordx4 v16, s[28:31], s52 offen offset:0 nt lds
    buffer_load_dwordx4 v17, s[28:31], s52 offen offset:1056 nt lds
    buffer_load_dwordx4 v18, s[28:31], s52 offen offset:2112 nt lds
    buffer_load_dwordx4 v19, s[28:31], s52 offen offset:3168 nt lds
    s_waitcnt vmcnt(16)
    s_barrier
    v_add_u32 v1, 0, v0
    v_mul_u32_u24 v2, 3277, v1
    v_lshrrev_b32 v2, 16, v2
    v_mul_u32_u24 v3, 20, v2
    v_sub_u32 v3, v1, v3
    v_mul_u32_u24 v2, 1280, v2
    v_lshl_add_u32 v2, v3, 4, v2
    v_subrev_u32 v24, 0, v2
    v_add_u32 v1, 64, v0
    v_mul_u32_u24 v2, 3277, v1
    v_lshrrev_b32 v2, 16, v2
    v_mul_u32_u24 v3, 20, v2
    v_sub_u32 v3, v1, v3
    v_mul_u32_u24 v2, 1280, v2
    v_lshl_add_u32 v2, v3, 4, v2
    v_subrev_u32 v25, 1024, v2
    v_add_u32 v1, 128, v0
    v_mul_u32_u24 v2, 3277, v1
    v_lshrrev_b32 v2, 16, v2
    v_mul_u32_u24 v3, 20, v2
    v_sub_u32 v3, v1, v3
    v_mul_u32_u24 v2, 1280, v2
    v_lshl_add_u32 v2, v3, 4, v2
    v_subrev_u32 v26, 2048, v2
    v_add_u32 v1, 192, v0
    v_mul_u32_u24 v2, 3277, v1
    v_lshrrev_b32 v2, 16, v2
    v_mul_u32_u24 v3, 20, v2
    v_sub_u32 v3, v1, v3
    v_mul_u32_u24 v2, 1280, v2
    v_lshl_add_u32 v2, v3, 4, v2
    v_subrev_u32 v27, 3072, v2
    v_add_u32 v1, 256, v0
    v_mul_u32_u24 v2, 3277, v1
    v_lshrrev_b32 v2, 16, v2
    v_mul_u32_u24 v3, 20, v2
    v_sub_u32 v3, v1, v3
    v_mul_u32_u24 v2, 1280, v2
    v_lshl_add_u32 v2, v3, 4, v2
    v_subrev_u32 v28, 0, v2
    v_add_u32 v1, 320, v0
    v_mul_u32_u24 v2, 3277, v1
    v_lshrrev_b32 v2, 16, v2
    v_mul_u32_u24 v3, 20, v2
    v_sub_u32 v3, v1, v3
    v_mul_u32_u24 v2, 1280, v2
    v_lshl_add_u32 v2, v3, 4, v2
    v_subrev_u32 v29, 1024, v2
    v_add_u32 v1, 384, v0
    v_mul_u32_u24 v2, 3277, v1
    v_lshrrev_b32 v2, 16, v2
    v_mul_u32_u24 v3, 20, v2
    v_sub_u32 v3, v1, v3
    v_mul_u32_u24 v2, 1280, v2
    v_lshl_add_u32 v2, v3, 4, v2
    v_subrev_u32 v30, 2048, v2
    v_add_u32 v1, 448, v0
    v_mul_u32_u24 v2, 3277, v1
    v_lshrrev_b32 v2, 16, v2
    v_mul_u32_u24 v3, 20, v2
    v_sub_u32 v3, v1, v3
    v_mul_u32_u24 v2, 1280, v2
    v_lshl_add_u32 v2, v3, 4, v2
    v_subrev_u32 v31, 3072, v2
    v_add_u32 v1, 512, v0
    v_mul_u32_u24 v2, 3277, v1
    v_lshrrev_b32 v2, 16, v2
    v_mul_u32_u24 v3, 20, v2
    v_sub_u32 v3, v1, v3
    v_mul_u32_u24 v2, 1280, v2
    v_lshl_add_u32 v2, v3, 4, v2
    v_subrev_u32 v32, 0, v2
    v_add_u32 v1, 576, v0
    v_mul_u32_u24 v2, 3277, v1
    v_lshrrev_b32 v2, 16, v2
    v_mul_u32_u24 v3, 20, v2
    v_sub_u32 v3, v1, v3
    v_mul_u32_u24 v2, 1280, v2
    v_lshl_add_u32 v2, v3, 4, v2
    v_subrev_u32 v33, 1024, v2
    v_lshlrev_b32 v34, 4, v0
    v_and_b32 v1, 15, v0
    v_lshlrev_b32 v35, 2, v1
    s_mul_i32 s52, s49, 1310720
    s_mul_i32 s53, s50, 320
    s_add_u32 s52, s52, s53
    s_sub_u32 s53, 5242880, s52
    s_add_u32 s40, s12, s52
    s_addc_u32 s41, s13, 0
    s_mov_b32 s42, s53
    s_mov_b32 s43, 0x20000
    s_lshl_b32 s54, s48, 5
    s_lshl_b32 s55, s49, 3
    s_add_u32 s54, s54, s55
    s_mul_i32 s54, s54, 24576
    s_add_u32 s36, s18, s54
    s_addc_u32 s37, s19, 0
    s_mov_b32 s38, 196608
    s_mov_b32 s39, 0x20000
    s_lshl_b32 s52, s48, 14
    s_lshl_b32 s53, s49, 8
    s_add_u32 s52, s52, s53
    s_add_u32 s52, s52, 33554432
    s_add_u32 s72, s18, s52
    s_addc_u32 s73, s19, 0
    s_mov_b32 s74, 256
    s_mov_b32 s75, 0x20000
    s_mov_b32 s44, s16
    s_mov_b32 s45, s17
    s_mov_b32 s46, 256
    s_mov_b32 s47, 0x20000
    s_lshl_b32 s52, s48, 2
    v_mov_b32 v37, s52
    s_lshl_b32 s52, s50, 2
    s_lshl_b32 s52, 15, s52
    s_andn2_b32 s59, 0x7777, s52
    s_bfe_u32 s52, s48, 0x10000
    s_lshl_b32 s52, s52, 1
    s_xor_b32 s60, s52, 0
    s_bfe_u32 s52, s48, 0x10000
    s_lshl_b32 s52, s52, 1
    s_xor_b32 s61, s52, 1
    s_bfe_u32 s52, s48, 0x10000
    s_lshl_b32 s52, s52, 1
    s_xor_b32 s62, s52, 2
    s_bfe_u32 s52, s48, 0x10000
    s_lshl_b32 s52, s52, 1
    s_xor_b32 s63, s52, 3
    s_lshl_b32 s64, s50, 3
    s_and_b32 s52, s48, 7
    s_lshl_b32 s52, s52, 1
    s_lshr_b32 s52, 19024, s52
    s_and_b32 s52, s52, 3
    s_add_u32 s53, s52, s50
    s_add_u32 s53, s53, 1
    s_and_b32 s53, s53, 3
    s_lshl_b32 s65, s53, 3
    s_add_u32 s52, s52, 1
    s_cmp_eq_u32 s52, 3
    s_cselect_b32 s52, 0, s52
    s_add_u32 s53, s52, s50
    s_add_u32 s53, s53, 1
    s_and_b32 s53, s53, 3
    s_lshl_b32 s66, s53, 3
    s_add_u32 s52, s52, 1
    s_cmp_eq_u32 s52, 3
    s_cselect_b32 s52, 0, s52
    s_add_u32 s53, s52, s50
    s_add_u32 s53, s53, 1
    s_and_b32 s53, s53, 3
    s_lshl_b32 s67, s53, 3
    s_add_u32 s52, s52, 1
    s_cmp_eq_u32 s52, 3
    s_cselect_b32 s52, 0, s52
    s_mov_b32 m0, 103168
    s_add_u32 s52, s58, 256
    buffer_load_dwordx4 v8, s[24:27], s52 offen offset:0 lds
    buffer_load_dwordx4 v9, s[24:27], s52 offen offset:1088 lds
    buffer_load_dwordx4 v10, s[24:27], s52 offen offset:2176 lds
    buffer_load_dwordx4 v11, s[24:27], s52 offen offset:3264 lds
    s_mov_b32 m0, 107520
    s_add_u32 s52, s58, 33024
    buffer_load_dwordx4 v8, s[24:27], s52 offen offset:0 lds
    buffer_load_dwordx4 v9, s[24:27], s52 offen offset:1088 lds
    buffer_load_dwordx4 v10, s[24:27], s52 offen offset:2176 lds
    buffer_load_dwordx4 v11, s[24:27], s52 offen offset:3264 lds
    s_mov_b32 m0, 111872
    s_add_u32 s52, s58, 65792
    buffer_load_dwordx4 v8, s[24:27], s52 offen offset:0 lds
    buffer_load_dwordx4 v9, s[24:27], s52 offen offset:1088 lds
    buffer_load_dwordx4 v10, s[24:27], s52 offen offset:2176 lds
    buffer_load_dwordx4 v11, s[24:27], s52 offen offset:3264 lds
    s_mov_b32 m0, 116224
    s_add_u32 s52, s58, 98560
    buffer_load_dwordx4 v8, s[24:27], s52 offen offset:0 lds
    buffer_load_dwordx4 v9, s[24:27], s52 offen offset:1088 lds
    buffer_load_dwordx4 v10, s[24:27], s52 offen offset:2176 lds
    buffer_load_dwordx4 v11, s[24:27], s52 offen offset:3264 lds
    s_add_u32 s58, s58, 524288
    s_cmp_eq_u32 s58, 5242880
    s_cselect_b32 s58, 0, s58
    s_mov_b32 m0, 68352
    s_add_u32 s52, s68, 1280
    s_and_b32 s52, s52, 0xfff
    buffer_load_dwordx4 v20, s[32:35], s52 offen offset:0 nt lds
    buffer_load_dwordx4 v21, s[32:35], s52 offen offset:1088 nt lds
    buffer_load_dwordx4 v22, s[32:35], s52 offen offset:2176 nt lds
    buffer_load_dwordx4 v23, s[32:35], s52 offen offset:3264 nt lds
    s_mov_b32 m0, 72704
    s_add_u32 s52, s52, 16384
    buffer_load_dwordx4 v20, s[32:35], s52 offen offset:0 nt lds
    buffer_load_dwordx4 v21, s[32:35], s52 offen offset:1088 nt lds
    buffer_load_dwordx4 v22, s[32:35], s52 offen offset:2176 nt lds
    buffer_load_dwordx4 v23, s[32:35], s52 offen offset:3264 nt lds
    s_mov_b32 m0, 8448
    s_add_u32 s52, s68, 2048
    s_and_b32 s52, s52, 0xfff
    buffer_load_dwordx4 v16, s[28:31], s52 offen offset:0 nt lds
    buffer_load_dwordx4 v17, s[28:31], s52 offen offset:1056 nt lds
    buffer_load_dwordx4 v18, s[28:31], s52 offen offset:2112 nt lds
    buffer_load_dwordx4 v19, s[28:31], s52 offen offset:3168 nt lds
    s_mov_b32 m0, 12672
    s_add_u32 s52, s52, 16384
    buffer_load_dwordx4 v16, s[28:31], s52 offen offset:0 nt lds
    buffer_load_dwordx4 v17, s[28:31], s52 offen offset:1056 nt lds
    buffer_load_dwordx4 v18, s[28:31], s52 offen offset:2112 nt lds
    buffer_load_dwordx4 v19, s[28:31], s52 offen offset:3168 nt lds
    s_barrier
    s_mov_b32 m0, 120576
    s_add_u32 s52, s58, 256
    buffer_load_dwordx4 v8, s[24:27], s52 offen offset:0 lds
    buffer_load_dwordx4 v9, s[24:27], s52 offen offset:1088 lds
    buffer_load_dwordx4 v10, s[24:27], s52 offen offset:2176 lds
    buffer_load_dwordx4 v11, s[24:27], s52 offen offset:3264 lds
    s_mov_b32 m0, 124928
    s_add_u32 s52, s58, 33024
    buffer_load_dwordx4 v8, s[24:27], s52 offen offset:0 lds
    buffer_load_dwordx4 v9, s[24:27], s52 offen offset:1088 lds
    buffer_load_dwordx4 v10, s[24:27], s52 offen offset:2176 lds
    buffer_load_dwordx4 v11, s[24:27], s52 offen offset:3264 lds
    s_mov_b32 m0, 129280
    s_add_u32 s52, s58, 65792
    buffer_load_dwordx4 v8, s[24:27], s52 offen offset:0 lds
    buffer_load_dwordx4 v9, s[24:27], s52 offen offset:1088 lds
    buffer_load_dwordx4 v10, s[24:27], s52 offen offset:2176 lds
    buffer_load_dwordx4 v11, s[24:27], s52 offen offset:3264 lds
    s_mov_b32 m0, 133632
    s_add_u32 s52, s58, 98560
    buffer_load_dwordx4 v8, s[24:27], s52 offen offset:0 lds
    buffer_load_dwordx4 v9, s[24:27], s52 offen offset:1088 lds
    buffer_load_dwordx4 v10, s[24:27], s52 offen offset:2176 lds
    buffer_load_dwordx4 v11, s[24:27], s52 offen offset:3264 lds
    s_add_u32 s58, s58, 524288
    s_cmp_eq_u32 s58, 5242880
    s_cselect_b32 s58, 0, s58
    s_mov_b32 m0, 77056
    s_add_u32 s52, s68, 1536
    s_and_b32 s52, s52, 0xfff
    buffer_load_dwordx4 v20, s[32:35], s52 offen offset:0 nt lds
    buffer_load_dwordx4 v21, s[32:35], s52 offen offset:1088 nt lds
    buffer_load_dwordx4 v22, s[32:35], s52 offen offset:2176 nt lds
    buffer_load_dwordx4 v23, s[32:35], s52 offen offset:3264 nt lds
    s_mov_b32 m0, 81408
    s_add_u32 s52, s52, 16384
    buffer_load_dwordx4 v20, s[32:35], s52 offen offset:0 nt lds
    buffer_load_dwordx4 v21, s[32:35], s52 offen offset:1088 nt lds
    buffer_load_dwordx4 v22, s[32:35], s52 offen offset:2176 nt lds
    buffer_load_dwordx4 v23, s[32:35], s52 offen offset:3264 nt lds
    s_mov_b32 m0, 16896
    s_add_u32 s52, s68, 2304
    s_and_b32 s52, s52, 0xfff
    buffer_load_dwordx4 v16, s[28:31], s52 offen offset:0 nt lds
    buffer_load_dwordx4 v17, s[28:31], s52 offen offset:1056 nt lds
    s_branch SK1
PAD1:
    s_branch BK1
SK1:
    buffer_load_dwordx4 v18, s[28:31], s52 offen offset:2112 nt lds
    buffer_load_dwordx4 v19, s[28:31], s52 offen offset:3168 nt lds
    s_mov_b32 m0, 21120
    s_add_u32 s52, s52, 16384
    buffer_load_dwordx4 v16, s[28:31], s52 offen offset:0 nt lds
    buffer_load_dwordx4 v17, s[28:31], s52 offen offset:1056 nt lds
    buffer_load_dwordx4 v18, s[28:31], s52 offen offset:2112 nt lds
    buffer_load_dwordx4 v19, s[28:31], s52 offen offset:3168 nt lds
    s_waitcnt vmcnt(48)
    s_barrier
    s_mov_b32 m0, 85760
    s_add_u32 s52, s58, 256
    buffer_load_dwordx4 v8, s[24:27], s52 offen offset:0 lds
    buffer_load_dwordx4 v9, s[24:27], s52 offen offset:1088 lds
    buffer_load_dwordx4 v10, s[24:27], s52 offen offset:2176 lds
    buffer_load_dwordx4 v11, s[24:27], s52 offen offset:3264 lds
    s_mov_b32 m0, 90112
    s_add_u32 s52, s58, 33024
    buffer_load_dwordx4 v8, s[24:27], s52 offen offset:0 lds
    buffer_load_dwordx4 v9, s[24:27], s52 offen offset:1088 lds
    buffer_load_dwordx4 v10, s[24:27], s52 offen offset:2176 lds
    buffer_load_dwordx4 v11, s[24:27], s52 offen offset:3264 lds
    s_mov_b32 m0, 94464
    s_add_u32 s52, s58, 65792
    buffer_load_dwordx4 v8, s[24:27], s52 offen offset:0 lds
    buffer_load_dwordx4 v9, s[24:27], s52 offen offset:1088 lds
    buffer_load_dwordx4 v10, s[24:27], s52 offen offset:2176 lds
    buffer_load_dwordx4 v11, s[24:27], s52 offen offset:3264 lds
    s_mov_b32 m0, 98816
    s_add_u32 s52, s58, 98560
    buffer_load_dwordx4 v8, s[24:27], s52 offen offset:0 lds
    buffer_load_dwordx4 v9, s[24:27], s52 offen offset:1088 lds
    buffer_load_dwordx4 v10, s[24:27], s52 offen offset:2176 lds
    buffer_load_dwordx4 v11, s[24:27], s52 offen offset:3264 lds
    s_add_u32 s58, s58, 524288
    s_cmp_eq_u32 s58, 5242880
    s_cselect_b32 s58, 0, s58
    buffer_load_dword v38, v37, s[44:47], 0 offen sc1
    s_mov_b32 m0, 42240
    s_add_u32 s52, s68, 1792
    s_and_b32 s52, s52, 0xfff
    buffer_load_dwordx4 v20, s[32:35], s52 offen offset:0 nt lds
    buffer_load_dwordx4 v21, s[32:35], s52 offen offset:1088 nt lds
    buffer_load_dwordx4 v22, s[32:35], s52 offen offset:2176 nt lds
    buffer_load_dwordx4 v23, s[32:35], s52 offen offset:3264 nt lds
    s_mov_b32 m0, 46592
    s_add_u32 s52, s52, 16384
    buffer_load_dwordx4 v20, s[32:35], s52 offen offset:0 nt lds
    buffer_load_dwordx4 v21, s[32:35], s52 offen offset:1088 nt lds
    buffer_load_dwordx4 v22, s[32:35], s52 offen offset:2176 nt lds
    buffer_load_dwordx4 v23, s[32:35], s52 offen offset:3264 nt lds
    s_mov_b32 m0, 25344
    s_add_u32 s52, s68, 2560
    s_and_b32 s52, s52, 0xfff
    buffer_load_dwordx4 v16, s[28:31], s52 offen offset:0 nt lds
    buffer_load_dwordx4 v17, s[28:31], s52 offen offset:1056 nt lds
    buffer_load_dwordx4 v18, s[28:31], s52 offen offset:2112 nt lds
    buffer_load_dwordx4 v19, s[28:31], s52 offen offset:3168 nt lds
    s_mov_b32 m0, 29568
    s_add_u32 s52, s52, 16384
    buffer_load_dwordx4 v16, s[28:31], s52 offen offset:0 nt lds
    buffer_load_dwordx4 v17, s[28:31], s52 offen offset:1056 nt lds
    buffer_load_dwordx4 v18, s[28:31], s52 offen offset:2112 nt lds
    buffer_load_dwordx4 v19, s[28:31], s52 offen offset:3168 nt lds
    s_waitcnt vmcnt(49)
    s_barrier
    s_mov_b32 m0, 50944
    s_add_u32 s52, s68, 2048
    s_and_b32 s52, s52, 0xfff
    buffer_load_dwordx4 v20, s[32:35], s52 offen offset:0 nt lds
    buffer_load_dwordx4 v21, s[32:35], s52 offen offset:1088 nt lds
    buffer_load_dwordx4 v22, s[32:35], s52 offen offset:2176 nt lds
    buffer_load_dwordx4 v23, s[32:35], s52 offen offset:3264 nt lds
    s_mov_b32 m0, 55296
    s_add_u32 s52, s52, 16384
    buffer_load_dwordx4 v20, s[32:35], s52 offen offset:0 nt lds
    buffer_load_dwordx4 v21, s[32:35], s52 offen offset:1088 nt lds
    buffer_load_dwordx4 v22, s[32:35], s52 offen offset:2176 nt lds
    buffer_load_dwordx4 v23, s[32:35], s52 offen offset:3264 nt lds
    s_mov_b32 m0, 33792
    s_add_u32 s52, s68, 2816
    s_and_b32 s52, s52, 0xfff
    buffer_load_dwordx4 v16, s[28:31], s52 offen offset:0 nt lds
    buffer_load_dwordx4 v17, s[28:31], s52 offen offset:1056 nt lds
    buffer_load_dwordx4 v18, s[28:31], s52 offen offset:2112 nt lds
    buffer_load_dwordx4 v19, s[28:31], s52 offen offset:3168 nt lds
    s_mov_b32 m0, 38016
    s_add_u32 s52, s52, 16384
    buffer_load_dwordx4 v16, s[28:31], s52 offen offset:0 nt lds
    buffer_load_dwordx4 v17, s[28:31], s52 offen offset:1056 nt lds
    buffer_load_dwordx4 v18, s[28:31], s52 offen offset:2112 nt lds
    buffer_load_dwordx4 v19, s[28:31], s52 offen offset:3168 nt lds
    s_waitcnt vmcnt(33)
    s_barrier
    s_mov_b32 m0, 103168
    s_add_u32 s52, s58, 256
    buffer_load_dwordx4 v8, s[24:27], s52 offen offset:0 lds
    buffer_load_dwordx4 v9, s[24:27], s52 offen offset:1088 lds
    buffer_load_dwordx4 v10, s[24:27], s52 offen offset:2176 lds
    buffer_load_dwordx4 v11, s[24:27], s52 offen offset:3264 lds
    s_mov_b32 m0, 107520
    s_add_u32 s52, s58, 33024
    buffer_load_dwordx4 v8, s[24:27], s52 offen offset:0 lds
    buffer_load_dwordx4 v9, s[24:27], s52 offen offset:1088 lds
    buffer_load_dwordx4 v10, s[24:27], s52 offen offset:2176 lds
    buffer_load_dwordx4 v11, s[24:27], s52 offen offset:3264 lds
    s_mov_b32 m0, 111872
    s_add_u32 s52, s58, 65792
    buffer_load_dwordx4 v8, s[24:27], s52 offen offset:0 lds
    buffer_load_dwordx4 v9, s[24:27], s52 offen offset:1088 lds
    buffer_load_dwordx4 v10, s[24:27], s52 offen offset:2176 lds
    buffer_load_dwordx4 v11, s[24:27], s52 offen offset:3264 lds
    s_mov_b32 m0, 116224
    s_add_u32 s52, s58, 98560
    buffer_load_dwordx4 v8, s[24:27], s52 offen offset:0 lds
    buffer_load_dwordx4 v9, s[24:27], s52 offen offset:1088 lds
    buffer_load_dwordx4 v10, s[24:27], s52 offen offset:2176 lds
    buffer_load_dwordx4 v11, s[24:27], s52 offen offset:3264 lds
    s_add_u32 s58, s58, 524288
    s_cmp_eq_u32 s58, 5242880
    s_cselect_b32 s58, 0, s58
    s_waitcnt vmcnt(48)
    v_readfirstlane_b32 s53, v38
    s_cmp_eq_u32 s53, 1
    s_cbranch_scc1 L_cntC_done
    s_mov_b32 s55, 0
L_cntC:
    buffer_load_dword v38, v37, s[44:47], 0 offen sc1
    s_add_u32 s55, s55, 1
    s_waitcnt vmcnt(0)
    s_cmp_ge_u32 s55, 200000
    s_cbranch_scc1 L_cntC_done
    v_readfirstlane_b32 s53, v38
    s_cmp_eq_u32 s53, 1
    s_cbranch_scc0 L_cntC
L_cntC_done:
    s_mov_b32 m0, 59648
    s_add_u32 s52, s68, 2304
    s_and_b32 s52, s52, 0xfff
    buffer_load_dwordx4 v20, s[32:35], s52 offen offset:0 nt lds
    buffer_load_dwordx4 v21, s[32:35], s52 offen offset:1088 nt lds
    buffer_load_dwordx4 v22, s[32:35], s52 offen offset:2176 nt lds
    buffer_load_dwordx4 v23, s[32:35], s52 offen offset:3264 nt lds
    s_mov_b32 m0, 64000
    s_add_u32 s52, s52, 16384
    buffer_load_dwordx4 v20, s[32:35], s52 offen offset:0 nt lds
    buffer_load_dwordx4 v21, s[32:35], s52 offen offset:1088 nt lds
    buffer_load_dwordx4 v22, s[32:35], s52 offen offset:2176 nt lds
    buffer_load_dwordx4 v23, s[32:35], s52 offen offset:3264 nt lds
    s_mov_b32 m0, 0
    s_add_u32 s52, s68, 3072
    s_and_b32 s52, s52, 0xfff
    buffer_load_dwordx4 v16, s[28:31], s52 offen offset:0 nt lds
    buffer_load_dwordx4 v17, s[28:31], s52 offen offset:1056 nt lds
    buffer_load_dwordx4 v18, s[28:31], s52 offen offset:2112 nt lds
    buffer_load_dwordx4 v19, s[28:31], s52 offen offset:3168 nt lds
    s_mov_b32 m0, 4224
    s_add_u32 s52, s52, 16384
    buffer_load_dwordx4 v16, s[28:31], s52 offen offset:0 nt lds
    buffer_load_dwordx4 v17, s[28:31], s52 offen offset:1056 nt lds
    buffer_load_dwordx4 v18, s[28:31], s52 offen offset:2112 nt lds
    buffer_load_dwordx4 v19, s[28:31], s52 offen offset:3168 nt lds
    s_mov_b32 m0, 68352
    s_add_u32 s52, s68, 2560
    s_and_b32 s52, s52, 0xfff
    buffer_load_dwordx4 v20, s[32:35], s52 offen offset:0 nt lds
    buffer_load_dwordx4 v21, s[32:35], s52 offen offset:1088 nt lds
    buffer_load_dwordx4 v22, s[32:35], s52 offen offset:2176 nt lds
    buffer_load_dwordx4 v23, s[32:35], s52 offen offset:3264 nt lds
    s_mov_b32 m0, 72704
    s_add_u32 s52, s52, 16384
    buffer_load_dwordx4 v20, s[32:35], s52 offen offset:0 nt lds
    buffer_load_dwordx4 v21, s[32:35], s52 offen offset:1088 nt lds
    buffer_load_dwordx4 v22, s[32:35], s52 offen offset:2176 nt lds
    buffer_load_dwordx4 v23, s[32:35], s52 offen offset:3264 nt lds
    s_mov_b32 m0, 8448
    s_add_u32 s52, s68, 3328
    s_and_b32 s52, s52, 0xfff
    buffer_load_dwordx4 v16, s[28:31], s52 offen offset:0 nt lds
    buffer_load_dwordx4 v17, s[28:31], s52 offen offset:1056 nt lds
    buffer_load_dwordx4 v18, s[28:31], s52 offen offset:2112 nt lds
    buffer_load_dwordx4 v19, s[28:31], s52 offen offset:3168 nt lds
    s_mov_b32 m0, 12672
    s_add_u32 s52, s52, 16384
    buffer_load_dwordx4 v16, s[28:31], s52 offen offset:0 nt lds
    buffer_load_dwordx4 v17, s[28:31], s52 offen offset:1056 nt lds
    buffer_load_dwordx4 v18, s[28:31], s52 offen offset:2112 nt lds
    buffer_load_dwordx4 v19, s[28:31], s52 offen offset:3168 nt lds
    s_waitcnt vmcnt(63)
    s_barrier
    s_mov_b32 m0, 120576
    s_add_u32 s52, s58, 256
    buffer_load_dwordx4 v8, s[24:27], s52 offen offset:0 lds
    buffer_load_dwordx4 v9, s[24:27], s52 offen offset:1088 lds
    buffer_load_dwordx4 v10, s[24:27], s52 offen offset:2176 lds
    buffer_load_dwordx4 v11, s[24:27], s52 offen offset:3264 lds
    s_mov_b32 m0, 124928
    s_add_u32 s52, s58, 33024
    buffer_load_dwordx4 v8, s[24:27], s52 offen offset:0 lds
    buffer_load_dwordx4 v9, s[24:27], s52 offen offset:1088 lds
    buffer_load_dwordx4 v10, s[24:27], s52 offen offset:2176 lds
    buffer_load_dwordx4 v11, s[24:27], s52 offen offset:3264 lds
    s_mov_b32 m0, 129280
    s_add_u32 s52, s58, 65792
    buffer_load_dwordx4 v8, s[24:27], s52 offen offset:0 lds
    buffer_load_dwordx4 v9, s[24:27], s52 offen offset:1088 lds
    buffer_load_dwordx4 v10, s[24:27], s52 offen offset:2176 lds
    buffer_load_dwordx4 v11, s[24:27], s52 offen offset:3264 lds
    s_mov_b32 m0, 133632
    s_add_u32 s52, s58, 98560
    buffer_load_dwordx4 v8, s[24:27], s52 offen offset:0 lds
    buffer_load_dwordx4 v9, s[24:27], s52 offen offset:1088 lds
    buffer_load_dwordx4 v10, s[24:27], s52 offen offset:2176 lds
    buffer_load_dwordx4 v11, s[24:27], s52 offen offset:3264 lds
    s_add_u32 s58, s58, 524288
    s_cmp_eq_u32 s58, 5242880
    s_cselect_b32 s58, 0, s58
    s_mov_b32 m0, 77056
    s_add_u32 s52, s68, 2816
    s_and_b32 s52, s52, 0xfff
    buffer_load_dwordx4 v20, s[32:35], s52 offen offset:0 nt lds
    buffer_load_dwordx4 v21, s[32:35], s52 offen offset:1088 nt lds
    buffer_load_dwordx4 v22, s[32:35], s52 offen offset:2176 nt lds
    buffer_load_dwordx4 v23, s[32:35], s52 offen offset:3264 nt lds
    s_mov_b32 m0, 81408
    s_add_u32 s52, s52, 16384
    buffer_load_dwordx4 v20, s[32:35], s52 offen offset:0 nt lds
    buffer_load_dwordx4 v21, s[32:35], s52 offen offset:1088 nt lds
    buffer_load_dwordx4 v22, s[32:35], s52 offen offset:2176 nt lds
    buffer_load_dwordx4 v23, s[32:35], s52 offen offset:3264 nt lds
    s_mov_b32 m0, 16896
    s_add_u32 s52, s68, 3584
    s_and_b32 s52, s52, 0xfff
    buffer_load_dwordx4 v16, s[28:31], s52 offen offset:0 nt lds
    buffer_load_dwordx4 v17, s[28:31], s52 offen offset:1056 nt lds
    buffer_load_dwordx4 v18, s[28:31], s52 offen offset:2112 nt lds
    buffer_load_dwordx4 v19, s[28:31], s52 offen offset:3168 nt lds
    s_mov_b32 m0, 21120
    s_add_u32 s52, s52, 16384
    buffer_load_dwordx4 v16, s[28:31], s52 offen offset:0 nt lds
    buffer_load_dwordx4 v17, s[28:31], s52 offen offset:1056 nt lds
    buffer_load_dwordx4 v18, s[28:31], s52 offen offset:2112 nt lds
    buffer_load_dwordx4 v19, s[28:31], s52 offen offset:3168 nt lds
    s_waitcnt vmcnt(63)
    s_barrier
    s_mov_b32 m0, 85760
    s_add_u32 s52, s58, 256
    buffer_load_dwordx4 v8, s[24:27], s52 offen offset:0 lds
    buffer_load_dwordx4 v9, s[24:27], s52 offen offset:1088 lds
    buffer_load_dwordx4 v10, s[24:27], s52 offen offset:2176 lds
    buffer_load_dwordx4 v11, s[24:27], s52 offen offset:3264 lds
    s_mov_b32 m0, 90112
    s_add_u32 s52, s58, 33024
    buffer_load_dwordx4 v8, s[24:27], s52 offen offset:0 lds
    buffer_load_dwordx4 v9, s[24:27], s52 offen offset:1088 lds
    buffer_load_dwordx4 v10, s[24:27], s52 offen offset:2176 lds
    buffer_load_dwordx4 v11, s[24:27], s52 offen offset:3264 lds
    s_mov_b32 m0, 94464
    s_add_u32 s52, s58, 65792
    buffer_load_dwordx4 v8, s[24:27], s52 offen offset:0 lds
    buffer_load_dwordx4 v9, s[24:27], s52 offen offset:1088 lds
    buffer_load_dwordx4 v10, s[24:27], s52 offen offset:2176 lds
    buffer_load_dwordx4 v11, s[24:27], s52 offen offset:3264 lds
    s_mov_b32 m0, 98816
    s_add_u32 s52, s58, 98560
    buffer_load_dwordx4 v8, s[24:27], s52 offen offset:0 lds
    buffer_load_dwordx4 v9, s[24:27], s52 offen offset:1088 lds
    buffer_load_dwordx4 v10, s[24:27], s52 offen offset:2176 lds
    buffer_load_dwordx4 v11, s[24:27], s52 offen offset:3264 lds
    s_add_u32 s58, s58, 524288
    s_cmp_eq_u32 s58, 5242880
    s_cselect_b32 s58, 0, s58
    s_mov_b32 m0, 42240
    s_add_u32 s52, s68, 3072
    s_and_b32 s52, s52, 0xfff
    buffer_load_dwordx4 v20, s[32:35], s52 offen offset:0 nt lds
    buffer_load_dwordx4 v21, s[32:35], s52 offen offset:1088 nt lds
    buffer_load_dwordx4 v22, s[32:35], s52 offen offset:2176 nt lds
    buffer_load_dwordx4 v23, s[32:35], s52 offen offset:3264 nt lds
    s_mov_b32 m0, 46592
    s_add_u32 s52, s52, 16384
    buffer_load_dwordx4 v20, s[32:35], s52 offen offset:0 nt lds
    buffer_load_dwordx4 v21, s[32:35], s52 offen offset:1088 nt lds
    buffer_load_dwordx4 v22, s[32:35], s52 offen offset:2176 nt lds
    buffer_load_dwordx4 v23, s[32:35], s52 offen offset:3264 nt lds
    s_mov_b32 m0, 25344
    s_add_u32 s52, s68, 3840
    s_and_b32 s52, s52, 0xfff
    buffer_load_dwordx4 v16, s[28:31], s52 offen offset:0 nt lds
    buffer_load_dwordx4 v17, s[28:31], s52 offen offset:1056 nt lds
    buffer_load_dwordx4 v18, s[28:31], s52 offen offset:2112 nt lds
    buffer_load_dwordx4 v19, s[28:31], s52 offen offset:3168 nt lds
    s_mov_b32 m0, 29568
    s_add_u32 s52, s52, 16384
    buffer_load_dwordx4 v16, s[28:31], s52 offen offset:0 nt lds
    buffer_load_dwordx4 v17, s[28:31], s52 offen offset:1056 nt lds
    buffer_load_dwordx4 v18, s[28:31], s52 offen offset:2112 nt lds
    buffer_load_dwordx4 v19, s[28:31], s52 offen offset:3168 nt lds
    s_waitcnt vmcnt(48)
    s_barrier
    s_add_u32 s52, s64, s63
    s_mul_i32 s52, s52, 40960
    s_mov_b32 m0, 153600
    s_nop 0
    buffer_load_dwordx4 v24, s[40:43], s52 offen offset:0 lds
    buffer_load_dwordx4 v25, s[40:43], s52 offen offset:1024 lds
    buffer_load_dwordx4 v26, s[40:43], s52 offen offset:2048 lds
    buffer_load_dwordx4 v27, s[40:43], s52 offen offset:3072 lds
    s_mov_b32 m0, 157696
    s_nop 0
    buffer_load_dwordx4 v28, s[40:43], s52 offen offset:0 lds
    buffer_load_dwordx4 v29, s[40:43], s52 offen offset:1024 lds
    buffer_load_dwordx4 v30, s[40:43], s52 offen offset:2048 lds
    buffer_load_dwordx4 v31, s[40:43], s52 offen offset:3072 lds
    s_mov_b32 m0, 161792
    s_nop 0
    buffer_load_dwordx4 v32, s[40:43], s52 offen offset:0 lds
    buffer_load_dwordx4 v33, s[40:43], s52 offen offset:1024 lds
    s_mov_b32 m0, 50944
    s_add_u32 s52, s68, 3328
    s_and_b32 s52, s52, 0xfff
    buffer_load_dwordx4 v20, s[32:35], s52 offen offset:0 nt lds
    buffer_load_dwordx4 v21, s[32:35], s52 offen offset:1088 nt lds
    buffer_load_dwordx4 v22, s[32:35], s52 offen offset:2176 nt lds
    buffer_load_dwordx4 v23, s[32:35], s52 offen offset:3264 nt lds
    s_mov_b32 m0, 55296
    s_add_u32 s52, s52, 16384
    buffer_load_dwordx4 v20, s[32:35], s52 offen offset:0 nt lds
    buffer_load_dwordx4 v21, s[32:35], s52 offen offset:1088 nt lds
    buffer_load_dwordx4 v22, s[32:35], s52 offen offset:2176 nt lds
    buffer_load_dwordx4 v23, s[32:35], s52 offen offset:3264 nt lds
    s_mov_b32 m0, 33792
    s_add_u32 s52, s68, 0
    s_and_b32 s52, s52, 0xfff
    s_bitset1_b32 s52, 17
    buffer_load_dwordx4 v16, s[28:31], s52 offen offset:0 nt lds
    buffer_load_dwordx4 v17, s[28:31], s52 offen offset:1056 nt lds
    buffer_load_dwordx4 v18, s[28:31], s52 offen offset:2112 nt lds
    buffer_load_dwordx4 v19, s[28:31], s52 offen offset:3168 nt lds
    s_mov_b32 m0, 38016
    s_add_u32 s52, s52, 16384
    buffer_load_dwordx4 v16, s[28:31], s52 offen offset:0 nt lds
    buffer_load_dwordx4 v17, s[28:31], s52 offen offset:1056 nt lds
    buffer_load_dwordx4 v18, s[28:31], s52 offen offset:2112 nt lds
    buffer_load_dwordx4 v19, s[28:31], s52 offen offset:3168 nt lds
    s_waitcnt vmcnt(42)
    s_barrier
    s_mov_b32 m0, 59648
    s_add_u32 s52, s68, 3584
    s_and_b32 s52, s52, 0xfff
    buffer_load_dwordx4 v20, s[32:35], s52 offen offset:0 nt lds
    buffer_load_dwordx4 v21, s[32:35], s52 offen offset:1088 nt lds
    buffer_load_dwordx4 v22, s[32:35], s52 offen offset:2176 nt lds
    buffer_load_dwordx4 v23, s[32:35], s52 offen offset:3264 nt lds
    s_mov_b32 m0, 64000
    s_add_u32 s52, s52, 16384
    buffer_load_dwordx4 v20, s[32:35], s52 offen offset:0 nt lds
    buffer_load_dwordx4 v21, s[32:35], s52 offen offset:1088 nt lds
    buffer_load_dwordx4 v22, s[32:35], s52 offen offset:2176 nt lds
    buffer_load_dwordx4 v23, s[32:35], s52 offen offset:3264 nt lds
    s_mov_b32 m0, 0
    s_add_u32 s52, s68, 256
    s_and_b32 s52, s52, 0xfff
    s_bitset1_b32 s52, 17
    buffer_load_dwordx4 v16, s[28:31], s52 offen offset:0 nt lds
    buffer_load_dwordx4 v17, s[28:31], s52 offen offset:1056 nt lds
    buffer_load_dwordx4 v18, s[28:31], s52 offen offset:2112 nt lds
    buffer_load_dwordx4 v19, s[28:31], s52 offen offset:3168 nt lds
    s_mov_b32 m0, 4224
    s_add_u32 s52, s52, 16384
    buffer_load_dwordx4 v16, s[28:31], s52 offen offset:0 nt lds
    buffer_load_dwordx4 v17, s[28:31], s52 offen offset:1056 nt lds
    buffer_load_dwordx4 v18, s[28:31], s52 offen offset:2112 nt lds
    buffer_load_dwordx4 v19, s[28:31], s52 offen offset:3168 nt lds
    s_barrier
    s_add_u32 s52, s64, s61
    s_mul_i32 s52, s52, 40960
    s_mov_b32 m0, 120832
    s_nop 0
    buffer_load_dwordx4 v24, s[40:43], s52 offen offset:0 lds
    buffer_load_dwordx4 v25, s[40:43], s52 offen offset:1024 lds
    buffer_load_dwordx4 v26, s[40:43], s52 offen offset:2048 lds
    buffer_load_dwordx4 v27, s[40:43], s52 offen offset:3072 lds
    s_mov_b32 m0, 124928
    s_nop 0
    buffer_load_dwordx4 v28, s[40:43], s52 offen offset:0 lds
    buffer_load_dwordx4 v29, s[40:43], s52 offen offset:1024 lds
    buffer_load_dwordx4 v30, s[40:43], s52 offen offset:2048 lds
    buffer_load_dwordx4 v31, s[40:43], s52 offen offset:3072 lds
    s_mov_b32 m0, 129024
    s_nop 0
    buffer_load_dwordx4 v32, s[40:43], s52 offen offset:0 lds
    buffer_load_dwordx4 v33, s[40:43], s52 offen offset:1024 lds
    s_mov_b32 m0, 68352
    s_add_u32 s52, s68, 3840
    s_and_b32 s52, s52, 0xfff
    buffer_load_dwordx4 v20, s[32:35], s52 offen offset:0 nt lds
    buffer_load_dwordx4 v21, s[32:35], s52 offen offset:1088 nt lds
    buffer_load_dwordx4 v22, s[32:35], s52 offen offset:2176 nt lds
    buffer_load_dwordx4 v23, s[32:35], s52 offen offset:3264 nt lds
    s_mov_b32 m0, 72704
    s_add_u32 s52, s52, 16384
    buffer_load_dwordx4 v20, s[32:35], s52 offen offset:0 nt lds
    buffer_load_dwordx4 v21, s[32:35], s52 offen offset:1088 nt lds
    buffer_load_dwordx4 v22, s[32:35], s52 offen offset:2176 nt lds
    buffer_load_dwordx4 v23, s[32:35], s52 offen offset:3264 nt lds
    s_mov_b32 m0, 8448
    s_add_u32 s52, s68, 512
    s_and_b32 s52, s52, 0xfff
    s_bitset1_b32 s52, 17
    buffer_load_dwordx4 v16, s[28:31], s52 offen offset:0 nt lds
    buffer_load_dwordx4 v17, s[28:31], s52 offen offset:1056 nt lds
    buffer_load_dwordx4 v18, s[28:31], s52 offen offset:2112 nt lds
    buffer_load_dwordx4 v19, s[28:31], s52 offen offset:3168 nt lds
    s_mov_b32 m0, 12672
    s_add_u32 s52, s52, 16384
    buffer_load_dwordx4 v16, s[28:31], s52 offen offset:0 nt lds
    buffer_load_dwordx4 v17, s[28:31], s52 offen offset:1056 nt lds
    buffer_load_dwordx4 v18, s[28:31], s52 offen offset:2112 nt lds
    buffer_load_dwordx4 v19, s[28:31], s52 offen offset:3168 nt lds
    s_waitcnt vmcnt(63)
    s_barrier
    s_add_u32 s52, s64, s60
    s_mul_i32 s52, s52, 40960
    s_mov_b32 m0, 98304
    s_nop 0
    buffer_load_dwordx4 v24, s[40:43], s52 offen offset:0 lds
    buffer_load_dwordx4 v25, s[40:43], s52 offen offset:1024 lds
    buffer_load_dwordx4 v26, s[40:43], s52 offen offset:2048 lds
    buffer_load_dwordx4 v27, s[40:43], s52 offen offset:3072 lds
    s_mov_b32 m0, 102400
    s_nop 0
    buffer_load_dwordx4 v28, s[40:43], s52 offen offset:0 lds
    buffer_load_dwordx4 v29, s[40:43], s52 offen offset:1024 lds
    buffer_load_dwordx4 v30, s[40:43], s52 offen offset:2048 lds
    buffer_load_dwordx4 v31, s[40:43], s52 offen offset:3072 lds
    s_mov_b32 m0, 106496
    s_nop 0
    buffer_load_dwordx4 v32, s[40:43], s52 offen offset:0 lds
    buffer_load_dwordx4 v33, s[40:43], s52 offen offset:1024 lds
    s_mov_b32 m0, 77056
    s_add_u32 s52, s68, 0
    s_and_b32 s52, s52, 0xfff
    s_bitset1_b32 s52, 17
    buffer_load_dwordx4 v20, s[32:35], s52 offen offset:0 nt lds
    buffer_load_dwordx4 v21, s[32:35], s52 offen offset:1088 nt lds
    buffer_load_dwordx4 v22, s[32:35], s52 offen offset:2176 nt lds
    buffer_load_dwordx4 v23, s[32:35], s52 offen offset:3264 nt lds
    s_mov_b32 m0, 81408
    s_add_u32 s52, s52, 16384
    buffer_load_dwordx4 v20, s[32:35], s52 offen offset:0 nt lds
    buffer_load_dwordx4 v21, s[32:35], s52 offen offset:1088 nt lds
    buffer_load_dwordx4 v22, s[32:35], s52 offen offset:2176 nt lds
    buffer_load_dwordx4 v23, s[32:35], s52 offen offset:3264 nt lds
    s_mov_b32 m0, 16896
    s_add_u32 s52, s68, 768
    s_and_b32 s52, s52, 0xfff
    s_bitset1_b32 s52, 17
    buffer_load_dwordx4 v16, s[28:31], s52 offen offset:0 nt lds
    buffer_load_dwordx4 v17, s[28:31], s52 offen offset:1056 nt lds
    buffer_load_dwordx4 v18, s[28:31], s52 offen offset:2112 nt lds
    buffer_load_dwordx4 v19, s[28:31], s52 offen offset:3168 nt lds
    s_mov_b32 m0, 21120
    s_add_u32 s52, s52, 16384
    buffer_load_dwordx4 v16, s[28:31], s52 offen offset:0 nt lds
    buffer_load_dwordx4 v17, s[28:31], s52 offen offset:1056 nt lds
    buffer_load_dwordx4 v18, s[28:31], s52 offen offset:2112 nt lds
    buffer_load_dwordx4 v19, s[28:31], s52 offen offset:3168 nt lds
    s_waitcnt vmcnt(63)
    s_barrier
    s_add_u32 s52, s64, s62
    s_mul_i32 s52, s52, 40960
    s_mov_b32 m0, 131072
    s_nop 0
    buffer_load_dwordx4 v24, s[40:43], s52 offen offset:0 lds
    buffer_load_dwordx4 v25, s[40:43], s52 offen offset:1024 lds
    buffer_load_dwordx4 v26, s[40:43], s52 offen offset:2048 lds
    buffer_load_dwordx4 v27, s[40:43], s52 offen offset:3072 lds
    s_mov_b32 m0, 135168
    s_nop 0
    buffer_load_dwordx4 v28, s[40:43], s52 offen offset:0 lds
    buffer_load_dwordx4 v29, s[40:43], s52 offen offset:1024 lds
    buffer_load_dwordx4 v30, s[40:43], s52 offen offset:2048 lds
    buffer_load_dwordx4 v31, s[40:43], s52 offen offset:3072 lds
    s_mov_b32 m0, 139264
    s_nop 0
    buffer_load_dwordx4 v32, s[40:43], s52 offen offset:0 lds
    buffer_load_dwordx4 v33, s[40:43], s52 offen offset:1024 lds
    s_mov_b32 m0, 42240
    s_add_u32 s52, s68, 256
    s_and_b32 s52, s52, 0xfff
    s_bitset1_b32 s52, 17
    buffer_load_dwordx4 v20, s[32:35], s52 offen offset:0 nt lds
    buffer_load_dwordx4 v21, s[32:35], s52 offen offset:1088 nt lds
    buffer_load_dwordx4 v22, s[32:35], s52 offen offset:2176 nt lds
    buffer_load_dwordx4 v23, s[32:35], s52 offen offset:3264 nt lds
    s_mov_b32 m0, 46592
    s_add_u32 s52, s52, 16384
    buffer_load_dwordx4 v20, s[32:35], s52 offen offset:0 nt lds
    buffer_load_dwordx4 v21, s[32:35], s52 offen offset:1088 nt lds
    buffer_load_dwordx4 v22, s[32:35], s52 offen offset:2176 nt lds
    buffer_load_dwordx4 v23, s[32:35], s52 offen offset:3264 nt lds
    s_mov_b32 m0, 25344
    s_add_u32 s52, s68, 1024
    s_and_b32 s52, s52, 0xfff
    s_bitset1_b32 s52, 17
    buffer_load_dwordx4 v16, s[28:31], s52 offen offset:0 nt lds
    buffer_load_dwordx4 v17, s[28:31], s52 offen offset:1056 nt lds
    buffer_load_dwordx4 v18, s[28:31], s52 offen offset:2112 nt lds
    buffer_load_dwordx4 v19, s[28:31], s52 offen offset:3168 nt lds
    s_mov_b32 m0, 29568
    s_add_u32 s52, s52, 16384
    buffer_load_dwordx4 v16, s[28:31], s52 offen offset:0 nt lds
    buffer_load_dwordx4 v17, s[28:31], s52 offen offset:1056 nt lds
    buffer_load_dwordx4 v18, s[28:31], s52 offen offset:2112 nt lds
    buffer_load_dwordx4 v19, s[28:31], s52 offen offset:3168 nt lds
    s_waitcnt vmcnt(63)
    s_barrier
    s_add_u32 s52, s66, s61
    s_mul_i32 s52, s52, 40960
    s_mov_b32 m0, 88064
    s_nop 0
    buffer_load_dwordx4 v24, s[40:43], s52 offen offset:0 lds
    buffer_load_dwordx4 v25, s[40:43], s52 offen offset:1024 lds
    buffer_load_dwordx4 v26, s[40:43], s52 offen offset:2048 lds
    buffer_load_dwordx4 v27, s[40:43], s52 offen offset:3072 lds
    s_mov_b32 m0, 92160
    s_nop 0
    buffer_load_dwordx4 v28, s[40:43], s52 offen offset:0 lds
    buffer_load_dwordx4 v29, s[40:43], s52 offen offset:1024 lds
    buffer_load_dwordx4 v30, s[40:43], s52 offen offset:2048 lds
    buffer_load_dwordx4 v31, s[40:43], s52 offen offset:3072 lds
    s_mov_b32 m0, 96256
    s_nop 0
    buffer_load_dwordx4 v32, s[40:43], s52 offen offset:0 lds
    buffer_load_dwordx4 v33, s[40:43], s52 offen offset:1024 lds
    s_mov_b32 m0, 50944
    s_add_u32 s52, s68, 512
    s_and_b32 s52, s52, 0xfff
    s_bitset1_b32 s52, 17
    buffer_load_dwordx4 v20, s[32:35], s52 offen offset:0 nt lds
    buffer_load_dwordx4 v21, s[32:35], s52 offen offset:1088 nt lds
    buffer_load_dwordx4 v22, s[32:35], s52 offen offset:2176 nt lds
    buffer_load_dwordx4 v23, s[32:35], s52 offen offset:3264 nt lds
    s_mov_b32 m0, 55296
    s_add_u32 s52, s52, 16384
    buffer_load_dwordx4 v20, s[32:35], s52 offen offset:0 nt lds
    s_branch SK2
PAD2:
    s_branch BK2
SK2:
    buffer_load_dwordx4 v21, s[32:35], s52 offen offset:1088 nt lds
    buffer_load_dwordx4 v22, s[32:35], s52 offen offset:2176 nt lds
    buffer_load_dwordx4 v23, s[32:35], s52 offen offset:3264 nt lds
    s_mov_b32 m0, 33792
    s_add_u32 s52, s68, 1280
    s_and_b32 s52, s52, 0xfff
    s_bitset1_b32 s52, 17
    buffer_load_dwordx4 v16, s[28:31], s52 offen offset:0 nt lds
    buffer_load_dwordx4 v17, s[28:31], s52 offen offset:1056 nt lds
    buffer_load_dwordx4 v18, s[28:31], s52 offen offset:2112 nt lds
    buffer_load_dwordx4 v19, s[28:31], s52 offen offset:3168 nt lds
    s_mov_b32 m0, 38016
    s_add_u32 s52, s52, 16384
    buffer_load_dwordx4 v16, s[28:31], s52 offen offset:0 nt lds
    buffer_load_dwordx4 v17, s[28:31], s52 offen offset:1056 nt lds
    buffer_load_dwordx4 v18, s[28:31], s52 offen offset:2112 nt lds
    buffer_load_dwordx4 v19, s[28:31], s52 offen offset:3168 nt lds
    s_waitcnt vmcnt(63)
    s_barrier
    s_mov_b32 m0, 59648
    s_add_u32 s52, s68, 768
    s_and_b32 s52, s52, 0xfff
    s_bitset1_b32 s52, 17
    buffer_load_dwordx4 v20, s[32:35], s52 offen offset:0 nt lds
    buffer_load_dwordx4 v21, s[32:35], s52 offen offset:1088 nt lds
    buffer_load_dwordx4 v22, s[32:35], s52 offen offset:2176 nt lds
    buffer_load_dwordx4 v23, s[32:35], s52 offen offset:3264 nt lds
    s_mov_b32 m0, 64000
    s_add_u32 s52, s52, 16384
    buffer_load_dwordx4 v20, s[32:35], s52 offen offset:0 nt lds
    buffer_load_dwordx4 v21, s[32:35], s52 offen offset:1088 nt lds
    buffer_load_dwordx4 v22, s[32:35], s52 offen offset:2176 nt lds
    buffer_load_dwordx4 v23, s[32:35], s52 offen offset:3264 nt lds
    s_mov_b32 m0, 0
    s_add_u32 s52, s68, 1536
    s_and_b32 s52, s52, 0xfff
    s_bitset1_b32 s52, 17
    buffer_load_dwordx4 v16, s[28:31], s52 offen offset:0 nt lds
    buffer_load_dwordx4 v17, s[28:31], s52 offen offset:1056 nt lds
    buffer_load_dwordx4 v18, s[28:31], s52 offen offset:2112 nt lds
    buffer_load_dwordx4 v19, s[28:31], s52 offen offset:3168 nt lds
    s_mov_b32 m0, 4224
    s_add_u32 s52, s52, 16384
    buffer_load_dwordx4 v16, s[28:31], s52 offen offset:0 nt lds
    buffer_load_dwordx4 v17, s[28:31], s52 offen offset:1056 nt lds
    buffer_load_dwordx4 v18, s[28:31], s52 offen offset:2112 nt lds
    buffer_load_dwordx4 v19, s[28:31], s52 offen offset:3168 nt lds
    s_waitcnt vmcnt(63)
    s_barrier
    s_mov_b32 m0, 68352
    s_add_u32 s52, s68, 1024
    s_and_b32 s52, s52, 0xfff
    s_bitset1_b32 s52, 17
    buffer_load_dwordx4 v20, s[32:35], s52 offen offset:0 nt lds
    buffer_load_dwordx4 v21, s[32:35], s52 offen offset:1088 nt lds
    buffer_load_dwordx4 v22, s[32:35], s52 offen offset:2176 nt lds
    buffer_load_dwordx4 v23, s[32:35], s52 offen offset:3264 nt lds
    s_mov_b32 m0, 72704
    s_add_u32 s52, s52, 16384
    buffer_load_dwordx4 v20, s[32:35], s52 offen offset:0 nt lds
    buffer_load_dwordx4 v21, s[32:35], s52 offen offset:1088 nt lds
    buffer_load_dwordx4 v22, s[32:35], s52 offen offset:2176 nt lds
    buffer_load_dwordx4 v23, s[32:35], s52 offen offset:3264 nt lds
    s_mov_b32 m0, 8448
    s_add_u32 s52, s68, 1792
    s_and_b32 s52, s52, 0xfff
    s_bitset1_b32 s52, 17
    buffer_load_dwordx4 v16, s[28:31], s52 offen offset:0 nt lds
    buffer_load_dwordx4 v17, s[28:31], s52 offen offset:1056 nt lds
    buffer_load_dwordx4 v18, s[28:31], s52 offen offset:2112 nt lds
    buffer_load_dwordx4 v19, s[28:31], s52 offen offset:3168 nt lds
    s_mov_b32 m0, 12672
    s_add_u32 s52, s52, 16384
    buffer_load_dwordx4 v16, s[28:31], s52 offen offset:0 nt lds
    buffer_load_dwordx4 v17, s[28:31], s52 offen offset:1056 nt lds
    buffer_load_dwordx4 v18, s[28:31], s52 offen offset:2112 nt lds
    buffer_load_dwordx4 v19, s[28:31], s52 offen offset:3168 nt lds
    s_waitcnt vmcnt(58)
    s_barrier
    s_mov_b32 m0, 77056
    s_add_u32 s52, s68, 1280
    s_and_b32 s52, s52, 0xfff
    s_bitset1_b32 s52, 17
    buffer_load_dwordx4 v20, s[32:35], s52 offen offset:0 nt lds
    buffer_load_dwordx4 v21, s[32:35], s52 offen offset:1088 nt lds
    buffer_load_dwordx4 v22, s[32:35], s52 offen offset:2176 nt lds
    buffer_load_dwordx4 v23, s[32:35], s52 offen offset:3264 nt lds
    s_mov_b32 m0, 81408
    s_add_u32 s52, s52, 16384
    buffer_load_dwordx4 v20, s[32:35], s52 offen offset:0 nt lds
    buffer_load_dwordx4 v21, s[32:35], s52 offen offset:1088 nt lds
    buffer_load_dwordx4 v22, s[32:35], s52 offen offset:2176 nt lds
    buffer_load_dwordx4 v23, s[32:35], s52 offen offset:3264 nt lds
    s_mov_b32 m0, 16896
    s_add_u32 s52, s68, 2048
    s_and_b32 s52, s52, 0xfff
    s_bitset1_b32 s52, 17
    buffer_load_dwordx4 v16, s[28:31], s52 offen offset:0 nt lds
    buffer_load_dwordx4 v17, s[28:31], s52 offen offset:1056 nt lds
    buffer_load_dwordx4 v18, s[28:31], s52 offen offset:2112 nt lds
    buffer_load_dwordx4 v19, s[28:31], s52 offen offset:3168 nt lds
    s_mov_b32 m0, 21120
    s_add_u32 s52, s52, 16384
    buffer_load_dwordx4 v16, s[28:31], s52 offen offset:0 nt lds
    buffer_load_dwordx4 v17, s[28:31], s52 offen offset:1056 nt lds
    buffer_load_dwordx4 v18, s[28:31], s52 offen offset:2112 nt lds
    buffer_load_dwordx4 v19, s[28:31], s52 offen offset:3168 nt lds
    s_waitcnt vmcnt(48)
    s_barrier
    s_mov_b32 m0, 42240
    s_add_u32 s52, s68, 1536
    s_and_b32 s52, s52, 0xfff
    s_bitset1_b32 s52, 17
    buffer_load_dwordx4 v20, s[32:35], s52 offen offset:0 nt lds
    buffer_load_dwordx4 v21, s[32:35], s52 offen offset:1088 nt lds
    buffer_load_dwordx4 v22, s[32:35], s52 offen offset:2176 nt lds
    buffer_load_dwordx4 v23, s[32:35], s52 offen offset:3264 nt lds
    s_mov_b32 m0, 46592
    s_add_u32 s52, s52, 16384
    buffer_load_dwordx4 v20, s[32:35], s52 offen offset:0 nt lds
    buffer_load_dwordx4 v21, s[32:35], s52 offen offset:1088 nt lds
    buffer_load_dwordx4 v22, s[32:35], s52 offen offset:2176 nt lds
    buffer_load_dwordx4 v23, s[32:35], s52 offen offset:3264 nt lds
    s_mov_b32 m0, 25344
    s_add_u32 s52, s68, 2304
    s_and_b32 s52, s52, 0xfff
    s_bitset1_b32 s52, 17
    buffer_load_dwordx4 v16, s[28:31], s52 offen offset:0 nt lds
    buffer_load_dwordx4 v17, s[28:31], s52 offen offset:1056 nt lds
    buffer_load_dwordx4 v18, s[28:31], s52 offen offset:2112 nt lds
    buffer_load_dwordx4 v19, s[28:31], s52 offen offset:3168 nt lds
    s_mov_b32 m0, 29568
    s_add_u32 s52, s52, 16384
    buffer_load_dwordx4 v16, s[28:31], s52 offen offset:0 nt lds
    buffer_load_dwordx4 v17, s[28:31], s52 offen offset:1056 nt lds
    buffer_load_dwordx4 v18, s[28:31], s52 offen offset:2112 nt lds
    buffer_load_dwordx4 v19, s[28:31], s52 offen offset:3168 nt lds
    s_waitcnt vmcnt(48)
    s_barrier
    s_mov_b32 m0, 50944
    s_add_u32 s52, s68, 1792
    s_and_b32 s52, s52, 0xfff
    s_bitset1_b32 s52, 17
    buffer_load_dwordx4 v20, s[32:35], s52 offen offset:0 nt lds
    buffer_load_dwordx4 v21, s[32:35], s52 offen offset:1088 nt lds
    buffer_load_dwordx4 v22, s[32:35], s52 offen offset:2176 nt lds
    buffer_load_dwordx4 v23, s[32:35], s52 offen offset:3264 nt lds
    s_mov_b32 m0, 55296
    s_add_u32 s52, s52, 16384
    buffer_load_dwordx4 v20, s[32:35], s52 offen offset:0 nt lds
    buffer_load_dwordx4 v21, s[32:35], s52 offen offset:1088 nt lds
    buffer_load_dwordx4 v22, s[32:35], s52 offen offset:2176 nt lds
    buffer_load_dwordx4 v23, s[32:35], s52 offen offset:3264 nt lds
    s_mov_b32 m0, 33792
    s_add_u32 s52, s68, 2560
    s_and_b32 s52, s52, 0xfff
    s_bitset1_b32 s52, 17
    buffer_load_dwordx4 v16, s[28:31], s52 offen offset:0 nt lds
    buffer_load_dwordx4 v17, s[28:31], s52 offen offset:1056 nt lds
    buffer_load_dwordx4 v18, s[28:31], s52 offen offset:2112 nt lds
    buffer_load_dwordx4 v19, s[28:31], s52 offen offset:3168 nt lds
    s_mov_b32 m0, 38016
    s_add_u32 s52, s52, 16384
    buffer_load_dwordx4 v16, s[28:31], s52 offen offset:0 nt lds
    buffer_load_dwordx4 v17, s[28:31], s52 offen offset:1056 nt lds
    buffer_load_dwordx4 v18, s[28:31], s52 offen offset:2112 nt lds
    buffer_load_dwordx4 v19, s[28:31], s52 offen offset:3168 nt lds
    s_waitcnt vmcnt(48)
    s_barrier
    s_mov_b32 m0, 59648
    s_add_u32 s52, s68, 2048
    s_and_b32 s52, s52, 0xfff
    s_bitset1_b32 s52, 17
    buffer_load_dwordx4 v20, s[32:35], s52 offen offset:0 nt lds
    buffer_load_dwordx4 v21, s[32:35], s52 offen offset:1088 nt lds
    buffer_load_dwordx4 v22, s[32:35], s52 offen offset:2176 nt lds
    buffer_load_dwordx4 v23, s[32:35], s52 offen offset:3264 nt lds
    s_mov_b32 m0, 64000
    s_add_u32 s52, s52, 16384
    buffer_load_dwordx4 v20, s[32:35], s52 offen offset:0 nt lds
    buffer_load_dwordx4 v21, s[32:35], s52 offen offset:1088 nt lds
    buffer_load_dwordx4 v22, s[32:35], s52 offen offset:2176 nt lds
    buffer_load_dwordx4 v23, s[32:35], s52 offen offset:3264 nt lds
    s_mov_b32 m0, 0
    s_add_u32 s52, s68, 2816
    s_and_b32 s52, s52, 0xfff
    s_bitset1_b32 s52, 17
    buffer_load_dwordx4 v16, s[28:31], s52 offen offset:0 nt lds
    buffer_load_dwordx4 v17, s[28:31], s52 offen offset:1056 nt lds
    buffer_load_dwordx4 v18, s[28:31], s52 offen offset:2112 nt lds
    buffer_load_dwordx4 v19, s[28:31], s52 offen offset:3168 nt lds
    s_mov_b32 m0, 4224
    s_add_u32 s52, s52, 16384
    buffer_load_dwordx4 v16, s[28:31], s52 offen offset:0 nt lds
    buffer_load_dwordx4 v17, s[28:31], s52 offen offset:1056 nt lds
    buffer_load_dwordx4 v18, s[28:31], s52 offen offset:2112 nt lds
    buffer_load_dwordx4 v19, s[28:31], s52 offen offset:3168 nt lds
    s_waitcnt vmcnt(48)
    s_barrier
    s_mov_b32 m0, 68352
    s_add_u32 s52, s68, 2304
    s_and_b32 s52, s52, 0xfff
    s_bitset1_b32 s52, 17
    buffer_load_dwordx4 v20, s[32:35], s52 offen offset:0 nt lds
    buffer_load_dwordx4 v21, s[32:35], s52 offen offset:1088 nt lds
    buffer_load_dwordx4 v22, s[32:35], s52 offen offset:2176 nt lds
    buffer_load_dwordx4 v23, s[32:35], s52 offen offset:3264 nt lds
    s_mov_b32 m0, 72704
    s_add_u32 s52, s52, 16384
    buffer_load_dwordx4 v20, s[32:35], s52 offen offset:0 nt lds
    buffer_load_dwordx4 v21, s[32:35], s52 offen offset:1088 nt lds
    buffer_load_dwordx4 v22, s[32:35], s52 offen offset:2176 nt lds
    buffer_load_dwordx4 v23, s[32:35], s52 offen offset:3264 nt lds
    s_mov_b32 m0, 8448
    s_add_u32 s52, s68, 3072
    s_and_b32 s52, s52, 0xfff
    s_bitset1_b32 s52, 17
    buffer_load_dwordx4 v16, s[28:31], s52 offen offset:0 nt lds
    buffer_load_dwordx4 v17, s[28:31], s52 offen offset:1056 nt lds
    buffer_load_dwordx4 v18, s[28:31], s52 offen offset:2112 nt lds
    buffer_load_dwordx4 v19, s[28:31], s52 offen offset:3168 nt lds
    s_mov_b32 m0, 12672
    s_add_u32 s52, s52, 16384
    buffer_load_dwordx4 v16, s[28:31], s52 offen offset:0 nt lds
    buffer_load_dwordx4 v17, s[28:31], s52 offen offset:1056 nt lds
    buffer_load_dwordx4 v18, s[28:31], s52 offen offset:2112 nt lds
    buffer_load_dwordx4 v19, s[28:31], s52 offen offset:3168 nt lds
    s_waitcnt vmcnt(48)
    s_barrier
    s_mov_b32 m0, 77056
    s_add_u32 s52, s68, 2560
    s_and_b32 s52, s52, 0xfff
    s_bitset1_b32 s52, 17
    buffer_load_dwordx4 v20, s[32:35], s52 offen offset:0 nt lds
    buffer_load_dwordx4 v21, s[32:35], s52 offen offset:1088 nt lds
    buffer_load_dwordx4 v22, s[32:35], s52 offen offset:2176 nt lds
    buffer_load_dwordx4 v23, s[32:35], s52 offen offset:3264 nt lds
    s_mov_b32 m0, 81408
    s_add_u32 s52, s52, 16384
    buffer_load_dwordx4 v20, s[32:35], s52 offen offset:0 nt lds
    buffer_load_dwordx4 v21, s[32:35], s52 offen offset:1088 nt lds
    buffer_load_dwordx4 v22, s[32:35], s52 offen offset:2176 nt lds
    buffer_load_dwordx4 v23, s[32:35], s52 offen offset:3264 nt lds
    s_mov_b32 m0, 16896
    s_add_u32 s52, s68, 3328
    s_and_b32 s52, s52, 0xfff
    s_bitset1_b32 s52, 17
    buffer_load_dwordx4 v16, s[28:31], s52 offen offset:0 nt lds
    buffer_load_dwordx4 v17, s[28:31], s52 offen offset:1056 nt lds
    buffer_load_dwordx4 v18, s[28:31], s52 offen offset:2112 nt lds
    buffer_load_dwordx4 v19, s[28:31], s52 offen offset:3168 nt lds
    s_mov_b32 m0, 21120
    s_add_u32 s52, s52, 16384
    buffer_load_dwordx4 v16, s[28:31], s52 offen offset:0 nt lds
    buffer_load_dwordx4 v17, s[28:31], s52 offen offset:1056 nt lds
    buffer_load_dwordx4 v18, s[28:31], s52 offen offset:2112 nt lds
    buffer_load_dwordx4 v19, s[28:31], s52 offen offset:3168 nt lds
    s_waitcnt vmcnt(48)
    s_barrier
    s_mov_b32 m0, 42240
    s_add_u32 s52, s68, 2816
    s_and_b32 s52, s52, 0xfff
    s_bitset1_b32 s52, 17
    buffer_load_dwordx4 v20, s[32:35], s52 offen offset:0 nt lds
    buffer_load_dwordx4 v21, s[32:35], s52 offen offset:1088 nt lds
    buffer_load_dwordx4 v22, s[32:35], s52 offen offset:2176 nt lds
    buffer_load_dwordx4 v23, s[32:35], s52 offen offset:3264 nt lds
    s_mov_b32 m0, 46592
    s_add_u32 s52, s52, 16384
    buffer_load_dwordx4 v20, s[32:35], s52 offen offset:0 nt lds
    buffer_load_dwordx4 v21, s[32:35], s52 offen offset:1088 nt lds
    buffer_load_dwordx4 v22, s[32:35], s52 offen offset:2176 nt lds
    buffer_load_dwordx4 v23, s[32:35], s52 offen offset:3264 nt lds
    s_mov_b32 m0, 25344
    s_add_u32 s52, s68, 3584
    s_and_b32 s52, s52, 0xfff
    s_bitset1_b32 s52, 17
    buffer_load_dwordx4 v16, s[28:31], s52 offen offset:0 nt lds
    buffer_load_dwordx4 v17, s[28:31], s52 offen offset:1056 nt lds
    buffer_load_dwordx4 v18, s[28:31], s52 offen offset:2112 nt lds
    buffer_load_dwordx4 v19, s[28:31], s52 offen offset:3168 nt lds
    s_mov_b32 m0, 29568
    s_add_u32 s52, s52, 16384
    buffer_load_dwordx4 v16, s[28:31], s52 offen offset:0 nt lds
    buffer_load_dwordx4 v17, s[28:31], s52 offen offset:1056 nt lds
    buffer_load_dwordx4 v18, s[28:31], s52 offen offset:2112 nt lds
    buffer_load_dwordx4 v19, s[28:31], s52 offen offset:3168 nt lds
    s_waitcnt vmcnt(48)
    s_barrier
    s_mov_b32 m0, 50944
    s_add_u32 s52, s68, 3072
    s_and_b32 s52, s52, 0xfff
    s_bitset1_b32 s52, 17
    buffer_load_dwordx4 v20, s[32:35], s52 offen offset:0 nt lds
    buffer_load_dwordx4 v21, s[32:35], s52 offen offset:1088 nt lds
    buffer_load_dwordx4 v22, s[32:35], s52 offen offset:2176 nt lds
    buffer_load_dwordx4 v23, s[32:35], s52 offen offset:3264 nt lds
    s_mov_b32 m0, 55296
    s_add_u32 s52, s52, 16384
    buffer_load_dwordx4 v20, s[32:35], s52 offen offset:0 nt lds
    buffer_load_dwordx4 v21, s[32:35], s52 offen offset:1088 nt lds
    buffer_load_dwordx4 v22, s[32:35], s52 offen offset:2176 nt lds
    buffer_load_dwordx4 v23, s[32:35], s52 offen offset:3264 nt lds
    s_mov_b32 m0, 33792
    s_add_u32 s52, s68, 3840
    s_and_b32 s52, s52, 0xfff
    s_bitset1_b32 s52, 17
    buffer_load_dwordx4 v16, s[28:31], s52 offen offset:0 nt lds
    buffer_load_dwordx4 v17, s[28:31], s52 offen offset:1056 nt lds
    buffer_load_dwordx4 v18, s[28:31], s52 offen offset:2112 nt lds
    buffer_load_dwordx4 v19, s[28:31], s52 offen offset:3168 nt lds
    s_mov_b32 m0, 38016
    s_add_u32 s52, s52, 16384
    buffer_load_dwordx4 v16, s[28:31], s52 offen offset:0 nt lds
    buffer_load_dwordx4 v17, s[28:31], s52 offen offset:1056 nt lds
    buffer_load_dwordx4 v18, s[28:31], s52 offen offset:2112 nt lds
    buffer_load_dwordx4 v19, s[28:31], s52 offen offset:3168 nt lds
    s_waitcnt vmcnt(48)
    s_barrier
    s_mov_b32 m0, 59648
    s_add_u32 s52, s68, 3328
    s_and_b32 s52, s52, 0xfff
    s_bitset1_b32 s52, 17
    buffer_load_dwordx4 v20, s[32:35], s52 offen offset:0 nt lds
    buffer_load_dwordx4 v21, s[32:35], s52 offen offset:1088 nt lds
    buffer_load_dwordx4 v22, s[32:35], s52 offen offset:2176 nt lds
    buffer_load_dwordx4 v23, s[32:35], s52 offen offset:3264 nt lds
    s_mov_b32 m0, 64000
    s_add_u32 s52, s52, 16384
    buffer_load_dwordx4 v20, s[32:35], s52 offen offset:0 nt lds
    buffer_load_dwordx4 v21, s[32:35], s52 offen offset:1088 nt lds
    buffer_load_dwordx4 v22, s[32:35], s52 offen offset:2176 nt lds
    buffer_load_dwordx4 v23, s[32:35], s52 offen offset:3264 nt lds
    s_add_u32 s52, s64, s60
    s_add_u32 s52, s52, 4
    s_mul_i32 s52, s52, 40960
    s_mov_b32 m0, 98304
    s_nop 0
    buffer_load_dwordx4 v24, s[40:43], s52 offen offset:0 lds
    buffer_load_dwordx4 v25, s[40:43], s52 offen offset:1024 lds
    buffer_load_dwordx4 v26, s[40:43], s52 offen offset:2048 lds
    buffer_load_dwordx4 v27, s[40:43], s52 offen offset:3072 lds
    s_mov_b32 m0, 102400
    s_nop 0
    buffer_load_dwordx4 v28, s[40:43], s52 offen offset:0 lds
    buffer_load_dwordx4 v29, s[40:43], s52 offen offset:1024 lds
    buffer_load_dwordx4 v30, s[40:43], s52 offen offset:2048 lds
    buffer_load_dwordx4 v31, s[40:43], s52 offen offset:3072 lds
    s_mov_b32 m0, 106496
    s_nop 0
    buffer_load_dwordx4 v32, s[40:43], s52 offen offset:0 lds
    buffer_load_dwordx4 v33, s[40:43], s52 offen offset:1024 lds
    s_waitcnt vmcnt(50)
    s_barrier
    s_mov_b32 m0, 68352
    s_add_u32 s52, s68, 3584
    s_and_b32 s52, s52, 0xfff
    s_bitset1_b32 s52, 17
    buffer_load_dwordx4 v20, s[32:35], s52 offen offset:0 nt lds
    buffer_load_dwordx4 v21, s[32:35], s52 offen offset:1088 nt lds
    buffer_load_dwordx4 v22, s[32:35], s52 offen offset:2176 nt lds
    buffer_load_dwordx4 v23, s[32:35], s52 offen offset:3264 nt lds
    s_mov_b32 m0, 72704
    s_add_u32 s52, s52, 16384
    buffer_load_dwordx4 v20, s[32:35], s52 offen offset:0 nt lds
    buffer_load_dwordx4 v21, s[32:35], s52 offen offset:1088 nt lds
    buffer_load_dwordx4 v22, s[32:35], s52 offen offset:2176 nt lds
    buffer_load_dwordx4 v23, s[32:35], s52 offen offset:3264 nt lds
    s_add_u32 s52, s64, s61
    s_add_u32 s52, s52, 4
    s_mul_i32 s52, s52, 40960
    s_mov_b32 m0, 120832
    s_nop 0
    buffer_load_dwordx4 v24, s[40:43], s52 offen offset:0 lds
    buffer_load_dwordx4 v25, s[40:43], s52 offen offset:1024 lds
    buffer_load_dwordx4 v26, s[40:43], s52 offen offset:2048 lds
    buffer_load_dwordx4 v27, s[40:43], s52 offen offset:3072 lds
    s_mov_b32 m0, 124928
    s_nop 0
    buffer_load_dwordx4 v28, s[40:43], s52 offen offset:0 lds
    buffer_load_dwordx4 v29, s[40:43], s52 offen offset:1024 lds
    buffer_load_dwordx4 v30, s[40:43], s52 offen offset:2048 lds
    buffer_load_dwordx4 v31, s[40:43], s52 offen offset:3072 lds
    s_mov_b32 m0, 129024
    s_nop 0
    buffer_load_dwordx4 v32, s[40:43], s52 offen offset:0 lds
    buffer_load_dwordx4 v33, s[40:43], s52 offen offset:1024 lds
    s_waitcnt vmcnt(52)
    s_barrier
    s_mov_b32 m0, 77056
    s_add_u32 s52, s68, 3840
    s_and_b32 s52, s52, 0xfff
    s_bitset1_b32 s52, 17
    buffer_load_dwordx4 v20, s[32:35], s52 offen offset:0 nt lds
    buffer_load_dwordx4 v21, s[32:35], s52 offen offset:1088 nt lds
    buffer_load_dwordx4 v22, s[32:35], s52 offen offset:2176 nt lds
    buffer_load_dwordx4 v23, s[32:35], s52 offen offset:3264 nt lds
    s_mov_b32 m0, 81408
    s_add_u32 s52, s52, 16384
    buffer_load_dwordx4 v20, s[32:35], s52 offen offset:0 nt lds
    buffer_load_dwordx4 v21, s[32:35], s52 offen offset:1088 nt lds
    buffer_load_dwordx4 v22, s[32:35], s52 offen offset:2176 nt lds
    buffer_load_dwordx4 v23, s[32:35], s52 offen offset:3264 nt lds
    s_add_u32 s52, s64, s62
    s_add_u32 s52, s52, 4
    s_mul_i32 s52, s52, 40960
    s_mov_b32 m0, 131072
    s_nop 0
    buffer_load_dwordx4 v24, s[40:43], s52 offen offset:0 lds
    buffer_load_dwordx4 v25, s[40:43], s52 offen offset:1024 lds
    buffer_load_dwordx4 v26, s[40:43], s52 offen offset:2048 lds
    buffer_load_dwordx4 v27, s[40:43], s52 offen offset:3072 lds
    s_mov_b32 m0, 135168
    s_nop 0
    buffer_load_dwordx4 v28, s[40:43], s52 offen offset:0 lds
    buffer_load_dwordx4 v29, s[40:43], s52 offen offset:1024 lds
    buffer_load_dwordx4 v30, s[40:43], s52 offen offset:2048 lds
    buffer_load_dwordx4 v31, s[40:43], s52 offen offset:3072 lds
    s_mov_b32 m0, 139264
    s_nop 0
    buffer_load_dwordx4 v32, s[40:43], s52 offen offset:0 lds
    buffer_load_dwordx4 v33, s[40:43], s52 offen offset:1024 lds
    s_waitcnt vmcnt(54)
    s_barrier
    s_add_u32 s52, s64, s63
    s_add_u32 s52, s52, 4
    s_mul_i32 s52, s52, 40960
    s_mov_b32 m0, 153600
    s_nop 0
    buffer_load_dwordx4 v24, s[40:43], s52 offen offset:0 lds
    buffer_load_dwordx4 v25, s[40:43], s52 offen offset:1024 lds
    buffer_load_dwordx4 v26, s[40:43], s52 offen offset:2048 lds
    buffer_load_dwordx4 v27, s[40:43], s52 offen offset:3072 lds
    s_mov_b32 m0, 157696
    s_nop 0
    buffer_load_dwordx4 v28, s[40:43], s52 offen offset:0 lds
    buffer_load_dwordx4 v29, s[40:43], s52 offen offset:1024 lds
    buffer_load_dwordx4 v30, s[40:43], s52 offen offset:2048 lds
    buffer_load_dwordx4 v31, s[40:43], s52 offen offset:3072 lds
    s_mov_b32 m0, 161792
    s_nop 0
    buffer_load_dwordx4 v32, s[40:43], s52 offen offset:0 lds
    buffer_load_dwordx4 v33, s[40:43], s52 offen offset:1024 lds
    s_add_u32 s52, s65, s60
    s_mul_i32 s52, s52, 40960
    s_mov_b32 m0, 0
    s_nop 0
    buffer_load_dwordx4 v24, s[40:43], s52 offen offset:0 lds
    buffer_load_dwordx4 v25, s[40:43], s52 offen offset:1024 lds
    buffer_load_dwordx4 v26, s[40:43], s52 offen offset:2048 lds
    buffer_load_dwordx4 v27, s[40:43], s52 offen offset:3072 lds
    s_mov_b32 m0, 4096
    s_nop 0
    buffer_load_dwordx4 v28, s[40:43], s52 offen offset:0 lds
    buffer_load_dwordx4 v29, s[40:43], s52 offen offset:1024 lds
    buffer_load_dwordx4 v30, s[40:43], s52 offen offset:2048 lds
    buffer_load_dwordx4 v31, s[40:43], s52 offen offset:3072 lds
    s_mov_b32 m0, 8192
    s_nop 0
    buffer_load_dwordx4 v32, s[40:43], s52 offen offset:0 lds
    buffer_load_dwordx4 v33, s[40:43], s52 offen offset:1024 lds
    s_waitcnt vmcnt(63)
    s_barrier
    s_add_u32 s52, s65, s61
    s_mul_i32 s52, s52, 40960
    s_mov_b32 m0, 22528
    s_nop 0
    buffer_load_dwordx4 v24, s[40:43], s52 offen offset:0 lds
    buffer_load_dwordx4 v25, s[40:43], s52 offen offset:1024 lds
    buffer_load_dwordx4 v26, s[40:43], s52 offen offset:2048 lds
    buffer_load_dwordx4 v27, s[40:43], s52 offen offset:3072 lds
    s_mov_b32 m0, 26624
    s_nop 0
    buffer_load_dwordx4 v28, s[40:43], s52 offen offset:0 lds
    buffer_load_dwordx4 v29, s[40:43], s52 offen offset:1024 lds
    buffer_load_dwordx4 v30, s[40:43], s52 offen offset:2048 lds
    buffer_load_dwordx4 v31, s[40:43], s52 offen offset:3072 lds
    s_mov_b32 m0, 30720
    s_nop 0
    buffer_load_dwordx4 v32, s[40:43], s52 offen offset:0 lds
    buffer_load_dwordx4 v33, s[40:43], s52 offen offset:1024 lds
    s_add_u32 s52, s65, s62
    s_mul_i32 s52, s52, 40960
    s_mov_b32 m0, 32768
    s_nop 0
    buffer_load_dwordx4 v24, s[40:43], s52 offen offset:0 lds
    buffer_load_dwordx4 v25, s[40:43], s52 offen offset:1024 lds
    buffer_load_dwordx4 v26, s[40:43], s52 offen offset:2048 lds
    buffer_load_dwordx4 v27, s[40:43], s52 offen offset:3072 lds
    s_mov_b32 m0, 36864
    s_nop 0
    buffer_load_dwordx4 v28, s[40:43], s52 offen offset:0 lds
    buffer_load_dwordx4 v29, s[40:43], s52 offen offset:1024 lds
    buffer_load_dwordx4 v30, s[40:43], s52 offen offset:2048 lds
    buffer_load_dwordx4 v31, s[40:43], s52 offen offset:3072 lds
    s_mov_b32 m0, 40960
    s_nop 0
    buffer_load_dwordx4 v32, s[40:43], s52 offen offset:0 lds
    buffer_load_dwordx4 v33, s[40:43], s52 offen offset:1024 lds
    s_waitcnt vmcnt(63)
    s_barrier
    s_add_u32 s52, s65, s63
    s_mul_i32 s52, s52, 40960
    s_mov_b32 m0, 55296
    s_nop 0
    buffer_load_dwordx4 v24, s[40:43], s52 offen offset:0 lds
    buffer_load_dwordx4 v25, s[40:43], s52 offen offset:1024 lds
    buffer_load_dwordx4 v26, s[40:43], s52 offen offset:2048 lds
    buffer_load_dwordx4 v27, s[40:43], s52 offen offset:3072 lds
    s_mov_b32 m0, 59392
    s_nop 0
    buffer_load_dwordx4 v28, s[40:43], s52 offen offset:0 lds
    buffer_load_dwordx4 v29, s[40:43], s52 offen offset:1024 lds
    buffer_load_dwordx4 v30, s[40:43], s52 offen offset:2048 lds
    buffer_load_dwordx4 v31, s[40:43], s52 offen offset:3072 lds
    s_mov_b32 m0, 63488
    s_nop 0
    buffer_load_dwordx4 v32, s[40:43], s52 offen offset:0 lds
    buffer_load_dwordx4 v33, s[40:43], s52 offen offset:1024 lds
    s_waitcnt vmcnt(60)
    s_barrier
    buffer_load_dword v36, v35, s[72:75], 0 offen offset:0 sc1
    s_add_u32 s52, s66, s60
    s_mul_i32 s52, s52, 40960
    s_mov_b32 m0, 65536
    s_nop 0
    buffer_load_dwordx4 v24, s[40:43], s52 offen offset:0 lds
    buffer_load_dwordx4 v25, s[40:43], s52 offen offset:1024 lds
    buffer_load_dwordx4 v26, s[40:43], s52 offen offset:2048 lds
    buffer_load_dwordx4 v27, s[40:43], s52 offen offset:3072 lds
    s_mov_b32 m0, 69632
    s_nop 0
    buffer_load_dwordx4 v28, s[40:43], s52 offen offset:0 lds
    buffer_load_dwordx4 v29, s[40:43], s52 offen offset:1024 lds
    buffer_load_dwordx4 v30, s[40:43], s52 offen offset:2048 lds
    buffer_load_dwordx4 v31, s[40:43], s52 offen offset:3072 lds
    s_mov_b32 m0, 73728
    s_nop 0
    buffer_load_dwordx4 v32, s[40:43], s52 offen offset:0 lds
    buffer_load_dwordx4 v33, s[40:43], s52 offen offset:1024 lds
    s_barrier
    s_waitcnt vmcnt(10)
    v_cmp_eq_u32 vcc, 1, v36
    s_and_b32 s54, vcc_lo, s59
    s_cmp_eq_u32 s54, s59
    s_cbranch_scc1 L_f1C_done
    s_mov_b32 s55, 0
L_f1C:
    buffer_load_dword v36, v35, s[72:75], 0 offen offset:0 sc1
    s_add_u32 s55, s55, 1
    s_waitcnt vmcnt(0)
    s_cmp_ge_u32 s55, 200000
    s_cbranch_scc1 L_f1C_done
    v_cmp_eq_u32 vcc, 1, v36
    s_and_b32 s54, vcc_lo, s59
    s_cmp_eq_u32 s54, s59
    s_cbranch_scc0 L_f1C
L_f1C_done:
    s_add_u32 s52, s65, s60
    s_mul_i32 s52, s52, 6144
    s_mov_b32 m0, 10240
    s_nop 0
    buffer_load_dwordx4 v34, s[36:39], s52 offen offset:0 sc1 lds
    buffer_load_dwordx4 v34, s[36:39], s52 offen offset:1024 sc1 lds
    buffer_load_dwordx4 v34, s[36:39], s52 offen offset:2048 sc1 lds
    buffer_load_dwordx4 v34, s[36:39], s52 offen offset:3072 sc1 lds
    s_mov_b32 m0, 14336
    s_add_u32 s52, s52, 4096
    buffer_load_dwordx4 v34, s[36:39], s52 offen offset:0 sc1 lds
    buffer_load_dwordx4 v34, s[36:39], s52 offen offset:1024 sc1 lds
    s_add_u32 s52, s65, s61
    s_mul_i32 s52, s52, 6144
    s_branch SK3
PAD3:
    s_branch BK3
SK3:
    s_mov_b32 m0, 16384
    s_nop 0
    buffer_load_dwordx4 v34, s[36:39], s52 offen offset:0 sc1 lds
    buffer_load_dwordx4 v34, s[36:39], s52 offen offset:1024 sc1 lds
    buffer_load_dwordx4 v34, s[36:39], s52 offen offset:2048 sc1 lds
    buffer_load_dwordx4 v34, s[36:39], s52 offen offset:3072 sc1 lds
    s_mov_b32 m0, 20480
    s_add_u32 s52, s52, 4096
    buffer_load_dwordx4 v34, s[36:39], s52 offen offset:0 sc1 lds
    buffer_load_dwordx4 v34, s[36:39], s52 offen offset:1024 sc1 lds
    s_add_u32 s52, s65, s62
    s_mul_i32 s52, s52, 6144
    s_mov_b32 m0, 43008
    s_nop 0
    buffer_load_dwordx4 v34, s[36:39], s52 offen offset:0 sc1 lds
    buffer_load_dwordx4 v34, s[36:39], s52 offen offset:1024 sc1 lds
    buffer_load_dwordx4 v34, s[36:39], s52 offen offset:2048 sc1 lds
    buffer_load_dwordx4 v34, s[36:39], s52 offen offset:3072 sc1 lds
    s_mov_b32 m0, 47104
    s_add_u32 s52, s52, 4096
    buffer_load_dwordx4 v34, s[36:39], s52 offen offset:0 sc1 lds
    buffer_load_dwordx4 v34, s[36:39], s52 offen offset:1024 sc1 lds
    s_add_u32 s52, s65, s63
    s_mul_i32 s52, s52, 6144
    s_mov_b32 m0, 49152
    s_nop 0
    buffer_load_dwordx4 v34, s[36:39], s52 offen offset:0 sc1 lds
    buffer_load_dwordx4 v34, s[36:39], s52 offen offset:1024 sc1 lds
    buffer_load_dwordx4 v34, s[36:39], s52 offen offset:2048 sc1 lds
    buffer_load_dwordx4 v34, s[36:39], s52 offen offset:3072 sc1 lds
    s_mov_b32 m0, 53248
    s_add_u32 s52, s52, 4096
    buffer_load_dwordx4 v34, s[36:39], s52 offen offset:0 sc1 lds
    buffer_load_dwordx4 v34, s[36:39], s52 offen offset:1024 sc1 lds
    s_barrier
    s_add_u32 s52, s66, s60
    s_mul_i32 s52, s52, 6144
    s_mov_b32 m0, 75776
    s_nop 0
    buffer_load_dwordx4 v34, s[36:39], s52 offen offset:0 sc1 lds
    buffer_load_dwordx4 v34, s[36:39], s52 offen offset:1024 sc1 lds
    buffer_load_dwordx4 v34, s[36:39], s52 offen offset:2048 sc1 lds
    buffer_load_dwordx4 v34, s[36:39], s52 offen offset:3072 sc1 lds
    s_mov_b32 m0, 79872
    s_add_u32 s52, s52, 4096
    buffer_load_dwordx4 v34, s[36:39], s52 offen offset:0 sc1 lds
    buffer_load_dwordx4 v34, s[36:39], s52 offen offset:1024 sc1 lds
    s_add_u32 s52, s66, s61
    s_mul_i32 s52, s52, 6144
    s_mov_b32 m0, 81920
    s_nop 0
    buffer_load_dwordx4 v34, s[36:39], s52 offen offset:0 sc1 lds
    buffer_load_dwordx4 v34, s[36:39], s52 offen offset:1024 sc1 lds
    buffer_load_dwordx4 v34, s[36:39], s52 offen offset:2048 sc1 lds
    buffer_load_dwordx4 v34, s[36:39], s52 offen offset:3072 sc1 lds
    s_mov_b32 m0, 86016
    s_add_u32 s52, s52, 4096
    buffer_load_dwordx4 v34, s[36:39], s52 offen offset:0 sc1 lds
    buffer_load_dwordx4 v34, s[36:39], s52 offen offset:1024 sc1 lds
    s_add_u32 s52, s66, s62
    s_mul_i32 s52, s52, 40960
    s_mov_b32 m0, 98304
    s_nop 0
    buffer_load_dwordx4 v24, s[40:43], s52 offen offset:0 lds
    buffer_load_dwordx4 v25, s[40:43], s52 offen offset:1024 lds
    buffer_load_dwordx4 v26, s[40:43], s52 offen offset:2048 lds
    buffer_load_dwordx4 v27, s[40:43], s52 offen offset:3072 lds
    s_mov_b32 m0, 102400
    s_nop 0
    buffer_load_dwordx4 v28, s[40:43], s52 offen offset:0 lds
    buffer_load_dwordx4 v29, s[40:43], s52 offen offset:1024 lds
    buffer_load_dwordx4 v30, s[40:43], s52 offen offset:2048 lds
    buffer_load_dwordx4 v31, s[40:43], s52 offen offset:3072 lds
    s_mov_b32 m0, 106496
    s_nop 0
    buffer_load_dwordx4 v32, s[40:43], s52 offen offset:0 lds
    buffer_load_dwordx4 v33, s[40:43], s52 offen offset:1024 lds
    s_add_u32 s52, s66, s62
    s_mul_i32 s52, s52, 6144
    s_mov_b32 m0, 108544
    s_nop 0
    buffer_load_dwordx4 v34, s[36:39], s52 offen offset:0 sc1 lds
    buffer_load_dwordx4 v34, s[36:39], s52 offen offset:1024 sc1 lds
    buffer_load_dwordx4 v34, s[36:39], s52 offen offset:2048 sc1 lds
    buffer_load_dwordx4 v34, s[36:39], s52 offen offset:3072 sc1 lds
    s_mov_b32 m0, 112640
    s_add_u32 s52, s52, 4096
    buffer_load_dwordx4 v34, s[36:39], s52 offen offset:0 sc1 lds
    buffer_load_dwordx4 v34, s[36:39], s52 offen offset:1024 sc1 lds
    s_waitcnt vmcnt(40)
    s_barrier
    s_add_u32 s52, s66, s63
    s_mul_i32 s52, s52, 40960
    s_mov_b32 m0, 120832
    s_nop 0
    buffer_load_dwordx4 v24, s[40:43], s52 offen offset:0 lds
    buffer_load_dwordx4 v25, s[40:43], s52 offen offset:1024 lds
    buffer_load_dwordx4 v26, s[40:43], s52 offen offset:2048 lds
    buffer_load_dwordx4 v27, s[40:43], s52 offen offset:3072 lds
    s_mov_b32 m0, 124928
    s_nop 0
    buffer_load_dwordx4 v28, s[40:43], s52 offen offset:0 lds
    buffer_load_dwordx4 v29, s[40:43], s52 offen offset:1024 lds
    buffer_load_dwordx4 v30, s[40:43], s52 offen offset:2048 lds
    buffer_load_dwordx4 v31, s[40:43], s52 offen offset:3072 lds
    s_mov_b32 m0, 129024
    s_nop 0
    buffer_load_dwordx4 v32, s[40:43], s52 offen offset:0 lds
    buffer_load_dwordx4 v33, s[40:43], s52 offen offset:1024 lds
    s_add_u32 s52, s66, s63
    s_mul_i32 s52, s52, 6144
    s_mov_b32 m0, 114688
    s_nop 0
    buffer_load_dwordx4 v34, s[36:39], s52 offen offset:0 sc1 lds
    buffer_load_dwordx4 v34, s[36:39], s52 offen offset:1024 sc1 lds
    buffer_load_dwordx4 v34, s[36:39], s52 offen offset:2048 sc1 lds
    buffer_load_dwordx4 v34, s[36:39], s52 offen offset:3072 sc1 lds
    s_mov_b32 m0, 118784
    s_add_u32 s52, s52, 4096
    buffer_load_dwordx4 v34, s[36:39], s52 offen offset:0 sc1 lds
    buffer_load_dwordx4 v34, s[36:39], s52 offen offset:1024 sc1 lds
    s_add_u32 s52, s67, s60
    s_mul_i32 s52, s52, 40960
    s_mov_b32 m0, 131072
    s_nop 0
    buffer_load_dwordx4 v24, s[40:43], s52 offen offset:0 lds
    buffer_load_dwordx4 v25, s[40:43], s52 offen offset:1024 lds
    buffer_load_dwordx4 v26, s[40:43], s52 offen offset:2048 lds
    buffer_load_dwordx4 v27, s[40:43], s52 offen offset:3072 lds
    s_mov_b32 m0, 135168
    s_nop 0
    buffer_load_dwordx4 v28, s[40:43], s52 offen offset:0 lds
    buffer_load_dwordx4 v29, s[40:43], s52 offen offset:1024 lds
    buffer_load_dwordx4 v30, s[40:43], s52 offen offset:2048 lds
    buffer_load_dwordx4 v31, s[40:43], s52 offen offset:3072 lds
    s_mov_b32 m0, 139264
    s_nop 0
    buffer_load_dwordx4 v32, s[40:43], s52 offen offset:0 lds
    buffer_load_dwordx4 v33, s[40:43], s52 offen offset:1024 lds
    s_waitcnt vmcnt(54)
    s_barrier
    s_add_u32 s52, s67, s60
    s_mul_i32 s52, s52, 6144
    s_mov_b32 m0, 141312
    s_nop 0
    buffer_load_dwordx4 v34, s[36:39], s52 offen offset:0 sc1 lds
    buffer_load_dwordx4 v34, s[36:39], s52 offen offset:1024 sc1 lds
    buffer_load_dwordx4 v34, s[36:39], s52 offen offset:2048 sc1 lds
    buffer_load_dwordx4 v34, s[36:39], s52 offen offset:3072 sc1 lds
    s_mov_b32 m0, 145408
    s_add_u32 s52, s52, 4096
    buffer_load_dwordx4 v34, s[36:39], s52 offen offset:0 sc1 lds
    buffer_load_dwordx4 v34, s[36:39], s52 offen offset:1024 sc1 lds
    s_add_u32 s52, s67, s61
    s_mul_i32 s52, s52, 40960
    s_mov_b32 m0, 153600
    s_nop 0
    buffer_load_dwordx4 v24, s[40:43], s52 offen offset:0 lds
    buffer_load_dwordx4 v25, s[40:43], s52 offen offset:1024 lds
    buffer_load_dwordx4 v26, s[40:43], s52 offen offset:2048 lds
    buffer_load_dwordx4 v27, s[40:43], s52 offen offset:3072 lds
    s_mov_b32 m0, 157696
    s_nop 0
    buffer_load_dwordx4 v28, s[40:43], s52 offen offset:0 lds
    buffer_load_dwordx4 v29, s[40:43], s52 offen offset:1024 lds
    buffer_load_dwordx4 v30, s[40:43], s52 offen offset:2048 lds
    buffer_load_dwordx4 v31, s[40:43], s52 offen offset:3072 lds
    s_mov_b32 m0, 161792
    s_nop 0
    buffer_load_dwordx4 v32, s[40:43], s52 offen offset:0 lds
    buffer_load_dwordx4 v33, s[40:43], s52 offen offset:1024 lds
    s_add_u32 s52, s67, s61
    s_mul_i32 s52, s52, 6144
    s_mov_b32 m0, 147456
    s_nop 0
    buffer_load_dwordx4 v34, s[36:39], s52 offen offset:0 sc1 lds
    buffer_load_dwordx4 v34, s[36:39], s52 offen offset:1024 sc1 lds
    buffer_load_dwordx4 v34, s[36:39], s52 offen offset:2048 sc1 lds
    buffer_load_dwordx4 v34, s[36:39], s52 offen offset:3072 sc1 lds
    s_mov_b32 m0, 151552
    s_add_u32 s52, s52, 4096
    buffer_load_dwordx4 v34, s[36:39], s52 offen offset:0 sc1 lds
    buffer_load_dwordx4 v34, s[36:39], s52 offen offset:1024 sc1 lds
    s_waitcnt vmcnt(63)
    s_barrier
    s_add_u32 s52, s67, s62
    s_mul_i32 s52, s52, 40960
    s_mov_b32 m0, 0
    s_nop 0
    buffer_load_dwordx4 v24, s[40:43], s52 offen offset:0 lds
    buffer_load_dwordx4 v25, s[40:43], s52 offen offset:1024 lds
    buffer_load_dwordx4 v26, s[40:43], s52 offen offset:2048 lds
    buffer_load_dwordx4 v27, s[40:43], s52 offen offset:3072 lds
    s_mov_b32 m0, 4096
    s_nop 0
    buffer_load_dwordx4 v28, s[40:43], s52 offen offset:0 lds
    buffer_load_dwordx4 v29, s[40:43], s52 offen offset:1024 lds
    buffer_load_dwordx4 v30, s[40:43], s52 offen offset:2048 lds
    buffer_load_dwordx4 v31, s[40:43], s52 offen offset:3072 lds
    s_mov_b32 m0, 8192
    s_nop 0
    buffer_load_dwordx4 v32, s[40:43], s52 offen offset:0 lds
    buffer_load_dwordx4 v33, s[40:43], s52 offen offset:1024 lds
    s_add_u32 s52, s67, s62
    s_mul_i32 s52, s52, 6144
    s_mov_b32 m0, 10240
    s_nop 0
    buffer_load_dwordx4 v34, s[36:39], s52 offen offset:0 sc1 lds
    buffer_load_dwordx4 v34, s[36:39], s52 offen offset:1024 sc1 lds
    buffer_load_dwordx4 v34, s[36:39], s52 offen offset:2048 sc1 lds
    buffer_load_dwordx4 v34, s[36:39], s52 offen offset:3072 sc1 lds
    s_mov_b32 m0, 14336
    s_add_u32 s52, s52, 4096
    buffer_load_dwordx4 v34, s[36:39], s52 offen offset:0 sc1 lds
    buffer_load_dwordx4 v34, s[36:39], s52 offen offset:1024 sc1 lds
    s_add_u32 s52, s67, s63
    s_mul_i32 s52, s52, 40960
    s_mov_b32 m0, 22528
    s_nop 0
    buffer_load_dwordx4 v24, s[40:43], s52 offen offset:0 lds
    buffer_load_dwordx4 v25, s[40:43], s52 offen offset:1024 lds
    buffer_load_dwordx4 v26, s[40:43], s52 offen offset:2048 lds
    buffer_load_dwordx4 v27, s[40:43], s52 offen offset:3072 lds
    s_mov_b32 m0, 26624
    s_nop 0
    buffer_load_dwordx4 v28, s[40:43], s52 offen offset:0 lds
    buffer_load_dwordx4 v29, s[40:43], s52 offen offset:1024 lds
    buffer_load_dwordx4 v30, s[40:43], s52 offen offset:2048 lds
    buffer_load_dwordx4 v31, s[40:43], s52 offen offset:3072 lds
    s_mov_b32 m0, 30720
    s_nop 0
    buffer_load_dwordx4 v32, s[40:43], s52 offen offset:0 lds
    buffer_load_dwordx4 v33, s[40:43], s52 offen offset:1024 lds
    s_add_u32 s52, s67, s63
    s_mul_i32 s52, s52, 6144
    s_mov_b32 m0, 16384
    s_nop 0
    buffer_load_dwordx4 v34, s[36:39], s52 offen offset:0 sc1 lds
    buffer_load_dwordx4 v34, s[36:39], s52 offen offset:1024 sc1 lds
    buffer_load_dwordx4 v34, s[36:39], s52 offen offset:2048 sc1 lds
    buffer_load_dwordx4 v34, s[36:39], s52 offen offset:3072 sc1 lds
    s_mov_b32 m0, 20480
    s_add_u32 s52, s52, 4096
    buffer_load_dwordx4 v34, s[36:39], s52 offen offset:0 sc1 lds
    buffer_load_dwordx4 v34, s[36:39], s52 offen offset:1024 sc1 lds
    s_waitcnt vmcnt(63)
    s_barrier
    buffer_load_dword v36, v35, s[72:75], 0 offen offset:128 sc1
    s_add_u32 s52, s65, s60
    s_add_u32 s52, s52, 4
    s_mul_i32 s52, s52, 40960
    s_mov_b32 m0, 32768
    s_nop 0
    buffer_load_dwordx4 v24, s[40:43], s52 offen offset:0 lds
    buffer_load_dwordx4 v25, s[40:43], s52 offen offset:1024 lds
    buffer_load_dwordx4 v26, s[40:43], s52 offen offset:2048 lds
    buffer_load_dwordx4 v27, s[40:43], s52 offen offset:3072 lds
    s_mov_b32 m0, 36864
    s_nop 0
    buffer_load_dwordx4 v28, s[40:43], s52 offen offset:0 lds
    buffer_load_dwordx4 v29, s[40:43], s52 offen offset:1024 lds
    buffer_load_dwordx4 v30, s[40:43], s52 offen offset:2048 lds
    buffer_load_dwordx4 v31, s[40:43], s52 offen offset:3072 lds
    s_mov_b32 m0, 40960
    s_nop 0
    buffer_load_dwordx4 v32, s[40:43], s52 offen offset:0 lds
    buffer_load_dwordx4 v33, s[40:43], s52 offen offset:1024 lds
    s_add_u32 s52, s65, s61
    s_add_u32 s52, s52, 4
    s_mul_i32 s52, s52, 40960
    s_mov_b32 m0, 55296
    s_nop 0
    buffer_load_dwordx4 v24, s[40:43], s52 offen offset:0 lds
    buffer_load_dwordx4 v25, s[40:43], s52 offen offset:1024 lds
    buffer_load_dwordx4 v26, s[40:43], s52 offen offset:2048 lds
    buffer_load_dwordx4 v27, s[40:43], s52 offen offset:3072 lds
    s_mov_b32 m0, 59392
    s_nop 0
    buffer_load_dwordx4 v28, s[40:43], s52 offen offset:0 lds
    buffer_load_dwordx4 v29, s[40:43], s52 offen offset:1024 lds
    buffer_load_dwordx4 v30, s[40:43], s52 offen offset:2048 lds
    buffer_load_dwordx4 v31, s[40:43], s52 offen offset:3072 lds
    s_mov_b32 m0, 63488
    s_nop 0
    buffer_load_dwordx4 v32, s[40:43], s52 offen offset:0 lds
    buffer_load_dwordx4 v33, s[40:43], s52 offen offset:1024 lds
    s_add_u32 s52, s65, s62
    s_add_u32 s52, s52, 4
    s_mul_i32 s52, s52, 40960
    s_mov_b32 m0, 65536
    s_nop 0
    buffer_load_dwordx4 v24, s[40:43], s52 offen offset:0 lds
    buffer_load_dwordx4 v25, s[40:43], s52 offen offset:1024 lds
    buffer_load_dwordx4 v26, s[40:43], s52 offen offset:2048 lds
    buffer_load_dwordx4 v27, s[40:43], s52 offen offset:3072 lds
    s_mov_b32 m0, 69632
    s_nop 0
    buffer_load_dwordx4 v28, s[40:43], s52 offen offset:0 lds
    buffer_load_dwordx4 v29, s[40:43], s52 offen offset:1024 lds
    buffer_load_dwordx4 v30, s[40:43], s52 offen offset:2048 lds
    buffer_load_dwordx4 v31, s[40:43], s52 offen offset:3072 lds
    s_mov_b32 m0, 73728
    s_nop 0
    buffer_load_dwordx4 v32, s[40:43], s52 offen offset:0 lds
    buffer_load_dwordx4 v33, s[40:43], s52 offen offset:1024 lds
    s_waitcnt vmcnt(63)
    s_barrier
    s_add_u32 s52, s65, s63
    s_add_u32 s52, s52, 4
    s_mul_i32 s52, s52, 40960
    s_mov_b32 m0, 88064
    s_nop 0
    buffer_load_dwordx4 v24, s[40:43], s52 offen offset:0 lds
    buffer_load_dwordx4 v25, s[40:43], s52 offen offset:1024 lds
    buffer_load_dwordx4 v26, s[40:43], s52 offen offset:2048 lds
    buffer_load_dwordx4 v27, s[40:43], s52 offen offset:3072 lds
    s_mov_b32 m0, 92160
    s_nop 0
    buffer_load_dwordx4 v28, s[40:43], s52 offen offset:0 lds
    buffer_load_dwordx4 v29, s[40:43], s52 offen offset:1024 lds
    buffer_load_dwordx4 v30, s[40:43], s52 offen offset:2048 lds
    buffer_load_dwordx4 v31, s[40:43], s52 offen offset:3072 lds
    s_mov_b32 m0, 96256
    s_nop 0
    buffer_load_dwordx4 v32, s[40:43], s52 offen offset:0 lds
    buffer_load_dwordx4 v33, s[40:43], s52 offen offset:1024 lds
    s_waitcnt vmcnt(40)
    v_cmp_eq_u32 vcc, 1, v36
    s_and_b32 s54, vcc_lo, s59
    s_cmp_eq_u32 s54, s59
    s_cbranch_scc1 L_f2C_done
    s_mov_b32 s55, 0
L_f2C:
    buffer_load_dword v36, v35, s[72:75], 0 offen offset:128 sc1
    s_add_u32 s55, s55, 1
    s_waitcnt vmcnt(0)
    s_cmp_ge_u32 s55, 200000
    s_cbranch_scc1 L_f2C_done
    v_cmp_eq_u32 vcc, 1, v36
    s_and_b32 s54, vcc_lo, s59
    s_cmp_eq_u32 s54, s59
    s_cbranch_scc0 L_f2C
L_f2C_done:
    s_add_u32 s52, s65, s60
    s_add_u32 s52, s52, 4
    s_mul_i32 s52, s52, 6144
    s_mov_b32 m0, 43008
    s_nop 0
    buffer_load_dwordx4 v34, s[36:39], s52 offen offset:0 sc1 lds
    buffer_load_dwordx4 v34, s[36:39], s52 offen offset:1024 sc1 lds
    buffer_load_dwordx4 v34, s[36:39], s52 offen offset:2048 sc1 lds
    buffer_load_dwordx4 v34, s[36:39], s52 offen offset:3072 sc1 lds
    s_mov_b32 m0, 47104
    s_add_u32 s52, s52, 4096
    buffer_load_dwordx4 v34, s[36:39], s52 offen offset:0 sc1 lds
    buffer_load_dwordx4 v34, s[36:39], s52 offen offset:1024 sc1 lds
    s_add_u32 s52, s65, s61
    s_add_u32 s52, s52, 4
    s_mul_i32 s52, s52, 6144
    s_mov_b32 m0, 49152
    s_nop 0
    buffer_load_dwordx4 v34, s[36:39], s52 offen offset:0 sc1 lds
    buffer_load_dwordx4 v34, s[36:39], s52 offen offset:1024 sc1 lds
    buffer_load_dwordx4 v34, s[36:39], s52 offen offset:2048 sc1 lds
    buffer_load_dwordx4 v34, s[36:39], s52 offen offset:3072 sc1 lds
    s_mov_b32 m0, 53248
    s_add_u32 s52, s52, 4096
    buffer_load_dwordx4 v34, s[36:39], s52 offen offset:0 sc1 lds
    buffer_load_dwordx4 v34, s[36:39], s52 offen offset:1024 sc1 lds
    s_add_u32 s52, s65, s62
    s_add_u32 s52, s52, 4
    s_mul_i32 s52, s52, 6144
    s_mov_b32 m0, 75776
    s_nop 0
    buffer_load_dwordx4 v34, s[36:39], s52 offen offset:0 sc1 lds
    buffer_load_dwordx4 v34, s[36:39], s52 offen offset:1024 sc1 lds
    buffer_load_dwordx4 v34, s[36:39], s52 offen offset:2048 sc1 lds
    buffer_load_dwordx4 v34, s[36:39], s52 offen offset:3072 sc1 lds
    s_mov_b32 m0, 79872
    s_add_u32 s52, s52, 4096
    buffer_load_dwordx4 v34, s[36:39], s52 offen offset:0 sc1 lds
    buffer_load_dwordx4 v34, s[36:39], s52 offen offset:1024 sc1 lds
    s_barrier
    s_add_u32 s52, s65, s63
    s_add_u32 s52, s52, 4
    s_mul_i32 s52, s52, 6144
    s_mov_b32 m0, 81920
    s_nop 0
    buffer_load_dwordx4 v34, s[36:39], s52 offen offset:0 sc1 lds
    buffer_load_dwordx4 v34, s[36:39], s52 offen offset:1024 sc1 lds
    buffer_load_dwordx4 v34, s[36:39], s52 offen offset:2048 sc1 lds
    buffer_load_dwordx4 v34, s[36:39], s52 offen offset:3072 sc1 lds
    s_mov_b32 m0, 86016
    s_add_u32 s52, s52, 4096
    buffer_load_dwordx4 v34, s[36:39], s52 offen offset:0 sc1 lds
    buffer_load_dwordx4 v34, s[36:39], s52 offen offset:1024 sc1 lds
    s_add_u32 s52, s66, s60
    s_add_u32 s52, s52, 4
    s_mul_i32 s52, s52, 40960
    s_mov_b32 m0, 98304
    s_nop 0
    buffer_load_dwordx4 v24, s[40:43], s52 offen offset:0 lds
    buffer_load_dwordx4 v25, s[40:43], s52 offen offset:1024 lds
    buffer_load_dwordx4 v26, s[40:43], s52 offen offset:2048 lds
    buffer_load_dwordx4 v27, s[40:43], s52 offen offset:3072 lds
    s_mov_b32 m0, 102400
    s_nop 0
    buffer_load_dwordx4 v28, s[40:43], s52 offen offset:0 lds
    buffer_load_dwordx4 v29, s[40:43], s52 offen offset:1024 lds
    buffer_load_dwordx4 v30, s[40:43], s52 offen offset:2048 lds
    buffer_load_dwordx4 v31, s[40:43], s52 offen offset:3072 lds
    s_mov_b32 m0, 106496
    s_nop 0
    buffer_load_dwordx4 v32, s[40:43], s52 offen offset:0 lds
    buffer_load_dwordx4 v33, s[40:43], s52 offen offset:1024 lds
    s_add_u32 s52, s66, s60
    s_add_u32 s52, s52, 4
    s_mul_i32 s52, s52, 6144
    s_mov_b32 m0, 108544
    s_nop 0
    buffer_load_dwordx4 v34, s[36:39], s52 offen offset:0 sc1 lds
    buffer_load_dwordx4 v34, s[36:39], s52 offen offset:1024 sc1 lds
    buffer_load_dwordx4 v34, s[36:39], s52 offen offset:2048 sc1 lds
    buffer_load_dwordx4 v34, s[36:39], s52 offen offset:3072 sc1 lds
    s_mov_b32 m0, 112640
    s_add_u32 s52, s52, 4096
    buffer_load_dwordx4 v34, s[36:39], s52 offen offset:0 sc1 lds
    buffer_load_dwordx4 v34, s[36:39], s52 offen offset:1024 sc1 lds
    s_add_u32 s52, s66, s61
    s_add_u32 s52, s52, 4
    s_mul_i32 s52, s52, 40960
    s_mov_b32 m0, 120832
    s_nop 0
    buffer_load_dwordx4 v24, s[40:43], s52 offen offset:0 lds
    buffer_load_dwordx4 v25, s[40:43], s52 offen offset:1024 lds
    buffer_load_dwordx4 v26, s[40:43], s52 offen offset:2048 lds
    buffer_load_dwordx4 v27, s[40:43], s52 offen offset:3072 lds
    s_mov_b32 m0, 124928
    s_nop 0
    buffer_load_dwordx4 v28, s[40:43], s52 offen offset:0 lds
    buffer_load_dwordx4 v29, s[40:43], s52 offen offset:1024 lds
    buffer_load_dwordx4 v30, s[40:43], s52 offen offset:2048 lds
    buffer_load_dwordx4 v31, s[40:43], s52 offen offset:3072 lds
    s_mov_b32 m0, 129024
    s_nop 0
    buffer_load_dwordx4 v32, s[40:43], s52 offen offset:0 lds
    buffer_load_dwordx4 v33, s[40:43], s52 offen offset:1024 lds
    s_waitcnt vmcnt(38)
    s_barrier
    s_add_u32 s52, s66, s61
    s_add_u32 s52, s52, 4
    s_mul_i32 s52, s52, 6144
    s_mov_b32 m0, 114688
    s_nop 0
    buffer_load_dwordx4 v34, s[36:39], s52 offen offset:0 sc1 lds
    buffer_load_dwordx4 v34, s[36:39], s52 offen offset:1024 sc1 lds
    buffer_load_dwordx4 v34, s[36:39], s52 offen offset:2048 sc1 lds
    buffer_load_dwordx4 v34, s[36:39], s52 offen offset:3072 sc1 lds
    s_mov_b32 m0, 118784
    s_add_u32 s52, s52, 4096
    buffer_load_dwordx4 v34, s[36:39], s52 offen offset:0 sc1 lds
    buffer_load_dwordx4 v34, s[36:39], s52 offen offset:1024 sc1 lds
    s_add_u32 s52, s66, s62
    s_add_u32 s52, s52, 4
    s_mul_i32 s52, s52, 40960
    s_mov_b32 m0, 131072
    s_nop 0
    buffer_load_dwordx4 v24, s[40:43], s52 offen offset:0 lds
    buffer_load_dwordx4 v25, s[40:43], s52 offen offset:1024 lds
    buffer_load_dwordx4 v26, s[40:43], s52 offen offset:2048 lds
    buffer_load_dwordx4 v27, s[40:43], s52 offen offset:3072 lds
    s_mov_b32 m0, 135168
    s_nop 0
    buffer_load_dwordx4 v28, s[40:43], s52 offen offset:0 lds
    buffer_load_dwordx4 v29, s[40:43], s52 offen offset:1024 lds
    buffer_load_dwordx4 v30, s[40:43], s52 offen offset:2048 lds
    buffer_load_dwordx4 v31, s[40:43], s52 offen offset:3072 lds
    s_mov_b32 m0, 139264
    s_nop 0
    buffer_load_dwordx4 v32, s[40:43], s52 offen offset:0 lds
    buffer_load_dwordx4 v33, s[40:43], s52 offen offset:1024 lds
    s_add_u32 s52, s66, s62
    s_add_u32 s52, s52, 4
    s_mul_i32 s52, s52, 6144
    s_mov_b32 m0, 141312
    s_nop 0
    buffer_load_dwordx4 v34, s[36:39], s52 offen offset:0 sc1 lds
    buffer_load_dwordx4 v34, s[36:39], s52 offen offset:1024 sc1 lds
    buffer_load_dwordx4 v34, s[36:39], s52 offen offset:2048 sc1 lds
    buffer_load_dwordx4 v34, s[36:39], s52 offen offset:3072 sc1 lds
    s_mov_b32 m0, 145408
    s_add_u32 s52, s52, 4096
    buffer_load_dwordx4 v34, s[36:39], s52 offen offset:0 sc1 lds
    buffer_load_dwordx4 v34, s[36:39], s52 offen offset:1024 sc1 lds
    s_waitcnt vmcnt(48)
    s_barrier
    s_add_u32 s52, s66, s63
    s_add_u32 s52, s52, 4
    s_mul_i32 s52, s52, 40960
    s_mov_b32 m0, 153600
    s_nop 0
    buffer_load_dwordx4 v24, s[40:43], s52 offen offset:0 lds
    buffer_load_dwordx4 v25, s[40:43], s52 offen offset:1024 lds
    buffer_load_dwordx4 v26, s[40:43], s52 offen offset:2048 lds
    buffer_load_dwordx4 v27, s[40:43], s52 offen offset:3072 lds
    s_mov_b32 m0, 157696
    s_nop 0
    buffer_load_dwordx4 v28, s[40:43], s52 offen offset:0 lds
    buffer_load_dwordx4 v29, s[40:43], s52 offen offset:1024 lds
    buffer_load_dwordx4 v30, s[40:43], s52 offen offset:2048 lds
    buffer_load_dwordx4 v31, s[40:43], s52 offen offset:3072 lds
    s_mov_b32 m0, 161792
    s_nop 0
    buffer_load_dwordx4 v32, s[40:43], s52 offen offset:0 lds
    buffer_load_dwordx4 v33, s[40:43], s52 offen offset:1024 lds
    s_add_u32 s52, s66, s63
    s_add_u32 s52, s52, 4
    s_mul_i32 s52, s52, 6144
    s_mov_b32 m0, 147456
    s_nop 0
    buffer_load_dwordx4 v34, s[36:39], s52 offen offset:0 sc1 lds
    buffer_load_dwordx4 v34, s[36:39], s52 offen offset:1024 sc1 lds
    buffer_load_dwordx4 v34, s[36:39], s52 offen offset:2048 sc1 lds
    buffer_load_dwordx4 v34, s[36:39], s52 offen offset:3072 sc1 lds
    s_mov_b32 m0, 151552
    s_add_u32 s52, s52, 4096
    buffer_load_dwordx4 v34, s[36:39], s52 offen offset:0 sc1 lds
    buffer_load_dwordx4 v34, s[36:39], s52 offen offset:1024 sc1 lds
    s_add_u32 s52, s67, s60
    s_add_u32 s52, s52, 4
    s_mul_i32 s52, s52, 40960
    s_mov_b32 m0, 0
    s_nop 0
    buffer_load_dwordx4 v24, s[40:43], s52 offen offset:0 lds
    buffer_load_dwordx4 v25, s[40:43], s52 offen offset:1024 lds
    buffer_load_dwordx4 v26, s[40:43], s52 offen offset:2048 lds
    buffer_load_dwordx4 v27, s[40:43], s52 offen offset:3072 lds
    s_mov_b32 m0, 4096
    s_nop 0
    buffer_load_dwordx4 v28, s[40:43], s52 offen offset:0 lds
    buffer_load_dwordx4 v29, s[40:43], s52 offen offset:1024 lds
    buffer_load_dwordx4 v30, s[40:43], s52 offen offset:2048 lds
    buffer_load_dwordx4 v31, s[40:43], s52 offen offset:3072 lds
    s_mov_b32 m0, 8192
    s_nop 0
    buffer_load_dwordx4 v32, s[40:43], s52 offen offset:0 lds
    buffer_load_dwordx4 v33, s[40:43], s52 offen offset:1024 lds
    s_waitcnt vmcnt(42)
    s_barrier
    s_add_u32 s52, s67, s60
    s_add_u32 s52, s52, 4
    s_mul_i32 s52, s52, 6144
    s_mov_b32 m0, 10240
    s_nop 0
    buffer_load_dwordx4 v34, s[36:39], s52 offen offset:0 sc1 lds
    buffer_load_dwordx4 v34, s[36:39], s52 offen offset:1024 sc1 lds
    buffer_load_dwordx4 v34, s[36:39], s52 offen offset:2048 sc1 lds
    buffer_load_dwordx4 v34, s[36:39], s52 offen offset:3072 sc1 lds
    s_mov_b32 m0, 14336
    s_add_u32 s52, s52, 4096
    buffer_load_dwordx4 v34, s[36:39], s52 offen offset:0 sc1 lds
    buffer_load_dwordx4 v34, s[36:39], s52 offen offset:1024 sc1 lds
    s_add_u32 s52, s67, s61
    s_add_u32 s52, s52, 4
    s_mul_i32 s52, s52, 40960
    s_mov_b32 m0, 22528
    s_nop 0
    buffer_load_dwordx4 v24, s[40:43], s52 offen offset:0 lds
    buffer_load_dwordx4 v25, s[40:43], s52 offen offset:1024 lds
    buffer_load_dwordx4 v26, s[40:43], s52 offen offset:2048 lds
    buffer_load_dwordx4 v27, s[40:43], s52 offen offset:3072 lds
    s_mov_b32 m0, 26624
    s_nop 0
    buffer_load_dwordx4 v28, s[40:43], s52 offen offset:0 lds
    buffer_load_dwordx4 v29, s[40:43], s52 offen offset:1024 lds
    buffer_load_dwordx4 v30, s[40:43], s52 offen offset:2048 lds
    buffer_load_dwordx4 v31, s[40:43], s52 offen offset:3072 lds
    s_mov_b32 m0, 30720
    s_nop 0
    buffer_load_dwordx4 v32, s[40:43], s52 offen offset:0 lds
    buffer_load_dwordx4 v33, s[40:43], s52 offen offset:1024 lds
    s_add_u32 s52, s67, s61
    s_add_u32 s52, s52, 4
    s_mul_i32 s52, s52, 6144
    s_mov_b32 m0, 16384
    s_nop 0
    buffer_load_dwordx4 v34, s[36:39], s52 offen offset:0 sc1 lds
    buffer_load_dwordx4 v34, s[36:39], s52 offen offset:1024 sc1 lds
    buffer_load_dwordx4 v34, s[36:39], s52 offen offset:2048 sc1 lds
    buffer_load_dwordx4 v34, s[36:39], s52 offen offset:3072 sc1 lds
    s_mov_b32 m0, 20480
    s_add_u32 s52, s52, 4096
    s_branch SK4
PAD4:
    s_branch BK4
SK4:
    buffer_load_dwordx4 v34, s[36:39], s52 offen offset:0 sc1 lds
    buffer_load_dwordx4 v34, s[36:39], s52 offen offset:1024 sc1 lds
    s_add_u32 s52, s67, s62
    s_add_u32 s52, s52, 4
    s_mul_i32 s52, s52, 40960
    s_mov_b32 m0, 32768
    s_nop 0
    buffer_load_dwordx4 v24, s[40:43], s52 offen offset:0 lds
    buffer_load_dwordx4 v25, s[40:43], s52 offen offset:1024 lds
    buffer_load_dwordx4 v26, s[40:43], s52 offen offset:2048 lds
    buffer_load_dwordx4 v27, s[40:43], s52 offen offset:3072 lds
    s_mov_b32 m0, 36864
    s_nop 0
    buffer_load_dwordx4 v28, s[40:43], s52 offen offset:0 lds
    buffer_load_dwordx4 v29, s[40:43], s52 offen offset:1024 lds
    buffer_load_dwordx4 v30, s[40:43], s52 offen offset:2048 lds
    buffer_load_dwordx4 v31, s[40:43], s52 offen offset:3072 lds
    s_mov_b32 m0, 40960
    s_nop 0
    buffer_load_dwordx4 v32, s[40:43], s52 offen offset:0 lds
    buffer_load_dwordx4 v33, s[40:43], s52 offen offset:1024 lds
    s_waitcnt vmcnt(42)
    s_barrier
    s_add_u32 s52, s67, s62
    s_add_u32 s52, s52, 4
    s_mul_i32 s52, s52, 6144
    s_mov_b32 m0, 43008
    s_nop 0
    buffer_load_dwordx4 v34, s[36:39], s52 offen offset:0 sc1 lds
    buffer_load_dwordx4 v34, s[36:39], s52 offen offset:1024 sc1 lds
    buffer_load_dwordx4 v34, s[36:39], s52 offen offset:2048 sc1 lds
    buffer_load_dwordx4 v34, s[36:39], s52 offen offset:3072 sc1 lds
    s_mov_b32 m0, 47104
    s_add_u32 s52, s52, 4096
    buffer_load_dwordx4 v34, s[36:39], s52 offen offset:0 sc1 lds
    buffer_load_dwordx4 v34, s[36:39], s52 offen offset:1024 sc1 lds
    s_add_u32 s52, s67, s63
    s_add_u32 s52, s52, 4
    s_mul_i32 s52, s52, 40960
    s_mov_b32 m0, 55296
    s_nop 0
    buffer_load_dwordx4 v24, s[40:43], s52 offen offset:0 lds
    buffer_load_dwordx4 v25, s[40:43], s52 offen offset:1024 lds
    buffer_load_dwordx4 v26, s[40:43], s52 offen offset:2048 lds
    buffer_load_dwordx4 v27, s[40:43], s52 offen offset:3072 lds
    s_mov_b32 m0, 59392
    s_nop 0
    buffer_load_dwordx4 v28, s[40:43], s52 offen offset:0 lds
    buffer_load_dwordx4 v29, s[40:43], s52 offen offset:1024 lds
    buffer_load_dwordx4 v30, s[40:43], s52 offen offset:2048 lds
    buffer_load_dwordx4 v31, s[40:43], s52 offen offset:3072 lds
    s_mov_b32 m0, 63488
    s_nop 0
    buffer_load_dwordx4 v32, s[40:43], s52 offen offset:0 lds
    buffer_load_dwordx4 v33, s[40:43], s52 offen offset:1024 lds
    s_add_u32 s52, s67, s63
    s_add_u32 s52, s52, 4
    s_mul_i32 s52, s52, 6144
    s_mov_b32 m0, 49152
    s_nop 0
    buffer_load_dwordx4 v34, s[36:39], s52 offen offset:0 sc1 lds
    buffer_load_dwordx4 v34, s[36:39], s52 offen offset:1024 sc1 lds
    buffer_load_dwordx4 v34, s[36:39], s52 offen offset:2048 sc1 lds
    buffer_load_dwordx4 v34, s[36:39], s52 offen offset:3072 sc1 lds
    s_mov_b32 m0, 53248
    s_add_u32 s52, s52, 4096
    buffer_load_dwordx4 v34, s[36:39], s52 offen offset:0 sc1 lds
    buffer_load_dwordx4 v34, s[36:39], s52 offen offset:1024 sc1 lds
    s_waitcnt vmcnt(32)
    s_barrier
    s_waitcnt vmcnt(0)
    s_barrier
    s_endpgm
K_notld:
BK0:
BK10:
BK1:
BK5:
BK6:
BK8:
    s_and_b32 s56, s3, 3
    s_lshr_b32 s57, s3, 2
    v_lshrrev_b32 v248, 5, v0
    v_and_b32 v249, 31, v0
    v_bfe_u32 v9, v0, 4, 1
    v_bfe_u32 v250, v0, 2, 2
    v_and_b32 v1, 1, v0
    v_bfe_u32 v15, v0, 1, 1
    v_lshl_add_u32 v251, v1, 1, v15
    v_lshlrev_b32 v251, 3, v251
    v_lshl_add_u32 v251, v9, 5, v251
    v_lshlrev_b32 v7, 4, v0
    s_cmp_eq_u32 s3, 3
    s_cbranch_scc1 K_w3
    s_lshl_b32 s52, s56, 12
    s_add_u32 s53, s52, 42240
    s_add_u32 s52, s52, 137984
    v_bfe_u32 v1, v0, 1, 3
    v_xor_b32 v1, v1, v248
    v_lshlrev_b32 v1, 4, v1
    v_lshl_add_u32 v1, v249, 7, v1
    v_xor_b32 v15, 0, v1
    v_add_u32 v11, s52, v15
    v_add_u32 v252, s53, v15
    v_xor_b32 v15, 32, v1
    v_add_u32 v12, s52, v15
    v_add_u32 v253, s53, v15
    v_xor_b32 v15, 64, v1
    v_add_u32 v13, s52, v15
    v_add_u32 v254, s53, v15
    v_xor_b32 v15, 96, v1
    v_add_u32 v14, s52, v15
    v_add_u32 v255, s53, v15
    v_lshl_add_u32 v1, v248, 3, v250
    v_mul_u32_u24 v1, 1088, v1
    s_mov_b32 s53, 85760
    v_add3_u32 v10, v1, v251, s53
    v_and_b32 v1, 7, v0
    v_mul_u32_u24 v1, 1056, v1
    v_bfe_u32 v15, v0, 3, 2
    v_lshl_add_u32 v1, v15, 8, v1
    v_xor_b32 v15, v248, v9
    v_lshl_add_u32 v2, v15, 4, v1
    v_lshl_add_u32 v1, v248, 2, v250
    v_mul_u32_u24 v1, 1088, v1
    s_mov_b32 s53, 42240
    v_add3_u32 v3, v1, v251, s53
    s_mov_b32 s70, 0x3e0293ee
    s_mov_b32 s71, 0x3e0293ee
    s_mov_b32 s68, 0x44800000
    s_cmp_eq_u32 s57, 0
    s_mov_b32 s54, 108544
    s_mov_b32 s55, 141312
    s_cselect_b32 s54, 108544, s54
    s_cselect_b32 s55, 141312, s55
    s_bfe_u32 s52, s48, 0x10000
    s_lshl_b32 s52, s52, 1
    s_xor_b32 s52, s52, 0
    s_and_b32 s53, s52, 1
    s_mul_i32 s53, s53, 6144
    s_bitcmp1_b32 s52, 1
    s_cselect_b32 s52, s55, s54
    s_add_u32 s52, s52, s53
    s_lshl_b32 s53, s56, 11
    s_add_u32 s60, s52, s53
    s_bfe_u32 s52, s48, 0x10000
    s_lshl_b32 s52, s52, 1
    s_xor_b32 s52, s52, 1
    s_and_b32 s53, s52, 1
    s_mul_i32 s53, s53, 6144
    s_bitcmp1_b32 s52, 1
    s_cselect_b32 s52, s55, s54
    s_add_u32 s52, s52, s53
    s_lshl_b32 s53, s56, 11
    s_add_u32 s61, s52, s53
    s_bfe_u32 s52, s48, 0x10000
    s_lshl_b32 s52, s52, 1
    s_xor_b32 s52, s52, 2
    s_and_b32 s53, s52, 1
    s_mul_i32 s53, s53, 6144
    s_bitcmp1_b32 s52, 1
    s_cselect_b32 s52, s55, s54
    s_add_u32 s52, s52, s53
    s_lshl_b32 s53, s56, 11
    s_add_u32 s62, s52, s53
    s_bfe_u32 s52, s48, 0x10000
    s_lshl_b32 s52, s52, 1
    s_xor_b32 s52, s52, 3
    s_and_b32 s53, s52, 1
    s_mul_i32 s53, s53, 6144
    s_bitcmp1_b32 s52, 1
    s_cselect_b32 s52, s55, s54
    s_add_u32 s52, s52, s53
    s_lshl_b32 s53, s56, 11
    s_add_u32 s63, s52, s53
    s_waitcnt lgkmcnt(0)
    s_lshl_b32 s52, s48, 5
    s_add_u32 s52, s52, s51
    s_add_u32 s52, s52, s57
    s_mul_i32 s52, s52, 24576
    s_lshl_b32 s53, s56, 11
    s_add_u32 s52, s52, s53
    s_add_u32 s36, s18, s52
    s_addc_u32 s37, s19, 0
    s_mov_b32 s38, 24576
    s_mov_b32 s39, 0x20000
    s_lshl_b32 s52, s48, 7
    s_lshl1_add_u32 s53, s49, s57
    s_add_u32 s52, s52, s53
    s_lshl_b32 s52, s52, 7
    s_lshl2_add_u32 s53, s50, s56
    s_lshl2_add_u32 s52, s53, s52
    s_add_u32 s52, s52, 33554432
    s_add_u32 s72, s18, s52
    s_addc_u32 s73, s19, 0
    s_mov_b32 s74, 4
    s_mov_b32 s75, 0x20000
    s_getreg_b32 s52, hwreg(HW_REG_XCC_ID, 0, 4)
    s_or_b32 s53, s52, 8
    s_mul_i32 s69, s53, 0x1111
    s_cmp_lt_u32 s52, 8
    s_cselect_b32 s69, s69, 0x10000
    s_lshl_b32 s52, s48, 3
    s_lshl1_add_u32 s52, s49, s52
    v_mov_b32 v15, s52
    s_cmp_eq_u32 s57, 0
    s_cbranch_scc0 K_bgrp
    s_barrier
    ds_read_b128 v[240:243], v11 offset:0
    ds_read_b64_tr_b16 v[208:209], v10 offset:34816
    ds_read_b64_tr_b16 v[210:211], v10 offset:39168
    ds_read_b64_tr_b16 v[212:213], v10 offset:34880
    ds_read_b64_tr_b16 v[214:215], v10 offset:39232
    ds_read_b64_tr_b16 v[216:217], v10 offset:34944
    ds_read_b64_tr_b16 v[218:219], v10 offset:39296
    ds_read_b64_tr_b16 v[220:221], v10 offset:35008
    ds_read_b64_tr_b16 v[222:223], v10 offset:39360
    ds_read_b64_tr_b16 v[224:225], v10 offset:35072
    ds_read_b64_tr_b16 v[226:227], v10 offset:39424
    s_waitcnt lgkmcnt(8)
    v_mfma_f32_32x32x16_bf16 v[64:79], v[208:211], v[240:243], 0
    s_waitcnt lgkmcnt(6)
    ds_read_b128 v[244:247], v12 offset:0
    ds_read_b64_tr_b16 v[228:229], v10 offset:35136
    ds_read_b64_tr_b16 v[230:231], v10 offset:39488
    v_mfma_f32_32x32x16_bf16 v[80:95], v[212:215], v[240:243], 0
    s_waitcnt lgkmcnt(7)
    ds_read_b64_tr_b16 v[232:233], v10 offset:35200
    ds_read_b64_tr_b16 v[234:235], v10 offset:39552
    ds_read_b64_tr_b16 v[236:237], v10 offset:35264
    v_mfma_f32_32x32x16_bf16 v[96:111], v[216:219], v[240:243], 0
    s_waitcnt lgkmcnt(8)
    ds_read_b64_tr_b16 v[238:239], v10 offset:39616
    ds_read_b64_tr_b16 v[208:209], v10 offset:35328
    ds_read_b64_tr_b16 v[210:211], v10 offset:39680
    v_mfma_f32_32x32x16_bf16 v[112:127], v[220:223], v[240:243], 0
    s_waitcnt lgkmcnt(8)
    ds_read_b64_tr_b16 v[212:213], v10 offset:35392
    ds_read_b64_tr_b16 v[214:215], v10 offset:39744
    ds_read_b64_tr_b16 v[216:217], v10 offset:35456
    v_mfma_f32_32x32x16_bf16 v[64:79], v[224:227], v[244:247], v[64:79]
    s_waitcnt lgkmcnt(9)
    ds_read_b128 v[240:243], v13 offset:0
    ds_read_b64_tr_b16 v[218:219], v10 offset:39808
    ds_read_b64_tr_b16 v[220:221], v10 offset:35520
    v_mfma_f32_32x32x16_bf16 v[80:95], v[228:231], v[244:247], v[80:95]
    s_waitcnt lgkmcnt(10)
    ds_read_b64_tr_b16 v[222:223], v10 offset:39872
    ds_read_b64_tr_b16 v[224:225], v10 offset:35584
    ds_read_b64_tr_b16 v[226:227], v10 offset:39936
    v_mfma_f32_32x32x16_bf16 v[96:111], v[232:235], v[244:247], v[96:111]
    s_waitcnt lgkmcnt(11)
    ds_read_b64_tr_b16 v[228:229], v10 offset:35648
    ds_read_b64_tr_b16 v[230:231], v10 offset:40000
    v_mfma_f32_32x32x16_bf16 v[112:127], v[236:239], v[244:247], v[112:127]
    s_waitcnt lgkmcnt(7)
    ds_read_b64_tr_b16 v[232:233], v10 offset:35712
    ds_read_b64_tr_b16 v[234:235], v10 offset:40064
    v_mfma_f32_32x32x16_bf16 v[64:79], v[208:211], v[240:243], v[64:79]
    ds_read_b128 v[244:247], v14 offset:0
    ds_read_b64_tr_b16 v[236:237], v10 offset:35776
    ds_read_b64_tr_b16 v[238:239], v10 offset:40128
    v_mfma_f32_32x32x16_bf16 v[80:95], v[212:215], v[240:243], v[80:95]
    s_waitcnt lgkmcnt(11)
    v_mfma_f32_32x32x16_bf16 v[96:111], v[216:219], v[240:243], v[96:111]
    s_waitcnt lgkmcnt(9)
    v_mfma_f32_32x32x16_bf16 v[112:127], v[220:223], v[240:243], v[112:127]
    s_waitcnt lgkmcnt(0)
    v_mfma_f32_32x32x16_bf16 v[64:79], v[224:227], v[244:247], v[64:79]
    s_barrier
    ds_read_b128 v[240:243], v11 offset:12288
    ds_read_b64_tr_b16 v[208:209], v10 offset:0
    v_mfma_f32_32x32x16_bf16 v[80:95], v[228:231], v[244:247], v[80:95]
    ds_read_b64_tr_b16 v[210:211], v10 offset:4352
    ds_read_b64_tr_b16 v[212:213], v10 offset:64
    ds_read_b64_tr_b16 v[214:215], v10 offset:4416
    v_mfma_f32_32x32x16_bf16 v[96:111], v[232:235], v[244:247], v[96:111]
    ds_read_b64_tr_b16 v[216:217], v10 offset:128
    ds_read_b64_tr_b16 v[218:219], v10 offset:4480
    ds_read_b64_tr_b16 v[220:221], v10 offset:192
    v_mfma_f32_32x32x16_bf16 v[112:127], v[236:239], v[244:247], v[112:127]
    s_waitcnt lgkmcnt(5)
    ds_read_b64_tr_b16 v[222:223], v10 offset:4544
    ds_read_b64_tr_b16 v[224:225], v10 offset:256
    ds_read_b64_tr_b16 v[226:227], v10 offset:4608
    v_mfma_f32_32x32x16_bf16 v[64:79], v[208:211], v[240:243], v[64:79]
    s_waitcnt lgkmcnt(6)
    ds_read_b128 v[244:247], v12 offset:12288
    ds_read_b64_tr_b16 v[228:229], v10 offset:320
    ds_read_b64_tr_b16 v[230:231], v10 offset:4672
    v_mfma_f32_32x32x16_bf16 v[80:95], v[212:215], v[240:243], v[80:95]
    s_waitcnt lgkmcnt(7)
    ds_read_b64_tr_b16 v[232:233], v10 offset:384
    ds_read_b64_tr_b16 v[234:235], v10 offset:4736
    ds_read_b64_tr_b16 v[236:237], v10 offset:448
    v_mfma_f32_32x32x16_bf16 v[96:111], v[216:219], v[240:243], v[96:111]
    s_waitcnt lgkmcnt(8)
    ds_read_b64_tr_b16 v[238:239], v10 offset:4800
    ds_read_b64_tr_b16 v[208:209], v10 offset:512
    ds_read_b64_tr_b16 v[210:211], v10 offset:4864
    v_mfma_f32_32x32x16_bf16 v[112:127], v[220:223], v[240:243], v[112:127]
    s_waitcnt lgkmcnt(8)
    ds_read_b64_tr_b16 v[212:213], v10 offset:576
    ds_read_b64_tr_b16 v[214:215], v10 offset:4928
    ds_read_b64_tr_b16 v[216:217], v10 offset:640
    v_mfma_f32_32x32x16_bf16 v[64:79], v[224:227], v[244:247], v[64:79]
    s_waitcnt lgkmcnt(9)
    ds_read_b128 v[240:243], v13 offset:12288
    ds_read_b64_tr_b16 v[218:219], v10 offset:4992
    ds_read_b64_tr_b16 v[220:221], v10 offset:704
    v_mfma_f32_32x32x16_bf16 v[80:95], v[228:231], v[244:247], v[80:95]
    s_waitcnt lgkmcnt(10)
    ds_read_b64_tr_b16 v[222:223], v10 offset:5056
    ds_read_b64_tr_b16 v[224:225], v10 offset:768
    ds_read_b64_tr_b16 v[226:227], v10 offset:5120
    v_mfma_f32_32x32x16_bf16 v[96:111], v[232:235], v[244:247], v[96:111]
    s_waitcnt lgkmcnt(11)
    ds_read_b64_tr_b16 v[228:229], v10 offset:832
    ds_read_b64_tr_b16 v[230:231], v10 offset:5184
    v_mfma_f32_32x32x16_bf16 v[112:127], v[236:239], v[244:247], v[112:127]
    s_waitcnt lgkmcnt(7)
    ds_read_b64_tr_b16 v[232:233], v10 offset:896
    ds_read_b64_tr_b16 v[234:235], v10 offset:5248
    v_mfma_f32_32x32x16_bf16 v[64:79], v[208:211], v[240:243], v[64:79]
    ds_read_b128 v[244:247], v14 offset:12288
    ds_read_b64_tr_b16 v[236:237], v10 offset:960
    ds_read_b64_tr_b16 v[238:239], v10 offset:5312
    v_mfma_f32_32x32x16_bf16 v[80:95], v[212:215], v[240:243], v[80:95]
    s_waitcnt lgkmcnt(11)
    v_mfma_f32_32x32x16_bf16 v[96:111], v[216:219], v[240:243], v[96:111]
    s_waitcnt lgkmcnt(9)
    v_mfma_f32_32x32x16_bf16 v[112:127], v[220:223], v[240:243], v[112:127]
    s_waitcnt lgkmcnt(0)
    v_mfma_f32_32x32x16_bf16 v[64:79], v[224:227], v[244:247], v[64:79]
    s_barrier
    ds_read_b128 v[240:243], v252 offset:0
    ds_read_b64_tr_b16 v[208:209], v10 offset:17408
    v_mfma_f32_32x32x16_bf16 v[80:95], v[228:231], v[244:247], v[80:95]
    ds_read_b64_tr_b16 v[210:211], v10 offset:21760
    ds_read_b64_tr_b16 v[212:213], v10 offset:17472
    ds_read_b64_tr_b16 v[214:215], v10 offset:21824
    v_mfma_f32_32x32x16_bf16 v[96:111], v[232:235], v[244:247], v[96:111]
    ds_read_b64_tr_b16 v[216:217], v10 offset:17536
    ds_read_b64_tr_b16 v[218:219], v10 offset:21888
    ds_read_b64_tr_b16 v[220:221], v10 offset:17600
    v_mfma_f32_32x32x16_bf16 v[112:127], v[236:239], v[244:247], v[112:127]
    s_waitcnt lgkmcnt(5)
    ds_read_b64_tr_b16 v[222:223], v10 offset:21952
    ds_read_b64_tr_b16 v[224:225], v10 offset:17664
    ds_read_b64_tr_b16 v[226:227], v10 offset:22016
    v_mfma_f32_32x32x16_bf16 v[64:79], v[208:211], v[240:243], v[64:79]
    s_waitcnt lgkmcnt(6)
    ds_read_b128 v[244:247], v253 offset:0
    ds_read_b64_tr_b16 v[228:229], v10 offset:17728
    ds_read_b64_tr_b16 v[230:231], v10 offset:22080
    v_mfma_f32_32x32x16_bf16 v[80:95], v[212:215], v[240:243], v[80:95]
    s_waitcnt lgkmcnt(7)
    ds_read_b64_tr_b16 v[232:233], v10 offset:17792
    ds_read_b64_tr_b16 v[234:235], v10 offset:22144
    ds_read_b64_tr_b16 v[236:237], v10 offset:17856
    v_mfma_f32_32x32x16_bf16 v[96:111], v[216:219], v[240:243], v[96:111]
    s_waitcnt lgkmcnt(8)
    ds_read_b64_tr_b16 v[238:239], v10 offset:22208
    ds_read_b64_tr_b16 v[208:209], v10 offset:17920
    ds_read_b64_tr_b16 v[210:211], v10 offset:22272
    v_mfma_f32_32x32x16_bf16 v[112:127], v[220:223], v[240:243], v[112:127]
    s_waitcnt lgkmcnt(8)
    ds_read_b64_tr_b16 v[212:213], v10 offset:17984
    ds_read_b64_tr_b16 v[214:215], v10 offset:22336
    ds_read_b64_tr_b16 v[216:217], v10 offset:18048
    v_mfma_f32_32x32x16_bf16 v[64:79], v[224:227], v[244:247], v[64:79]
    s_waitcnt lgkmcnt(9)
    ds_read_b128 v[240:243], v254 offset:0
    ds_read_b64_tr_b16 v[218:219], v10 offset:22400
    ds_read_b64_tr_b16 v[220:221], v10 offset:18112
    v_mfma_f32_32x32x16_bf16 v[80:95], v[228:231], v[244:247], v[80:95]
    s_waitcnt lgkmcnt(10)
    ds_read_b64_tr_b16 v[222:223], v10 offset:22464
    ds_read_b64_tr_b16 v[224:225], v10 offset:18176
    ds_read_b64_tr_b16 v[226:227], v10 offset:22528
    v_mfma_f32_32x32x16_bf16 v[96:111], v[232:235], v[244:247], v[96:111]
    s_waitcnt lgkmcnt(11)
    ds_read_b64_tr_b16 v[228:229], v10 offset:18240
    ds_read_b64_tr_b16 v[230:231], v10 offset:22592
    v_mfma_f32_32x32x16_bf16 v[112:127], v[236:239], v[244:247], v[112:127]
    s_waitcnt lgkmcnt(7)
    ds_read_b64_tr_b16 v[232:233], v10 offset:18304
    ds_read_b64_tr_b16 v[234:235], v10 offset:22656
    v_mfma_f32_32x32x16_bf16 v[64:79], v[208:211], v[240:243], v[64:79]
    ds_read_b128 v[244:247], v255 offset:0
    ds_read_b64_tr_b16 v[236:237], v10 offset:18368
    ds_read_b64_tr_b16 v[238:239], v10 offset:22720
    v_mfma_f32_32x32x16_bf16 v[80:95], v[212:215], v[240:243], v[80:95]
    s_waitcnt lgkmcnt(11)
    v_mfma_f32_32x32x16_bf16 v[96:111], v[216:219], v[240:243], v[96:111]
    s_waitcnt lgkmcnt(9)
    v_mfma_f32_32x32x16_bf16 v[112:127], v[220:223], v[240:243], v[112:127]
    s_waitcnt lgkmcnt(0)
    v_mfma_f32_32x32x16_bf16 v[64:79], v[224:227], v[244:247], v[64:79]
    s_barrier
    ds_read_b128 v[240:243], v252 offset:12288
    ds_read_b64_tr_b16 v[208:209], v10 offset:34816
    v_mfma_f32_32x32x16_bf16 v[80:95], v[228:231], v[244:247], v[80:95]
    ds_read_b64_tr_b16 v[210:211], v10 offset:39168
    ds_read_b64_tr_b16 v[212:213], v10 offset:34880
    ds_read_b64_tr_b16 v[214:215], v10 offset:39232
    v_mfma_f32_32x32x16_bf16 v[96:111], v[232:235], v[244:247], v[96:111]
    ds_read_b64_tr_b16 v[216:217], v10 offset:34944
    ds_read_b64_tr_b16 v[218:219], v10 offset:39296
    ds_read_b64_tr_b16 v[220:221], v10 offset:35008
    v_mfma_f32_32x32x16_bf16 v[112:127], v[236:239], v[244:247], v[112:127]
    s_waitcnt lgkmcnt(5)
    ds_read_b64_tr_b16 v[222:223], v10 offset:39360
    ds_read_b64_tr_b16 v[224:225], v10 offset:35072
    ds_read_b64_tr_b16 v[226:227], v10 offset:39424
    v_mfma_f32_32x32x16_bf16 v[64:79], v[208:211], v[240:243], v[64:79]
    s_waitcnt lgkmcnt(6)
    ds_read_b128 v[244:247], v253 offset:12288
    ds_read_b64_tr_b16 v[228:229], v10 offset:35136
    ds_read_b64_tr_b16 v[230:231], v10 offset:39488
    v_mfma_f32_32x32x16_bf16 v[80:95], v[212:215], v[240:243], v[80:95]
    s_waitcnt lgkmcnt(7)
    ds_read_b64_tr_b16 v[232:233], v10 offset:35200
    ds_read_b64_tr_b16 v[234:235], v10 offset:39552
    ds_read_b64_tr_b16 v[236:237], v10 offset:35264
    v_mfma_f32_32x32x16_bf16 v[96:111], v[216:219], v[240:243], v[96:111]
    s_waitcnt lgkmcnt(8)
    ds_read_b64_tr_b16 v[238:239], v10 offset:39616
    ds_read_b64_tr_b16 v[208:209], v10 offset:35328
    ds_read_b64_tr_b16 v[210:211], v10 offset:39680
    v_mfma_f32_32x32x16_bf16 v[112:127], v[220:223], v[240:243], v[112:127]
    s_waitcnt lgkmcnt(8)
    ds_read_b64_tr_b16 v[212:213], v10 offset:35392
    ds_read_b64_tr_b16 v[214:215], v10 offset:39744
    ds_read_b64_tr_b16 v[216:217], v10 offset:35456
    v_mfma_f32_32x32x16_bf16 v[64:79], v[224:227], v[244:247], v[64:79]
    s_waitcnt lgkmcnt(9)
    ds_read_b128 v[240:243], v254 offset:12288
    ds_read_b64_tr_b16 v[218:219], v10 offset:39808
    ds_read_b64_tr_b16 v[220:221], v10 offset:35520
    v_mfma_f32_32x32x16_bf16 v[80:95], v[228:231], v[244:247], v[80:95]
    s_waitcnt lgkmcnt(10)
    ds_read_b64_tr_b16 v[222:223], v10 offset:39872
    ds_read_b64_tr_b16 v[224:225], v10 offset:35584
    ds_read_b64_tr_b16 v[226:227], v10 offset:39936
    v_mfma_f32_32x32x16_bf16 v[96:111], v[232:235], v[244:247], v[96:111]
    s_waitcnt lgkmcnt(11)
    ds_read_b64_tr_b16 v[228:229], v10 offset:35648
    ds_read_b64_tr_b16 v[230:231], v10 offset:40000
    v_mfma_f32_32x32x16_bf16 v[112:127], v[236:239], v[244:247], v[112:127]
    s_waitcnt lgkmcnt(7)
    ds_read_b64_tr_b16 v[232:233], v10 offset:35712
    ds_read_b64_tr_b16 v[234:235], v10 offset:40064
    v_mfma_f32_32x32x16_bf16 v[64:79], v[208:211], v[240:243], v[64:79]
    ds_read_b128 v[244:247], v255 offset:12288
    ds_read_b64_tr_b16 v[236:237], v10 offset:35776
    ds_read_b64_tr_b16 v[238:239], v10 offset:40128
    v_mfma_f32_32x32x16_bf16 v[80:95], v[212:215], v[240:243], v[80:95]
    s_waitcnt lgkmcnt(11)
    v_mfma_f32_32x32x16_bf16 v[96:111], v[216:219], v[240:243], v[96:111]
    s_waitcnt lgkmcnt(9)
    v_mfma_f32_32x32x16_bf16 v[112:127], v[220:223], v[240:243], v[112:127]
    s_waitcnt lgkmcnt(0)
    v_mfma_f32_32x32x16_bf16 v[64:79], v[224:227], v[244:247], v[64:79]
    s_barrier
    ds_read_b128 v[240:243], v11 offset:0
    ds_read_b64_tr_b16 v[208:209], v10 offset:0
    v_mfma_f32_32x32x16_bf16 v[80:95], v[228:231], v[244:247], v[80:95]
    ds_read_b64_tr_b16 v[210:211], v10 offset:4352
    ds_read_b64_tr_b16 v[212:213], v10 offset:64
    ds_read_b64_tr_b16 v[214:215], v10 offset:4416
    v_mfma_f32_32x32x16_bf16 v[96:111], v[232:235], v[244:247], v[96:111]
    ds_read_b64_tr_b16 v[216:217], v10 offset:128
    ds_read_b64_tr_b16 v[218:219], v10 offset:4480
    ds_read_b64_tr_b16 v[220:221], v10 offset:192
    v_mfma_f32_32x32x16_bf16 v[112:127], v[236:239], v[244:247], v[112:127]
    s_waitcnt lgkmcnt(5)
    ds_read_b64_tr_b16 v[222:223], v10 offset:4544
    ds_read_b64_tr_b16 v[224:225], v10 offset:256
    ds_read_b64_tr_b16 v[226:227], v10 offset:4608
    v_mfma_f32_32x32x16_bf16 v[64:79], v[208:211], v[240:243], v[64:79]
    s_waitcnt lgkmcnt(6)
    ds_read_b128 v[244:247], v12 offset:0
    ds_read_b64_tr_b16 v[228:229], v10 offset:320
    ds_read_b64_tr_b16 v[230:231], v10 offset:4672
    v_mfma_f32_32x32x16_bf16 v[80:95], v[212:215], v[240:243], v[80:95]
    s_waitcnt lgkmcnt(7)
    ds_read_b64_tr_b16 v[232:233], v10 offset:384
    ds_read_b64_tr_b16 v[234:235], v10 offset:4736
    ds_read_b64_tr_b16 v[236:237], v10 offset:448
    v_mfma_f32_32x32x16_bf16 v[96:111], v[216:219], v[240:243], v[96:111]
    s_waitcnt lgkmcnt(8)
    ds_read_b64_tr_b16 v[238:239], v10 offset:4800
    ds_read_b64_tr_b16 v[208:209], v10 offset:512
    ds_read_b64_tr_b16 v[210:211], v10 offset:4864
    v_mfma_f32_32x32x16_bf16 v[112:127], v[220:223], v[240:243], v[112:127]
    s_waitcnt lgkmcnt(8)
    ds_read_b64_tr_b16 v[212:213], v10 offset:576
    ds_read_b64_tr_b16 v[214:215], v10 offset:4928
    ds_read_b64_tr_b16 v[216:217], v10 offset:640
    v_mfma_f32_32x32x16_bf16 v[64:79], v[224:227], v[244:247], v[64:79]
    s_waitcnt lgkmcnt(9)
    ds_read_b128 v[240:243], v13 offset:0
    ds_read_b64_tr_b16 v[218:219], v10 offset:4992
    ds_read_b64_tr_b16 v[220:221], v10 offset:704
    v_mfma_f32_32x32x16_bf16 v[80:95], v[228:231], v[244:247], v[80:95]
    s_waitcnt lgkmcnt(10)
    ds_read_b64_tr_b16 v[222:223], v10 offset:5056
    ds_read_b64_tr_b16 v[224:225], v10 offset:768
    ds_read_b64_tr_b16 v[226:227], v10 offset:5120
    v_mfma_f32_32x32x16_bf16 v[96:111], v[232:235], v[244:247], v[96:111]
    s_waitcnt lgkmcnt(11)
    ds_read_b64_tr_b16 v[228:229], v10 offset:832
    ds_read_b64_tr_b16 v[230:231], v10 offset:5184
    v_mfma_f32_32x32x16_bf16 v[112:127], v[236:239], v[244:247], v[112:127]
    s_waitcnt lgkmcnt(7)
    ds_read_b64_tr_b16 v[232:233], v10 offset:896
    ds_read_b64_tr_b16 v[234:235], v10 offset:5248
    v_mfma_f32_32x32x16_bf16 v[64:79], v[208:211], v[240:243], v[64:79]
    ds_read_b128 v[244:247], v14 offset:0
    ds_read_b64_tr_b16 v[236:237], v10 offset:960
    ds_read_b64_tr_b16 v[238:239], v10 offset:5312
    v_mfma_f32_32x32x16_bf16 v[80:95], v[212:215], v[240:243], v[80:95]
    s_waitcnt lgkmcnt(11)
    v_mfma_f32_32x32x16_bf16 v[96:111], v[216:219], v[240:243], v[96:111]
    s_waitcnt lgkmcnt(9)
    v_mfma_f32_32x32x16_bf16 v[112:127], v[220:223], v[240:243], v[112:127]
    s_waitcnt lgkmcnt(0)
    v_mfma_f32_32x32x16_bf16 v[64:79], v[224:227], v[244:247], v[64:79]
    s_barrier
    ds_read_b128 v[240:243], v11 offset:12288
    ds_read_b64_tr_b16 v[208:209], v10 offset:17408
    v_mfma_f32_32x32x16_bf16 v[80:95], v[228:231], v[244:247], v[80:95]
    ds_read_b64_tr_b16 v[210:211], v10 offset:21760
    ds_read_b64_tr_b16 v[212:213], v10 offset:17472
    ds_read_b64_tr_b16 v[214:215], v10 offset:21824
    v_mfma_f32_32x32x16_bf16 v[96:111], v[232:235], v[244:247], v[96:111]
    ds_read_b64_tr_b16 v[216:217], v10 offset:17536
    ds_read_b64_tr_b16 v[218:219], v10 offset:21888
    ds_read_b64_tr_b16 v[220:221], v10 offset:17600
    v_mfma_f32_32x32x16_bf16 v[112:127], v[236:239], v[244:247], v[112:127]
    s_waitcnt lgkmcnt(5)
    ds_read_b64_tr_b16 v[222:223], v10 offset:21952
    ds_read_b64_tr_b16 v[224:225], v10 offset:17664
    ds_read_b64_tr_b16 v[226:227], v10 offset:22016
    v_mfma_f32_32x32x16_bf16 v[64:79], v[208:211], v[240:243], v[64:79]
    s_waitcnt lgkmcnt(6)
    ds_read_b128 v[244:247], v12 offset:12288
    ds_read_b64_tr_b16 v[228:229], v10 offset:17728
    ds_read_b64_tr_b16 v[230:231], v10 offset:22080
    v_mfma_f32_32x32x16_bf16 v[80:95], v[212:215], v[240:243], v[80:95]
    s_waitcnt lgkmcnt(7)
    ds_read_b64_tr_b16 v[232:233], v10 offset:17792
    ds_read_b64_tr_b16 v[234:235], v10 offset:22144
    ds_read_b64_tr_b16 v[236:237], v10 offset:17856
    v_mfma_f32_32x32x16_bf16 v[96:111], v[216:219], v[240:243], v[96:111]
    s_waitcnt lgkmcnt(8)
    ds_read_b64_tr_b16 v[238:239], v10 offset:22208
    ds_read_b64_tr_b16 v[208:209], v10 offset:17920
    ds_read_b64_tr_b16 v[210:211], v10 offset:22272
    v_mfma_f32_32x32x16_bf16 v[112:127], v[220:223], v[240:243], v[112:127]
    s_waitcnt lgkmcnt(8)
    ds_read_b64_tr_b16 v[212:213], v10 offset:17984
    ds_read_b64_tr_b16 v[214:215], v10 offset:22336
    ds_read_b64_tr_b16 v[216:217], v10 offset:18048
    v_mfma_f32_32x32x16_bf16 v[64:79], v[224:227], v[244:247], v[64:79]
    s_waitcnt lgkmcnt(9)
    ds_read_b128 v[240:243], v13 offset:12288
    ds_read_b64_tr_b16 v[218:219], v10 offset:22400
    ds_read_b64_tr_b16 v[220:221], v10 offset:18112
    v_mfma_f32_32x32x16_bf16 v[80:95], v[228:231], v[244:247], v[80:95]
    s_waitcnt lgkmcnt(10)
    ds_read_b64_tr_b16 v[222:223], v10 offset:22464
    ds_read_b64_tr_b16 v[224:225], v10 offset:18176
    ds_read_b64_tr_b16 v[226:227], v10 offset:22528
    v_mfma_f32_32x32x16_bf16 v[96:111], v[232:235], v[244:247], v[96:111]
    s_waitcnt lgkmcnt(11)
    ds_read_b64_tr_b16 v[228:229], v10 offset:18240
    ds_read_b64_tr_b16 v[230:231], v10 offset:22592
    v_mfma_f32_32x32x16_bf16 v[112:127], v[236:239], v[244:247], v[112:127]
    s_waitcnt lgkmcnt(7)
    ds_read_b64_tr_b16 v[232:233], v10 offset:18304
    ds_read_b64_tr_b16 v[234:235], v10 offset:22656
    v_mfma_f32_32x32x16_bf16 v[64:79], v[208:211], v[240:243], v[64:79]
    ds_read_b128 v[244:247], v14 offset:12288
    ds_read_b64_tr_b16 v[236:237], v10 offset:18368
    ds_read_b64_tr_b16 v[238:239], v10 offset:22720
    v_mfma_f32_32x32x16_bf16 v[80:95], v[212:215], v[240:243], v[80:95]
    s_waitcnt lgkmcnt(11)
    v_mfma_f32_32x32x16_bf16 v[96:111], v[216:219], v[240:243], v[96:111]
    s_waitcnt lgkmcnt(9)
    v_mfma_f32_32x32x16_bf16 v[112:127], v[220:223], v[240:243], v[112:127]
    s_waitcnt lgkmcnt(0)
    v_mfma_f32_32x32x16_bf16 v[64:79], v[224:227], v[244:247], v[64:79]
    s_barrier
    ds_read_b128 v[240:243], v252 offset:0
    ds_read_b64_tr_b16 v[208:209], v10 offset:34816
    v_mfma_f32_32x32x16_bf16 v[80:95], v[228:231], v[244:247], v[80:95]
    ds_read_b64_tr_b16 v[210:211], v10 offset:39168
    ds_read_b64_tr_b16 v[212:213], v10 offset:34880
    ds_read_b64_tr_b16 v[214:215], v10 offset:39232
    v_mfma_f32_32x32x16_bf16 v[96:111], v[232:235], v[244:247], v[96:111]
    ds_read_b64_tr_b16 v[216:217], v10 offset:34944
    ds_read_b64_tr_b16 v[218:219], v10 offset:39296
    ds_read_b64_tr_b16 v[220:221], v10 offset:35008
    v_mfma_f32_32x32x16_bf16 v[112:127], v[236:239], v[244:247], v[112:127]
    s_waitcnt lgkmcnt(5)
    ds_read_b64_tr_b16 v[222:223], v10 offset:39360
    ds_read_b64_tr_b16 v[224:225], v10 offset:35072
    ds_read_b64_tr_b16 v[226:227], v10 offset:39424
    v_mfma_f32_32x32x16_bf16 v[64:79], v[208:211], v[240:243], v[64:79]
    s_branch SK5
PAD5:
    s_branch BK5
SK5:
    s_waitcnt lgkmcnt(6)
    ds_read_b128 v[244:247], v253 offset:0
    ds_read_b64_tr_b16 v[228:229], v10 offset:35136
    ds_read_b64_tr_b16 v[230:231], v10 offset:39488
    v_mfma_f32_32x32x16_bf16 v[80:95], v[212:215], v[240:243], v[80:95]
    s_waitcnt lgkmcnt(7)
    ds_read_b64_tr_b16 v[232:233], v10 offset:35200
    ds_read_b64_tr_b16 v[234:235], v10 offset:39552
    ds_read_b64_tr_b16 v[236:237], v10 offset:35264
    v_mfma_f32_32x32x16_bf16 v[96:111], v[216:219], v[240:243], v[96:111]
    s_waitcnt lgkmcnt(8)
    ds_read_b64_tr_b16 v[238:239], v10 offset:39616
    ds_read_b64_tr_b16 v[208:209], v10 offset:35328
    ds_read_b64_tr_b16 v[210:211], v10 offset:39680
    v_mfma_f32_32x32x16_bf16 v[112:127], v[220:223], v[240:243], v[112:127]
    s_waitcnt lgkmcnt(8)
    ds_read_b64_tr_b16 v[212:213], v10 offset:35392
    ds_read_b64_tr_b16 v[214:215], v10 offset:39744
    ds_read_b64_tr_b16 v[216:217], v10 offset:35456
    v_mfma_f32_32x32x16_bf16 v[64:79], v[224:227], v[244:247], v[64:79]
    s_waitcnt lgkmcnt(9)
    ds_read_b128 v[240:243], v254 offset:0
    ds_read_b64_tr_b16 v[218:219], v10 offset:39808
    ds_read_b64_tr_b16 v[220:221], v10 offset:35520
    v_mfma_f32_32x32x16_bf16 v[80:95], v[228:231], v[244:247], v[80:95]
    s_waitcnt lgkmcnt(10)
    ds_read_b64_tr_b16 v[222:223], v10 offset:39872
    ds_read_b64_tr_b16 v[224:225], v10 offset:35584
    ds_read_b64_tr_b16 v[226:227], v10 offset:39936
    v_mfma_f32_32x32x16_bf16 v[96:111], v[232:235], v[244:247], v[96:111]
    s_waitcnt lgkmcnt(11)
    ds_read_b64_tr_b16 v[228:229], v10 offset:35648
    ds_read_b64_tr_b16 v[230:231], v10 offset:40000
    v_mfma_f32_32x32x16_bf16 v[112:127], v[236:239], v[244:247], v[112:127]
    s_waitcnt lgkmcnt(7)
    ds_read_b64_tr_b16 v[232:233], v10 offset:35712
    ds_read_b64_tr_b16 v[234:235], v10 offset:40064
    v_mfma_f32_32x32x16_bf16 v[64:79], v[208:211], v[240:243], v[64:79]
    ds_read_b128 v[244:247], v255 offset:0
    ds_read_b64_tr_b16 v[236:237], v10 offset:35776
    ds_read_b64_tr_b16 v[238:239], v10 offset:40128
    v_mfma_f32_32x32x16_bf16 v[80:95], v[212:215], v[240:243], v[80:95]
    s_waitcnt lgkmcnt(11)
    v_mfma_f32_32x32x16_bf16 v[96:111], v[216:219], v[240:243], v[96:111]
    s_waitcnt lgkmcnt(9)
    v_mfma_f32_32x32x16_bf16 v[112:127], v[220:223], v[240:243], v[112:127]
    s_waitcnt lgkmcnt(0)
    v_mfma_f32_32x32x16_bf16 v[64:79], v[224:227], v[244:247], v[64:79]
    s_barrier
    ds_read_b128 v[240:243], v252 offset:12288
    ds_read_b64_tr_b16 v[208:209], v10 offset:0
    v_mfma_f32_32x32x16_bf16 v[80:95], v[228:231], v[244:247], v[80:95]
    ds_read_b64_tr_b16 v[210:211], v10 offset:4352
    ds_read_b64_tr_b16 v[212:213], v10 offset:64
    ds_read_b64_tr_b16 v[214:215], v10 offset:4416
    v_mfma_f32_32x32x16_bf16 v[96:111], v[232:235], v[244:247], v[96:111]
    ds_read_b64_tr_b16 v[216:217], v10 offset:128
    ds_read_b64_tr_b16 v[218:219], v10 offset:4480
    ds_read_b64_tr_b16 v[220:221], v10 offset:192
    v_mfma_f32_32x32x16_bf16 v[112:127], v[236:239], v[244:247], v[112:127]
    s_waitcnt lgkmcnt(5)
    ds_read_b64_tr_b16 v[222:223], v10 offset:4544
    ds_read_b64_tr_b16 v[224:225], v10 offset:256
    ds_read_b64_tr_b16 v[226:227], v10 offset:4608
    v_mfma_f32_32x32x16_bf16 v[64:79], v[208:211], v[240:243], v[64:79]
    s_waitcnt lgkmcnt(6)
    ds_read_b128 v[244:247], v253 offset:12288
    ds_read_b64_tr_b16 v[228:229], v10 offset:320
    ds_read_b64_tr_b16 v[230:231], v10 offset:4672
    v_mfma_f32_32x32x16_bf16 v[80:95], v[212:215], v[240:243], v[80:95]
    s_waitcnt lgkmcnt(7)
    ds_read_b64_tr_b16 v[232:233], v10 offset:384
    ds_read_b64_tr_b16 v[234:235], v10 offset:4736
    ds_read_b64_tr_b16 v[236:237], v10 offset:448
    v_mfma_f32_32x32x16_bf16 v[96:111], v[216:219], v[240:243], v[96:111]
    s_waitcnt lgkmcnt(8)
    ds_read_b64_tr_b16 v[238:239], v10 offset:4800
    ds_read_b64_tr_b16 v[208:209], v10 offset:512
    ds_read_b64_tr_b16 v[210:211], v10 offset:4864
    v_mfma_f32_32x32x16_bf16 v[112:127], v[220:223], v[240:243], v[112:127]
    s_waitcnt lgkmcnt(8)
    ds_read_b64_tr_b16 v[212:213], v10 offset:576
    ds_read_b64_tr_b16 v[214:215], v10 offset:4928
    ds_read_b64_tr_b16 v[216:217], v10 offset:640
    v_mfma_f32_32x32x16_bf16 v[64:79], v[224:227], v[244:247], v[64:79]
    s_waitcnt lgkmcnt(9)
    ds_read_b128 v[240:243], v254 offset:12288
    ds_read_b64_tr_b16 v[218:219], v10 offset:4992
    ds_read_b64_tr_b16 v[220:221], v10 offset:704
    v_mfma_f32_32x32x16_bf16 v[80:95], v[228:231], v[244:247], v[80:95]
    s_waitcnt lgkmcnt(10)
    ds_read_b64_tr_b16 v[222:223], v10 offset:5056
    ds_read_b64_tr_b16 v[224:225], v10 offset:768
    ds_read_b64_tr_b16 v[226:227], v10 offset:5120
    v_mfma_f32_32x32x16_bf16 v[96:111], v[232:235], v[244:247], v[96:111]
    s_waitcnt lgkmcnt(11)
    ds_read_b64_tr_b16 v[228:229], v10 offset:832
    ds_read_b64_tr_b16 v[230:231], v10 offset:5184
    v_mfma_f32_32x32x16_bf16 v[112:127], v[236:239], v[244:247], v[112:127]
    s_waitcnt lgkmcnt(7)
    ds_read_b64_tr_b16 v[232:233], v10 offset:896
    ds_read_b64_tr_b16 v[234:235], v10 offset:5248
    v_mfma_f32_32x32x16_bf16 v[64:79], v[208:211], v[240:243], v[64:79]
    ds_read_b128 v[244:247], v255 offset:12288
    ds_read_b64_tr_b16 v[236:237], v10 offset:960
    ds_read_b64_tr_b16 v[238:239], v10 offset:5312
    v_mfma_f32_32x32x16_bf16 v[80:95], v[212:215], v[240:243], v[80:95]
    s_waitcnt lgkmcnt(11)
    v_mfma_f32_32x32x16_bf16 v[96:111], v[216:219], v[240:243], v[96:111]
    s_waitcnt lgkmcnt(9)
    v_mfma_f32_32x32x16_bf16 v[112:127], v[220:223], v[240:243], v[112:127]
    s_waitcnt lgkmcnt(0)
    v_mfma_f32_32x32x16_bf16 v[64:79], v[224:227], v[244:247], v[64:79]
    s_barrier
    ds_read_b128 v[240:243], v11 offset:0
    ds_read_b64_tr_b16 v[208:209], v10 offset:17408
    v_mfma_f32_32x32x16_bf16 v[80:95], v[228:231], v[244:247], v[80:95]
    ds_read_b64_tr_b16 v[210:211], v10 offset:21760
    ds_read_b64_tr_b16 v[212:213], v10 offset:17472
    ds_read_b64_tr_b16 v[214:215], v10 offset:21824
    v_mfma_f32_32x32x16_bf16 v[96:111], v[232:235], v[244:247], v[96:111]
    ds_read_b64_tr_b16 v[216:217], v10 offset:17536
    ds_read_b64_tr_b16 v[218:219], v10 offset:21888
    ds_read_b64_tr_b16 v[220:221], v10 offset:17600
    v_mfma_f32_32x32x16_bf16 v[112:127], v[236:239], v[244:247], v[112:127]
    s_waitcnt lgkmcnt(5)
    ds_read_b64_tr_b16 v[222:223], v10 offset:21952
    ds_read_b64_tr_b16 v[224:225], v10 offset:17664
    ds_read_b64_tr_b16 v[226:227], v10 offset:22016
    v_mfma_f32_32x32x16_bf16 v[64:79], v[208:211], v[240:243], v[64:79]
    s_waitcnt lgkmcnt(6)
    ds_read_b128 v[244:247], v12 offset:0
    ds_read_b64_tr_b16 v[228:229], v10 offset:17728
    ds_read_b64_tr_b16 v[230:231], v10 offset:22080
    v_mfma_f32_32x32x16_bf16 v[80:95], v[212:215], v[240:243], v[80:95]
    s_waitcnt lgkmcnt(7)
    ds_read_b64_tr_b16 v[232:233], v10 offset:17792
    ds_read_b64_tr_b16 v[234:235], v10 offset:22144
    ds_read_b64_tr_b16 v[236:237], v10 offset:17856
    v_mfma_f32_32x32x16_bf16 v[96:111], v[216:219], v[240:243], v[96:111]
    s_waitcnt lgkmcnt(8)
    ds_read_b64_tr_b16 v[238:239], v10 offset:22208
    ds_read_b64_tr_b16 v[208:209], v10 offset:17920
    ds_read_b64_tr_b16 v[210:211], v10 offset:22272
    v_mfma_f32_32x32x16_bf16 v[112:127], v[220:223], v[240:243], v[112:127]
    s_waitcnt lgkmcnt(8)
    ds_read_b64_tr_b16 v[212:213], v10 offset:17984
    ds_read_b64_tr_b16 v[214:215], v10 offset:22336
    ds_read_b64_tr_b16 v[216:217], v10 offset:18048
    v_mfma_f32_32x32x16_bf16 v[64:79], v[224:227], v[244:247], v[64:79]
    s_waitcnt lgkmcnt(9)
    ds_read_b128 v[240:243], v13 offset:0
    ds_read_b64_tr_b16 v[218:219], v10 offset:22400
    ds_read_b64_tr_b16 v[220:221], v10 offset:18112
    v_mfma_f32_32x32x16_bf16 v[80:95], v[228:231], v[244:247], v[80:95]
    s_waitcnt lgkmcnt(10)
    ds_read_b64_tr_b16 v[222:223], v10 offset:22464
    ds_read_b64_tr_b16 v[224:225], v10 offset:18176
    ds_read_b64_tr_b16 v[226:227], v10 offset:22528
    v_mfma_f32_32x32x16_bf16 v[96:111], v[232:235], v[244:247], v[96:111]
    s_waitcnt lgkmcnt(11)
    ds_read_b64_tr_b16 v[228:229], v10 offset:18240
    ds_read_b64_tr_b16 v[230:231], v10 offset:22592
    v_mfma_f32_32x32x16_bf16 v[112:127], v[236:239], v[244:247], v[112:127]
    s_waitcnt lgkmcnt(7)
    ds_read_b64_tr_b16 v[232:233], v10 offset:18304
    ds_read_b64_tr_b16 v[234:235], v10 offset:22656
    v_mfma_f32_32x32x16_bf16 v[64:79], v[208:211], v[240:243], v[64:79]
    ds_read_b128 v[244:247], v14 offset:0
    ds_read_b64_tr_b16 v[236:237], v10 offset:18368
    ds_read_b64_tr_b16 v[238:239], v10 offset:22720
    v_mfma_f32_32x32x16_bf16 v[80:95], v[212:215], v[240:243], v[80:95]
    s_waitcnt lgkmcnt(11)
    v_mfma_f32_32x32x16_bf16 v[96:111], v[216:219], v[240:243], v[96:111]
    s_waitcnt lgkmcnt(9)
    v_mfma_f32_32x32x16_bf16 v[112:127], v[220:223], v[240:243], v[112:127]
    s_waitcnt lgkmcnt(0)
    v_mfma_f32_32x32x16_bf16 v[64:79], v[224:227], v[244:247], v[64:79]
    s_barrier
    ds_read_b128 v[240:243], v11 offset:12288
    ds_read_b64_tr_b16 v[208:209], v10 offset:34816
    v_mfma_f32_32x32x16_bf16 v[80:95], v[228:231], v[244:247], v[80:95]
    ds_read_b64_tr_b16 v[210:211], v10 offset:39168
    ds_read_b64_tr_b16 v[212:213], v10 offset:34880
    ds_read_b64_tr_b16 v[214:215], v10 offset:39232
    v_mfma_f32_32x32x16_bf16 v[96:111], v[232:235], v[244:247], v[96:111]
    ds_read_b64_tr_b16 v[216:217], v10 offset:34944
    ds_read_b64_tr_b16 v[218:219], v10 offset:39296
    ds_read_b64_tr_b16 v[220:221], v10 offset:35008
    v_mfma_f32_32x32x16_bf16 v[112:127], v[236:239], v[244:247], v[112:127]
    s_waitcnt lgkmcnt(5)
    ds_read_b64_tr_b16 v[222:223], v10 offset:39360
    ds_read_b64_tr_b16 v[224:225], v10 offset:35072
    ds_read_b64_tr_b16 v[226:227], v10 offset:39424
    v_mfma_f32_32x32x16_bf16 v[64:79], v[208:211], v[240:243], v[64:79]
    s_waitcnt lgkmcnt(6)
    ds_read_b128 v[244:247], v12 offset:12288
    ds_read_b64_tr_b16 v[228:229], v10 offset:35136
    ds_read_b64_tr_b16 v[230:231], v10 offset:39488
    v_mfma_f32_32x32x16_bf16 v[80:95], v[212:215], v[240:243], v[80:95]
    s_waitcnt lgkmcnt(7)
    ds_read_b64_tr_b16 v[232:233], v10 offset:35200
    ds_read_b64_tr_b16 v[234:235], v10 offset:39552
    ds_read_b64_tr_b16 v[236:237], v10 offset:35264
    v_mfma_f32_32x32x16_bf16 v[96:111], v[216:219], v[240:243], v[96:111]
    s_waitcnt lgkmcnt(8)
    ds_read_b64_tr_b16 v[238:239], v10 offset:39616
    ds_read_b64_tr_b16 v[208:209], v10 offset:35328
    ds_read_b64_tr_b16 v[210:211], v10 offset:39680
    v_mfma_f32_32x32x16_bf16 v[112:127], v[220:223], v[240:243], v[112:127]
    s_waitcnt lgkmcnt(8)
    ds_read_b64_tr_b16 v[212:213], v10 offset:35392
    ds_read_b64_tr_b16 v[214:215], v10 offset:39744
    ds_read_b64_tr_b16 v[216:217], v10 offset:35456
    v_mfma_f32_32x32x16_bf16 v[64:79], v[224:227], v[244:247], v[64:79]
    s_waitcnt lgkmcnt(9)
    ds_read_b128 v[240:243], v13 offset:12288
    ds_read_b64_tr_b16 v[218:219], v10 offset:39808
    ds_read_b64_tr_b16 v[220:221], v10 offset:35520
    v_mfma_f32_32x32x16_bf16 v[80:95], v[228:231], v[244:247], v[80:95]
    s_waitcnt lgkmcnt(10)
    ds_read_b64_tr_b16 v[222:223], v10 offset:39872
    ds_read_b64_tr_b16 v[224:225], v10 offset:35584
    ds_read_b64_tr_b16 v[226:227], v10 offset:39936
    v_mfma_f32_32x32x16_bf16 v[96:111], v[232:235], v[244:247], v[96:111]
    s_waitcnt lgkmcnt(11)
    ds_read_b64_tr_b16 v[228:229], v10 offset:35648
    ds_read_b64_tr_b16 v[230:231], v10 offset:40000
    v_mfma_f32_32x32x16_bf16 v[112:127], v[236:239], v[244:247], v[112:127]
    s_waitcnt lgkmcnt(7)
    ds_read_b64_tr_b16 v[232:233], v10 offset:35712
    ds_read_b64_tr_b16 v[234:235], v10 offset:40064
    v_mfma_f32_32x32x16_bf16 v[64:79], v[208:211], v[240:243], v[64:79]
    ds_read_b128 v[244:247], v14 offset:12288
    ds_read_b64_tr_b16 v[236:237], v10 offset:35776
    ds_read_b64_tr_b16 v[238:239], v10 offset:40128
    v_mfma_f32_32x32x16_bf16 v[80:95], v[212:215], v[240:243], v[80:95]
    s_waitcnt lgkmcnt(11)
    v_mfma_f32_32x32x16_bf16 v[96:111], v[216:219], v[240:243], v[96:111]
    s_waitcnt lgkmcnt(9)
    v_mfma_f32_32x32x16_bf16 v[112:127], v[220:223], v[240:243], v[112:127]
    s_waitcnt lgkmcnt(0)
    s_mov_b32 s64, 0
    s_mov_b32 s65, 26112
    s_mov_b32 s66, 0
    v_mfma_f32_32x32x16_bf16 v[64:79], v[224:227], v[244:247], v[64:79]
    s_barrier
    ds_read_b128 v[176:179], v2 offset:25344
    ds_read_b128 v[180:183], v2 offset:25376
    ds_read_b128 v[184:187], v2 offset:25408
    v_mfma_f32_32x32x16_bf16 v[80:95], v[228:231], v[244:247], v[80:95]
    ds_read_b128 v[188:191], v2 offset:25440
    ds_read_b128 v[192:195], v2 offset:25472
    ds_read_b128 v[196:199], v2 offset:25504
    v_mfma_f32_32x32x16_bf16 v[96:111], v[232:235], v[244:247], v[96:111]
    ds_read_b128 v[200:203], v2 offset:25536
    ds_read_b128 v[204:207], v2 offset:25568
    v_mfma_f32_32x32x16_bf16 v[112:127], v[236:239], v[244:247], v[112:127]
    s_nop 1
    v_pk_mul_f32 v[64:65], v[64:65], s[70:71]
    v_pk_mul_f32 v[66:67], v[66:67], s[70:71]
    v_pk_mul_f32 v[68:69], v[68:69], s[70:71]
    v_pk_mul_f32 v[70:71], v[70:71], s[70:71]
    v_cvt_pk_bf16_f32 v32, v64, v65
    v_cvt_pk_bf16_f32 v33, v66, v67
    v_cvt_pk_bf16_f32 v34, v68, v69
    v_cvt_pk_bf16_f32 v35, v70, v71
    s_waitcnt lgkmcnt(0)
    s_nop 0
    v_mfma_f32_32x32x16_bf16 v[128:143], v[176:179], v[32:35], 0
    s_barrier
    global_load_ushort v15, v15, s[16:17] offset:64 sc1
    v_pk_mul_f32 v[72:73], v[72:73], s[70:71]
    v_pk_mul_f32 v[74:75], v[74:75], s[70:71]
    v_pk_mul_f32 v[76:77], v[76:77], s[70:71]
    v_pk_mul_f32 v[78:79], v[78:79], s[70:71]
    v_cvt_pk_bf16_f32 v36, v72, v73
    v_cvt_pk_bf16_f32 v37, v74, v75
    v_cvt_pk_bf16_f32 v38, v76, v77
    v_cvt_pk_bf16_f32 v39, v78, v79
    s_nop 1
    v_mfma_f32_32x32x16_bf16 v[128:143], v[180:183], v[36:39], v[128:143]
    ds_read_b128 v[176:179], v2 offset:33792
    v_pk_mul_f32 v[80:81], v[80:81], s[70:71]
    v_pk_mul_f32 v[82:83], v[82:83], s[70:71]
    v_pk_mul_f32 v[84:85], v[84:85], s[70:71]
    v_pk_mul_f32 v[86:87], v[86:87], s[70:71]
    v_cvt_pk_bf16_f32 v40, v80, v81
    v_cvt_pk_bf16_f32 v41, v82, v83
    v_cvt_pk_bf16_f32 v42, v84, v85
    v_cvt_pk_bf16_f32 v43, v86, v87
    s_nop 1
    v_mfma_f32_32x32x16_bf16 v[128:143], v[184:187], v[40:43], v[128:143]
    ds_read_b128 v[180:183], v2 offset:33824
    v_pk_mul_f32 v[88:89], v[88:89], s[70:71]
    v_pk_mul_f32 v[90:91], v[90:91], s[70:71]
    v_pk_mul_f32 v[92:93], v[92:93], s[70:71]
    v_pk_mul_f32 v[94:95], v[94:95], s[70:71]
    v_cvt_pk_bf16_f32 v44, v88, v89
    v_cvt_pk_bf16_f32 v45, v90, v91
    v_cvt_pk_bf16_f32 v46, v92, v93
    v_cvt_pk_bf16_f32 v47, v94, v95
    s_nop 1
    v_mfma_f32_32x32x16_bf16 v[128:143], v[188:191], v[44:47], v[128:143]
    ds_read_b128 v[184:187], v2 offset:33856
    v_pk_mul_f32 v[96:97], v[96:97], s[70:71]
    v_pk_mul_f32 v[98:99], v[98:99], s[70:71]
    v_pk_mul_f32 v[100:101], v[100:101], s[70:71]
    v_pk_mul_f32 v[102:103], v[102:103], s[70:71]
    v_cvt_pk_bf16_f32 v48, v96, v97
    v_cvt_pk_bf16_f32 v49, v98, v99
    v_cvt_pk_bf16_f32 v50, v100, v101
    v_cvt_pk_bf16_f32 v51, v102, v103
    s_nop 1
    v_mfma_f32_32x32x16_bf16 v[128:143], v[192:195], v[48:51], v[128:143]
    ds_read_b128 v[188:191], v2 offset:33888
    v_pk_mul_f32 v[104:105], v[104:105], s[70:71]
    v_pk_mul_f32 v[106:107], v[106:107], s[70:71]
    v_pk_mul_f32 v[108:109], v[108:109], s[70:71]
    v_pk_mul_f32 v[110:111], v[110:111], s[70:71]
    v_cvt_pk_bf16_f32 v52, v104, v105
    v_cvt_pk_bf16_f32 v53, v106, v107
    v_cvt_pk_bf16_f32 v54, v108, v109
    v_cvt_pk_bf16_f32 v55, v110, v111
    s_nop 1
    v_mfma_f32_32x32x16_bf16 v[128:143], v[196:199], v[52:55], v[128:143]
    ds_read_b128 v[192:195], v2 offset:33920
    v_pk_mul_f32 v[112:113], v[112:113], s[70:71]
    v_pk_mul_f32 v[114:115], v[114:115], s[70:71]
    v_pk_mul_f32 v[116:117], v[116:117], s[70:71]
    v_pk_mul_f32 v[118:119], v[118:119], s[70:71]
    v_cvt_pk_bf16_f32 v56, v112, v113
    v_cvt_pk_bf16_f32 v57, v114, v115
    v_cvt_pk_bf16_f32 v58, v116, v117
    v_cvt_pk_bf16_f32 v59, v118, v119
    s_nop 1
    v_mfma_f32_32x32x16_bf16 v[128:143], v[200:203], v[56:59], v[128:143]
    ds_read_b128 v[196:199], v2 offset:33952
    v_pk_mul_f32 v[120:121], v[120:121], s[70:71]
    v_pk_mul_f32 v[122:123], v[122:123], s[70:71]
    v_pk_mul_f32 v[124:125], v[124:125], s[70:71]
    v_pk_mul_f32 v[126:127], v[126:127], s[70:71]
    v_cvt_pk_bf16_f32 v60, v120, v121
    v_cvt_pk_bf16_f32 v61, v122, v123
    v_cvt_pk_bf16_f32 v62, v124, v125
    v_cvt_pk_bf16_f32 v63, v126, v127
    s_nop 1
    v_mfma_f32_32x32x16_bf16 v[128:143], v[204:207], v[60:63], v[128:143]
    ds_read_b128 v[200:203], v2 offset:33984
    v_add_u32 v10, s64, v2
    v_add_u32 v11, s65, v3
    s_nop 1
    ds_read_b128 v[204:207], v2 offset:34016
ATT:
    s_nop 6
    v_max3_f32 v8, v128, v129, v130
    v_max3_f32 v9, v131, v132, v133
    v_max3_f32 v8, v8, v134, v135
    v_max3_f32 v9, v9, v136, v137
    v_max3_f32 v8, v8, v138, v139
    v_max3_f32 v9, v9, v140, v141
    v_max3_f32 v8, v8, v142, v143
    v_max_f32 v8, v8, v9
    v_mov_b32 v9, v8
    s_nop 1
    v_permlane32_swap_b32 v9, v8
    s_nop 1
    v_max_f32 v8, v8, v9
    v_sub_f32 v8, 0, v8
    v_mov_b32 v9, v8
    v_mov_b64 v[160:161], v[8:9]
    v_mov_b64 v[162:163], v[8:9]
    v_mov_b64 v[164:165], v[8:9]
    v_mov_b64 v[166:167], v[8:9]
    v_mov_b64 v[168:169], v[8:9]
    v_mov_b64 v[170:171], v[8:9]
    v_mov_b64 v[172:173], v[8:9]
    v_mov_b64 v[174:175], v[8:9]
    v_pk_add_f32 v[128:129], v[128:129], v[8:9]
    v_pk_add_f32 v[130:131], v[130:131], v[8:9]
    v_pk_add_f32 v[132:133], v[132:133], v[8:9]
    v_pk_add_f32 v[134:135], v[134:135], v[8:9]
    v_pk_add_f32 v[136:137], v[136:137], v[8:9]
    v_pk_add_f32 v[138:139], v[138:139], v[8:9]
    v_pk_add_f32 v[140:141], v[140:141], v[8:9]
    v_pk_add_f32 v[142:143], v[142:143], v[8:9]
    v_exp_f32 v16, v128
    s_waitcnt lgkmcnt(0)
    s_add_u32 s64, s64, 8448
    s_cmp_eq_u32 s64, 42240
    s_cselect_b32 s64, 0, s64
    v_mfma_f32_32x32x16_bf16 v[144:159], v[176:179], v[32:35], v[160:175]
    s_barrier
    v_exp_f32 v17, v129
    v_exp_f32 v18, v130
    v_add_f32 v6, v16, v17
    v_cvt_pk_bf16_f32 v24, v16, v17
    v_mfma_f32_32x32x16_bf16 v[144:159], v[180:183], v[36:39], v[144:159]
    ds_read_b128 v[176:179], v10 offset:0
    v_exp_f32 v19, v131
    v_add_f32 v6, v6, v18
    v_exp_f32 v20, v132
    v_add_f32 v6, v6, v19
    v_mfma_f32_32x32x16_bf16 v[144:159], v[184:187], v[40:43], v[144:159]
    ds_read_b128 v[180:183], v10 offset:32
    v_cvt_pk_bf16_f32 v25, v18, v19
    v_exp_f32 v21, v133
    v_add_f32 v6, v6, v20
    v_exp_f32 v22, v134
    v_mfma_f32_32x32x16_bf16 v[144:159], v[188:191], v[44:47], v[144:159]
    ds_read_b128 v[184:187], v10 offset:64
    v_add_f32 v6, v6, v21
    v_cvt_pk_bf16_f32 v26, v20, v21
    v_exp_f32 v23, v135
    v_add_f32 v6, v6, v22
    v_mfma_f32_32x32x16_bf16 v[144:159], v[192:195], v[48:51], v[144:159]
    ds_read_b128 v[188:191], v10 offset:96
    v_exp_f32 v16, v136
    v_add_f32 v6, v6, v23
    v_cvt_pk_bf16_f32 v27, v22, v23
    v_exp_f32 v17, v137
    v_mfma_f32_32x32x16_bf16 v[144:159], v[196:199], v[52:55], v[144:159]
    ds_read_b128 v[192:195], v10 offset:128
    v_add_f32 v6, v6, v16
    v_exp_f32 v18, v138
    v_add_f32 v6, v6, v17
    v_cvt_pk_bf16_f32 v28, v16, v17
    v_mfma_f32_32x32x16_bf16 v[144:159], v[200:203], v[56:59], v[144:159]
    ds_read_b128 v[196:199], v10 offset:160
    v_exp_f32 v19, v139
    v_add_f32 v6, v6, v18
    v_exp_f32 v20, v140
    v_add_f32 v6, v6, v19
    v_mfma_f32_32x32x16_bf16 v[144:159], v[204:207], v[60:63], v[144:159]
    ds_read_b128 v[200:203], v10 offset:192
    v_cvt_pk_bf16_f32 v29, v18, v19
    v_exp_f32 v21, v141
    v_add_f32 v6, v6, v20
    v_exp_f32 v22, v142
    v_add_f32 v6, v6, v21
    v_cvt_pk_bf16_f32 v30, v20, v21
    v_exp_f32 v23, v143
    v_add_f32 v6, v6, v22
    v_add_f32 v6, v6, v23
    v_cvt_pk_bf16_f32 v31, v22, v23
    ds_read_b128 v[204:207], v10 offset:224
    v_mov_b32 v4, v6
    v_add_u32 v10, s64, v2
    s_waitcnt lgkmcnt(0)
    s_barrier
    v_exp_f32 v16, v144
    v_mfma_f32_32x32x16_bf16 v[128:143], v[176:179], v[32:35], v[160:175]
    ds_read_b64_tr_b16 v[208:209], v11 offset:0
    ds_read_b64_tr_b16 v[210:211], v11 offset:256
    v_exp_f32 v17, v145
    v_exp_f32 v18, v146
    v_mfma_f32_32x32x16_bf16 v[128:143], v[180:183], v[36:39], v[128:143]
    ds_read_b64_tr_b16 v[212:213], v11 offset:64
    ds_read_b64_tr_b16 v[214:215], v11 offset:320
    v_add_f32 v6, v16, v17
    v_cvt_pk_bf16_f32 v240, v16, v17
    v_exp_f32 v19, v147
    v_mfma_f32_32x32x16_bf16 v[128:143], v[184:187], v[40:43], v[128:143]
    ds_read_b64_tr_b16 v[216:217], v11 offset:128
    ds_read_b64_tr_b16 v[218:219], v11 offset:384
    v_add_f32 v6, v6, v18
    v_exp_f32 v20, v148
    v_add_f32 v6, v6, v19
    v_mfma_f32_32x32x16_bf16 v[128:143], v[188:191], v[44:47], v[128:143]
    ds_read_b64_tr_b16 v[220:221], v11 offset:192
    ds_read_b64_tr_b16 v[222:223], v11 offset:448
    v_cvt_pk_bf16_f32 v241, v18, v19
    v_exp_f32 v21, v149
    v_add_f32 v6, v6, v20
    v_mfma_f32_32x32x16_bf16 v[128:143], v[192:195], v[48:51], v[128:143]
    ds_read_b64_tr_b16 v[224:225], v11 offset:512
    ds_read_b64_tr_b16 v[226:227], v11 offset:768
    v_exp_f32 v22, v150
    v_add_f32 v6, v6, v21
    v_cvt_pk_bf16_f32 v242, v20, v21
    v_mfma_f32_32x32x16_bf16 v[128:143], v[196:199], v[52:55], v[128:143]
    ds_read_b64_tr_b16 v[228:229], v11 offset:576
    ds_read_b64_tr_b16 v[230:231], v11 offset:832
    s_add_u32 s65, s65, 8704
    s_cmp_eq_u32 s65, 43520
    s_cselect_b32 s65, 0, s65
    v_exp_f32 v23, v151
    v_add_f32 v6, v6, v22
    v_mfma_f32_32x32x16_bf16 v[128:143], v[200:203], v[56:59], v[128:143]
    ds_read_b64_tr_b16 v[232:233], v11 offset:640
    ds_read_b64_tr_b16 v[234:235], v11 offset:896
    v_exp_f32 v16, v152
    v_add_f32 v6, v6, v23
    v_cvt_pk_bf16_f32 v243, v22, v23
    v_mfma_f32_32x32x16_bf16 v[128:143], v[204:207], v[60:63], v[128:143]
    s_waitcnt lgkmcnt(6)
    ds_read_b64_tr_b16 v[236:237], v11 offset:704
    ds_read_b64_tr_b16 v[238:239], v11 offset:960
    s_add_u32 s64, s64, 8448
    s_cmp_eq_u32 s64, 42240
    s_cselect_b32 s64, 0, s64
    v_exp_f32 v17, v153
    v_add_f32 v6, v6, v16
    v_mfma_f32_32x32x16_bf16 v[64:79], v[208:211], v[24:27], 0
    ds_read_b128 v[176:179], v10 offset:0
    ds_read_b128 v[180:183], v10 offset:32
    v_exp_f32 v18, v154
    v_add_f32 v6, v6, v17
    v_cvt_pk_bf16_f32 v244, v16, v17
    v_mfma_f32_32x32x16_bf16 v[80:95], v[212:215], v[24:27], 0
    ds_read_b128 v[184:187], v10 offset:64
    ds_read_b128 v[188:191], v10 offset:96
    v_add_u32 v11, s65, v3
    v_exp_f32 v19, v155
    v_add_f32 v6, v6, v18
    v_mfma_f32_32x32x16_bf16 v[96:111], v[216:219], v[24:27], 0
    ds_read_b128 v[192:195], v10 offset:128
    ds_read_b128 v[196:199], v10 offset:160
    v_exp_f32 v20, v156
    v_add_f32 v6, v6, v19
    v_cvt_pk_bf16_f32 v245, v18, v19
    v_mfma_f32_32x32x16_bf16 v[112:127], v[220:223], v[24:27], 0
    s_waitcnt lgkmcnt(6)
    ds_read_b128 v[200:203], v10 offset:192
    ds_read_b128 v[204:207], v10 offset:224
    v_exp_f32 v21, v157
    v_add_f32 v6, v6, v20
    v_mfma_f32_32x32x16_bf16 v[64:79], v[224:227], v[28:31], v[64:79]
    v_exp_f32 v22, v158
    v_add_f32 v6, v6, v21
    v_cvt_pk_bf16_f32 v246, v20, v21
    v_exp_f32 v23, v159
    v_mfma_f32_32x32x16_bf16 v[80:95], v[228:231], v[28:31], v[80:95]
    v_add_f32 v6, v6, v22
    v_add_f32 v6, v6, v23
    v_cmp_lt_f32 vcc, s68, v6
    v_cvt_pk_bf16_f32 v247, v22, v23
    v_mfma_f32_32x32x16_bf16 v[96:111], v[232:235], v[28:31], v[96:111]
    v_add_u32 v10, s64, v2
    s_waitcnt lgkmcnt(0)
    s_barrier
    v_mfma_f32_32x32x16_bf16 v[112:127], v[236:239], v[28:31], v[112:127]
    s_cbranch_vccnz R1_0
R1_0_back:
    v_add_f32 v4, v4, v6
    v_exp_f32 v16, v128
ATT_l:
    v_mfma_f32_32x32x16_bf16 v[144:159], v[176:179], v[32:35], v[160:175]
    ds_read_b64_tr_b16 v[208:209], v11 offset:0
    ds_read_b64_tr_b16 v[210:211], v11 offset:256
    v_exp_f32 v17, v129
    v_exp_f32 v18, v130
    v_mfma_f32_32x32x16_bf16 v[144:159], v[180:183], v[36:39], v[144:159]
    ds_read_b64_tr_b16 v[212:213], v11 offset:64
    ds_read_b64_tr_b16 v[214:215], v11 offset:320
    v_add_f32 v6, v16, v17
    v_cvt_pk_bf16_f32 v24, v16, v17
    v_exp_f32 v19, v131
    v_mfma_f32_32x32x16_bf16 v[144:159], v[184:187], v[40:43], v[144:159]
    ds_read_b64_tr_b16 v[216:217], v11 offset:128
    ds_read_b64_tr_b16 v[218:219], v11 offset:384
    v_add_f32 v6, v6, v18
    v_exp_f32 v20, v132
    v_add_f32 v6, v6, v19
    v_mfma_f32_32x32x16_bf16 v[144:159], v[188:191], v[44:47], v[144:159]
    ds_read_b64_tr_b16 v[220:221], v11 offset:192
    ds_read_b64_tr_b16 v[222:223], v11 offset:448
    v_cvt_pk_bf16_f32 v25, v18, v19
    v_exp_f32 v21, v133
    v_add_f32 v6, v6, v20
    v_mfma_f32_32x32x16_bf16 v[144:159], v[192:195], v[48:51], v[144:159]
    ds_read_b64_tr_b16 v[224:225], v11 offset:512
    ds_read_b64_tr_b16 v[226:227], v11 offset:768
    v_exp_f32 v22, v134
    v_add_f32 v6, v6, v21
    v_cvt_pk_bf16_f32 v26, v20, v21
    v_mfma_f32_32x32x16_bf16 v[144:159], v[196:199], v[52:55], v[144:159]
    ds_read_b64_tr_b16 v[228:229], v11 offset:576
    ds_read_b64_tr_b16 v[230:231], v11 offset:832
    s_add_u32 s65, s65, 8704
    s_cmp_eq_u32 s65, 43520
    s_cselect_b32 s65, 0, s65
    v_exp_f32 v23, v135
    v_add_f32 v6, v6, v22
    v_mfma_f32_32x32x16_bf16 v[144:159], v[200:203], v[56:59], v[144:159]
    ds_read_b64_tr_b16 v[232:233], v11 offset:640
    ds_read_b64_tr_b16 v[234:235], v11 offset:896
    v_exp_f32 v16, v136
    v_add_f32 v6, v6, v23
    v_cvt_pk_bf16_f32 v27, v22, v23
    v_mfma_f32_32x32x16_bf16 v[144:159], v[204:207], v[60:63], v[144:159]
    s_waitcnt lgkmcnt(6)
    ds_read_b64_tr_b16 v[236:237], v11 offset:704
    ds_read_b64_tr_b16 v[238:239], v11 offset:960
    s_add_u32 s64, s64, 8448
    s_cmp_eq_u32 s64, 42240
    s_cselect_b32 s64, 0, s64
    v_exp_f32 v17, v137
    v_add_f32 v6, v6, v16
    v_mfma_f32_32x32x16_bf16 v[64:79], v[208:211], v[240:243], v[64:79]
    ds_read_b128 v[176:179], v10 offset:0
    ds_read_b128 v[180:183], v10 offset:32
    v_exp_f32 v18, v138
    v_add_f32 v6, v6, v17
    v_cvt_pk_bf16_f32 v28, v16, v17
    v_mfma_f32_32x32x16_bf16 v[80:95], v[212:215], v[240:243], v[80:95]
    ds_read_b128 v[184:187], v10 offset:64
    ds_read_b128 v[188:191], v10 offset:96
    s_branch SK6
PAD6:
    s_branch BK6
SK6:
    v_add_u32 v11, s65, v3
    v_exp_f32 v19, v139
    v_add_f32 v6, v6, v18
    v_mfma_f32_32x32x16_bf16 v[96:111], v[216:219], v[240:243], v[96:111]
    ds_read_b128 v[192:195], v10 offset:128
    ds_read_b128 v[196:199], v10 offset:160
    v_exp_f32 v20, v140
    v_add_f32 v6, v6, v19
    v_cvt_pk_bf16_f32 v29, v18, v19
    v_mfma_f32_32x32x16_bf16 v[112:127], v[220:223], v[240:243], v[112:127]
    s_waitcnt lgkmcnt(6)
    ds_read_b128 v[200:203], v10 offset:192
    ds_read_b128 v[204:207], v10 offset:224
    v_exp_f32 v21, v141
    v_add_f32 v6, v6, v20
    v_mfma_f32_32x32x16_bf16 v[64:79], v[224:227], v[244:247], v[64:79]
    v_exp_f32 v22, v142
    v_add_f32 v6, v6, v21
    v_cvt_pk_bf16_f32 v30, v20, v21
    v_exp_f32 v23, v143
    v_mfma_f32_32x32x16_bf16 v[80:95], v[228:231], v[244:247], v[80:95]
    v_add_f32 v6, v6, v22
    v_add_f32 v6, v6, v23
    v_cmp_lt_f32 vcc, s68, v6
    v_cvt_pk_bf16_f32 v31, v22, v23
    v_mfma_f32_32x32x16_bf16 v[96:111], v[232:235], v[244:247], v[96:111]
    v_add_u32 v10, s64, v2
    s_add_u32 s66, s66, 1
    s_cmp_eq_u32 s66, 7
    s_waitcnt lgkmcnt(0)
    s_barrier
    v_mfma_f32_32x32x16_bf16 v[112:127], v[236:239], v[244:247], v[112:127]
    s_cbranch_vccnz R0_0
R0_0_back:
    v_add_f32 v4, v4, v6
    v_exp_f32 v16, v144
    s_cbranch_scc1 ATT_x
    v_mfma_f32_32x32x16_bf16 v[128:143], v[176:179], v[32:35], v[160:175]
    ds_read_b64_tr_b16 v[208:209], v11 offset:0
    ds_read_b64_tr_b16 v[210:211], v11 offset:256
    v_exp_f32 v17, v145
    v_exp_f32 v18, v146
    v_mfma_f32_32x32x16_bf16 v[128:143], v[180:183], v[36:39], v[128:143]
    ds_read_b64_tr_b16 v[212:213], v11 offset:64
    ds_read_b64_tr_b16 v[214:215], v11 offset:320
    v_add_f32 v6, v16, v17
    v_cvt_pk_bf16_f32 v240, v16, v17
    v_exp_f32 v19, v147
    v_mfma_f32_32x32x16_bf16 v[128:143], v[184:187], v[40:43], v[128:143]
    ds_read_b64_tr_b16 v[216:217], v11 offset:128
    ds_read_b64_tr_b16 v[218:219], v11 offset:384
    v_add_f32 v6, v6, v18
    v_exp_f32 v20, v148
    v_add_f32 v6, v6, v19
    v_mfma_f32_32x32x16_bf16 v[128:143], v[188:191], v[44:47], v[128:143]
    ds_read_b64_tr_b16 v[220:221], v11 offset:192
    ds_read_b64_tr_b16 v[222:223], v11 offset:448
    v_cvt_pk_bf16_f32 v241, v18, v19
    v_exp_f32 v21, v149
    v_add_f32 v6, v6, v20
    v_mfma_f32_32x32x16_bf16 v[128:143], v[192:195], v[48:51], v[128:143]
    ds_read_b64_tr_b16 v[224:225], v11 offset:512
    ds_read_b64_tr_b16 v[226:227], v11 offset:768
    v_exp_f32 v22, v150
    v_add_f32 v6, v6, v21
    v_cvt_pk_bf16_f32 v242, v20, v21
    v_mfma_f32_32x32x16_bf16 v[128:143], v[196:199], v[52:55], v[128:143]
    ds_read_b64_tr_b16 v[228:229], v11 offset:576
    ds_read_b64_tr_b16 v[230:231], v11 offset:832
    s_add_u32 s65, s65, 8704
    s_cmp_eq_u32 s65, 43520
    s_cselect_b32 s65, 0, s65
    v_exp_f32 v23, v151
    v_add_f32 v6, v6, v22
    v_mfma_f32_32x32x16_bf16 v[128:143], v[200:203], v[56:59], v[128:143]
    ds_read_b64_tr_b16 v[232:233], v11 offset:640
    ds_read_b64_tr_b16 v[234:235], v11 offset:896
    v_exp_f32 v16, v152
    v_add_f32 v6, v6, v23
    v_cvt_pk_bf16_f32 v243, v22, v23
    v_mfma_f32_32x32x16_bf16 v[128:143], v[204:207], v[60:63], v[128:143]
    s_waitcnt lgkmcnt(6)
    ds_read_b64_tr_b16 v[236:237], v11 offset:704
    ds_read_b64_tr_b16 v[238:239], v11 offset:960
    s_add_u32 s64, s64, 8448
    s_cmp_eq_u32 s64, 42240
    s_cselect_b32 s64, 0, s64
    v_exp_f32 v17, v153
    v_add_f32 v6, v6, v16
    v_mfma_f32_32x32x16_bf16 v[64:79], v[208:211], v[24:27], v[64:79]
    ds_read_b128 v[176:179], v10 offset:0
    ds_read_b128 v[180:183], v10 offset:32
    v_exp_f32 v18, v154
    v_add_f32 v6, v6, v17
    v_cvt_pk_bf16_f32 v244, v16, v17
    v_mfma_f32_32x32x16_bf16 v[80:95], v[212:215], v[24:27], v[80:95]
    ds_read_b128 v[184:187], v10 offset:64
    ds_read_b128 v[188:191], v10 offset:96
    v_add_u32 v11, s65, v3
    v_exp_f32 v19, v155
    v_add_f32 v6, v6, v18
    v_mfma_f32_32x32x16_bf16 v[96:111], v[216:219], v[24:27], v[96:111]
    ds_read_b128 v[192:195], v10 offset:128
    ds_read_b128 v[196:199], v10 offset:160
    v_exp_f32 v20, v156
    v_add_f32 v6, v6, v19
    v_cvt_pk_bf16_f32 v245, v18, v19
    v_mfma_f32_32x32x16_bf16 v[112:127], v[220:223], v[24:27], v[112:127]
    s_waitcnt lgkmcnt(6)
    ds_read_b128 v[200:203], v10 offset:192
    ds_read_b128 v[204:207], v10 offset:224
    v_exp_f32 v21, v157
    v_add_f32 v6, v6, v20
    v_mfma_f32_32x32x16_bf16 v[64:79], v[224:227], v[28:31], v[64:79]
    v_exp_f32 v22, v158
    v_add_f32 v6, v6, v21
    v_cvt_pk_bf16_f32 v246, v20, v21
    v_exp_f32 v23, v159
    v_mfma_f32_32x32x16_bf16 v[80:95], v[228:231], v[28:31], v[80:95]
    v_add_f32 v6, v6, v22
    v_add_f32 v6, v6, v23
    v_cmp_lt_f32 vcc, s68, v6
    v_cvt_pk_bf16_f32 v247, v22, v23
    v_mfma_f32_32x32x16_bf16 v[96:111], v[232:235], v[28:31], v[96:111]
    v_add_u32 v10, s64, v2
    s_waitcnt lgkmcnt(0)
    s_barrier
    v_mfma_f32_32x32x16_bf16 v[112:127], v[236:239], v[28:31], v[112:127]
    s_cbranch_vccnz R1_1
R1_1_back:
    v_add_f32 v4, v4, v6
    v_exp_f32 v16, v128
    s_branch ATT_l
ATT_x:
    s_add_u32 s65, s65, 8704
    s_cmp_eq_u32 s65, 43520
    s_cselect_b32 s65, 0, s65
    ds_read_b64_tr_b16 v[208:209], v11 offset:0
    ds_read_b64_tr_b16 v[210:211], v11 offset:256
    ds_read_b64_tr_b16 v[212:213], v11 offset:64
    ds_read_b64_tr_b16 v[214:215], v11 offset:320
    ds_read_b64_tr_b16 v[216:217], v11 offset:128
    ds_read_b64_tr_b16 v[218:219], v11 offset:384
    ds_read_b64_tr_b16 v[220:221], v11 offset:192
    ds_read_b64_tr_b16 v[222:223], v11 offset:448
    v_exp_f32 v17, v145
    v_exp_f32 v18, v146
    v_add_f32 v6, v16, v17
    v_cvt_pk_bf16_f32 v240, v16, v17
    v_exp_f32 v19, v147
    v_add_f32 v6, v6, v18
    ds_read_b64_tr_b16 v[224:225], v11 offset:512
    ds_read_b64_tr_b16 v[226:227], v11 offset:768
    ds_read_b64_tr_b16 v[228:229], v11 offset:576
    ds_read_b64_tr_b16 v[230:231], v11 offset:832
    ds_read_b64_tr_b16 v[232:233], v11 offset:640
    ds_read_b64_tr_b16 v[234:235], v11 offset:896
    ds_read_b64_tr_b16 v[236:237], v11 offset:704
    ds_read_b64_tr_b16 v[238:239], v11 offset:960
    v_exp_f32 v20, v148
    v_add_f32 v6, v6, v19
    v_cvt_pk_bf16_f32 v241, v18, v19
    v_exp_f32 v21, v149
    v_add_f32 v6, v6, v20
    v_exp_f32 v22, v150
    v_add_u32 v11, s65, v3
    s_waitcnt lgkmcnt(8)
    v_mfma_f32_32x32x16_bf16 v[64:79], v[208:211], v[24:27], v[64:79]
    v_add_f32 v6, v6, v21
    v_cvt_pk_bf16_f32 v242, v20, v21
    v_exp_f32 v23, v151
    v_add_f32 v6, v6, v22
    v_mfma_f32_32x32x16_bf16 v[80:95], v[212:215], v[24:27], v[80:95]
    v_exp_f32 v16, v152
    v_add_f32 v6, v6, v23
    v_cvt_pk_bf16_f32 v243, v22, v23
    v_exp_f32 v17, v153
    v_mfma_f32_32x32x16_bf16 v[96:111], v[216:219], v[24:27], v[96:111]
    v_add_f32 v6, v6, v16
    v_exp_f32 v18, v154
    v_add_f32 v6, v6, v17
    v_cvt_pk_bf16_f32 v244, v16, v17
    v_mfma_f32_32x32x16_bf16 v[112:127], v[220:223], v[24:27], v[112:127]
    s_waitcnt lgkmcnt(0)
    v_exp_f32 v19, v155
    v_add_f32 v6, v6, v18
    v_exp_f32 v20, v156
    v_add_f32 v6, v6, v19
    v_mfma_f32_32x32x16_bf16 v[64:79], v[224:227], v[28:31], v[64:79]
    v_cvt_pk_bf16_f32 v245, v18, v19
    v_exp_f32 v21, v157
    v_add_f32 v6, v6, v20
    v_exp_f32 v22, v158
    v_mfma_f32_32x32x16_bf16 v[80:95], v[228:231], v[28:31], v[80:95]
    v_add_f32 v6, v6, v21
    v_cvt_pk_bf16_f32 v246, v20, v21
    v_exp_f32 v23, v159
    v_add_f32 v6, v6, v22
    v_mfma_f32_32x32x16_bf16 v[96:111], v[232:235], v[28:31], v[96:111]
    v_add_f32 v6, v6, v23
    v_cmp_lt_f32 vcc, s68, v6
    v_cvt_pk_bf16_f32 v247, v22, v23
    v_mfma_f32_32x32x16_bf16 v[112:127], v[236:239], v[28:31], v[112:127]
    s_cbranch_vccnz R1_2
R1_2_back:
    v_add_f32 v4, v4, v6
    v_mov_b32 v8, v4
    s_nop 1
    v_permlane32_swap_b32 v8, v4
    s_nop 1
    v_add_f32 v4, v4, v8
    v_rcp_f32 v4, v4
    s_waitcnt vmcnt(0)
    v_readfirstlane_b32 s53, v15
    s_cmp_eq_u32 s53, s69
    s_cselect_b64 vcc, -1, 0
    s_cmp_eq_u32 s57, 0
    s_barrier
    ds_read_b64_tr_b16 v[208:209], v11 offset:0
    ds_read_b64_tr_b16 v[210:211], v11 offset:256
    ds_read_b64_tr_b16 v[224:225], v11 offset:512
    ds_read_b64_tr_b16 v[226:227], v11 offset:768
    ds_read_b64_tr_b16 v[212:213], v11 offset:64
    ds_read_b64_tr_b16 v[214:215], v11 offset:320
    ds_read_b64_tr_b16 v[228:229], v11 offset:576
    ds_read_b64_tr_b16 v[230:231], v11 offset:832
    ds_read_b64_tr_b16 v[216:217], v11 offset:128
    ds_read_b64_tr_b16 v[218:219], v11 offset:384
    ds_read_b64_tr_b16 v[232:233], v11 offset:640
    ds_read_b64_tr_b16 v[234:235], v11 offset:896
    ds_read_b64_tr_b16 v[220:221], v11 offset:192
    ds_read_b64_tr_b16 v[222:223], v11 offset:448
    ds_read_b64_tr_b16 v[236:237], v11 offset:704
    ds_read_b64_tr_b16 v[238:239], v11 offset:960
    v_mov_b32 v5, v4
    v_add_u32 v16, s60, v7
    v_add_u32 v17, s61, v7
    v_add_u32 v18, s62, v7
    v_add_u32 v19, s63, v7
    s_waitcnt lgkmcnt(14)
    v_mfma_f32_32x32x16_bf16 v[64:79], v[208:211], v[240:243], v[64:79]
    s_waitcnt lgkmcnt(12)
    v_mfma_f32_32x32x16_bf16 v[64:79], v[224:227], v[244:247], v[64:79]
    s_waitcnt lgkmcnt(10)
    v_mfma_f32_32x32x16_bf16 v[80:95], v[212:215], v[240:243], v[80:95]
    s_waitcnt lgkmcnt(8)
    v_mfma_f32_32x32x16_bf16 v[80:95], v[228:231], v[244:247], v[80:95]
    s_nop 3
    v_pk_mul_f32 v[64:65], v[64:65], v[4:5]
    v_pk_mul_f32 v[66:67], v[66:67], v[4:5]
    v_pk_mul_f32 v[68:69], v[68:69], v[4:5]
    v_pk_mul_f32 v[70:71], v[70:71], v[4:5]
    v_pk_mul_f32 v[72:73], v[72:73], v[4:5]
    v_pk_mul_f32 v[74:75], v[74:75], v[4:5]
    v_pk_mul_f32 v[76:77], v[76:77], v[4:5]
    v_pk_mul_f32 v[78:79], v[78:79], v[4:5]
    v_cvt_pk_bf16_f32 v176, v64, v65
    v_cvt_pk_bf16_f32 v177, v66, v67
    v_cvt_pk_bf16_f32 v178, v68, v69
    v_cvt_pk_bf16_f32 v179, v70, v71
    v_cvt_pk_bf16_f32 v180, v72, v73
    v_cvt_pk_bf16_f32 v181, v74, v75
    v_cvt_pk_bf16_f32 v182, v76, v77
    v_cvt_pk_bf16_f32 v183, v78, v79
    ds_write_b128 v16, v[176:179] offset:0
    ds_write_b128 v16, v[180:183] offset:1024
    s_cbranch_scc1 ATT_s0
    s_cbranch_vccz OSB0_t
    s_mov_b32 s52, 0
    buffer_store_dwordx4 v[176:179], v7, s[36:39], s52 offen offset:0
    s_mov_b32 s52, 0
    buffer_store_dwordx4 v[180:183], v7, s[36:39], s52 offen offset:1024
    s_branch OSB0_e
OSB0_t:
    s_mov_b32 s52, 0
    buffer_store_dwordx4 v[176:179], v7, s[36:39], s52 offen offset:0 sc1
    s_mov_b32 s52, 0
    buffer_store_dwordx4 v[180:183], v7, s[36:39], s52 offen offset:1024 sc1
OSB0_e:
ATT_s0:
    s_waitcnt lgkmcnt(8)
    v_mfma_f32_32x32x16_bf16 v[96:111], v[216:219], v[240:243], v[96:111]
    s_waitcnt lgkmcnt(6)
    v_mfma_f32_32x32x16_bf16 v[96:111], v[232:235], v[244:247], v[96:111]
    v_pk_mul_f32 v[80:81], v[80:81], v[4:5]
    v_pk_mul_f32 v[82:83], v[82:83], v[4:5]
    v_pk_mul_f32 v[84:85], v[84:85], v[4:5]
    v_pk_mul_f32 v[86:87], v[86:87], v[4:5]
    v_pk_mul_f32 v[88:89], v[88:89], v[4:5]
    v_pk_mul_f32 v[90:91], v[90:91], v[4:5]
    v_pk_mul_f32 v[92:93], v[92:93], v[4:5]
    v_pk_mul_f32 v[94:95], v[94:95], v[4:5]
    v_cvt_pk_bf16_f32 v184, v80, v81
    v_cvt_pk_bf16_f32 v185, v82, v83
    v_cvt_pk_bf16_f32 v186, v84, v85
    v_cvt_pk_bf16_f32 v187, v86, v87
    v_cvt_pk_bf16_f32 v188, v88, v89
    v_cvt_pk_bf16_f32 v189, v90, v91
    v_cvt_pk_bf16_f32 v190, v92, v93
    v_cvt_pk_bf16_f32 v191, v94, v95
    ds_write_b128 v17, v[184:187] offset:0
    ds_write_b128 v17, v[188:191] offset:1024
    s_cbranch_scc1 ATT_s1
    s_cbranch_vccz OSB1_t
    s_mov_b32 s52, 6144
    buffer_store_dwordx4 v[184:187], v7, s[36:39], s52 offen offset:0
    s_mov_b32 s52, 6144
    buffer_store_dwordx4 v[188:191], v7, s[36:39], s52 offen offset:1024
    s_branch OSB1_e
OSB1_t:
    s_mov_b32 s52, 6144
    buffer_store_dwordx4 v[184:187], v7, s[36:39], s52 offen offset:0 sc1
    s_mov_b32 s52, 6144
    buffer_store_dwordx4 v[188:191], v7, s[36:39], s52 offen offset:1024 sc1
OSB1_e:
ATT_s1:
    s_waitcnt lgkmcnt(6)
    v_mfma_f32_32x32x16_bf16 v[112:127], v[220:223], v[240:243], v[112:127]
    s_waitcnt lgkmcnt(4)
    v_mfma_f32_32x32x16_bf16 v[112:127], v[236:239], v[244:247], v[112:127]
    v_pk_mul_f32 v[96:97], v[96:97], v[4:5]
    v_pk_mul_f32 v[98:99], v[98:99], v[4:5]
    v_pk_mul_f32 v[100:101], v[100:101], v[4:5]
    v_pk_mul_f32 v[102:103], v[102:103], v[4:5]
    v_pk_mul_f32 v[104:105], v[104:105], v[4:5]
    v_pk_mul_f32 v[106:107], v[106:107], v[4:5]
    v_pk_mul_f32 v[108:109], v[108:109], v[4:5]
    v_pk_mul_f32 v[110:111], v[110:111], v[4:5]
    v_cvt_pk_bf16_f32 v192, v96, v97
    v_cvt_pk_bf16_f32 v193, v98, v99
    v_cvt_pk_bf16_f32 v194, v100, v101
    v_cvt_pk_bf16_f32 v195, v102, v103
    v_cvt_pk_bf16_f32 v196, v104, v105
    v_cvt_pk_bf16_f32 v197, v106, v107
    v_cvt_pk_bf16_f32 v198, v108, v109
    v_cvt_pk_bf16_f32 v199, v110, v111
    ds_write_b128 v18, v[192:195] offset:0
    ds_write_b128 v18, v[196:199] offset:1024
    s_cbranch_scc1 ATT_s2
    s_cbranch_vccz OSB2_t
    s_mov_b32 s52, 12288
    buffer_store_dwordx4 v[192:195], v7, s[36:39], s52 offen offset:0
    s_mov_b32 s52, 12288
    buffer_store_dwordx4 v[196:199], v7, s[36:39], s52 offen offset:1024
    s_branch OSB2_e
OSB2_t:
    s_mov_b32 s52, 12288
    buffer_store_dwordx4 v[192:195], v7, s[36:39], s52 offen offset:0 sc1
    s_mov_b32 s52, 12288
    buffer_store_dwordx4 v[196:199], v7, s[36:39], s52 offen offset:1024 sc1
OSB2_e:
ATT_s2:
    v_pk_mul_f32 v[112:113], v[112:113], v[4:5]
    v_pk_mul_f32 v[114:115], v[114:115], v[4:5]
    v_pk_mul_f32 v[116:117], v[116:117], v[4:5]
    v_pk_mul_f32 v[118:119], v[118:119], v[4:5]
    v_pk_mul_f32 v[120:121], v[120:121], v[4:5]
    v_pk_mul_f32 v[122:123], v[122:123], v[4:5]
    v_pk_mul_f32 v[124:125], v[124:125], v[4:5]
    v_pk_mul_f32 v[126:127], v[126:127], v[4:5]
    v_cvt_pk_bf16_f32 v200, v112, v113
    v_cvt_pk_bf16_f32 v201, v114, v115
    v_cvt_pk_bf16_f32 v202, v116, v117
    v_cvt_pk_bf16_f32 v203, v118, v119
    v_cvt_pk_bf16_f32 v204, v120, v121
    v_cvt_pk_bf16_f32 v205, v122, v123
    v_cvt_pk_bf16_f32 v206, v124, v125
    v_cvt_pk_bf16_f32 v207, v126, v127
    ds_write_b128 v19, v[200:203] offset:0
    ds_write_b128 v19, v[204:207] offset:1024
    s_cbranch_scc1 ATT_s3
    s_cbranch_vccz OSB3_t
    s_mov_b32 s52, 18432
    buffer_store_dwordx4 v[200:203], v7, s[36:39], s52 offen offset:0
    s_mov_b32 s52, 18432
    buffer_store_dwordx4 v[204:207], v7, s[36:39], s52 offen offset:1024
    s_branch OSB3_e
OSB3_t:
    s_mov_b32 s52, 18432
    buffer_store_dwordx4 v[200:203], v7, s[36:39], s52 offen offset:0 sc1
    s_mov_b32 s52, 18432
    buffer_store_dwordx4 v[204:207], v7, s[36:39], s52 offen offset:1024 sc1
OSB3_e:
ATT_s3:
    v_mov_b32 v8, 1
    s_waitcnt lgkmcnt(0)
    s_cbranch_scc1 K_aop
    s_barrier
    s_mov_b32 s58, 0
B_x:
    s_mov_b32 s52, 0
B_y:
    s_getreg_b32 s53, hwreg(HW_REG_IB_STS, 0, 4)
    s_cmp_eq_u32 s53, 0
    s_cbranch_scc1 B_z
    s_add_u32 s52, s52, 1
    s_cmp_lt_u32 s52, 8
    s_cbranch_scc1 B_y
    s_barrier
    s_add_u32 s58, s58, 1
    s_cmp_lt_u32 s58, 4
    s_cbranch_scc1 B_x
B_z:
    s_waitcnt vmcnt(0)
    buffer_store_dword v8, v7, s[72:75], 0 offen sc1
B_w:
    s_cmp_ge_u32 s58, 10
    s_cbranch_scc1 B_v
    s_barrier
    s_add_u32 s58, s58, 1
    s_branch B_w
B_v:
    s_lshr_b32 s52, s2, 3
    s_and_b32 s52, s52, 31
    s_or_b32 s52, s52, s56
    s_cbranch_scc1 B_r
    buffer_wbl2 sc1
B_r:
    s_barrier
    s_add_u32 s58, s58, 1
    s_cmp_lt_u32 s58, 13
    s_cbranch_scc1 B_r
    s_endpgm
K_aop:
    v_lshl_add_u32 v1, v248, 3, v250
    v_mul_u32_u24 v1, 320, v1
    v_add_u32 v1, v1, v251
    s_add_u32 s20, s49, 0
    s_and_b32 s20, s20, 3
    s_lshl_b32 s52, s20, 6
    v_add_u32 v16, s52, v1
    s_add_u32 s21, s49, 1
    s_and_b32 s21, s21, 3
    s_lshl_b32 s52, s21, 6
    v_add_u32 v17, s52, v1
    s_add_u32 s22, s49, 2
    s_and_b32 s22, s22, 3
    s_lshl_b32 s52, s22, 6
    v_add_u32 v18, s52, v1
    s_add_u32 s23, s49, 3
    s_and_b32 s23, s23, 3
    s_lshl_b32 s52, s23, 6
    v_add_u32 v19, s52, v1
    s_lshl_b32 s52, s3, 11
    v_add_u32 v20, s52, v7
    s_barrier
    s_mov_b32 s67, 98304
    v_add_u32 v24, s67, v16
    v_add_u32 v25, s67, v17
    v_add_u32 v26, s67, v18
    v_add_u32 v27, s67, v19
    v_add_u32 v28, s67, v20
    s_barrier
    ds_read_b128 v[160:163], v28 offset:10240
    ds_read_b64_tr_b16 v[128:129], v24 offset:0
    ds_read_b64_tr_b16 v[130:131], v24 offset:1280
    ds_read_b64_tr_b16 v[132:133], v25 offset:0
    ds_read_b64_tr_b16 v[134:135], v25 offset:1280
    ds_read_b64_tr_b16 v[136:137], v26 offset:0
    ds_read_b64_tr_b16 v[138:139], v26 offset:1280
    ds_read_b64_tr_b16 v[140:141], v27 offset:0
    ds_read_b64_tr_b16 v[142:143], v27 offset:1280
    s_waitcnt lgkmcnt(0)
    v_mfma_f32_32x32x16_bf16 v[64:79], v[128:131], v[160:163], 0
    s_barrier
    ds_read_b128 v[164:167], v28 offset:11264
    ds_read_b64_tr_b16 v[144:145], v24 offset:5120
    v_mfma_f32_32x32x16_bf16 v[80:95], v[132:135], v[160:163], 0
    ds_read_b64_tr_b16 v[146:147], v24 offset:6400
    ds_read_b64_tr_b16 v[148:149], v25 offset:5120
    ds_read_b64_tr_b16 v[150:151], v25 offset:6400
    v_mfma_f32_32x32x16_bf16 v[96:111], v[136:139], v[160:163], 0
    ds_read_b64_tr_b16 v[152:153], v26 offset:5120
    ds_read_b64_tr_b16 v[154:155], v26 offset:6400
    ds_read_b64_tr_b16 v[156:157], v27 offset:5120
    v_mfma_f32_32x32x16_bf16 v[112:127], v[140:143], v[160:163], 0
    ds_read_b64_tr_b16 v[158:159], v27 offset:6400
    s_waitcnt lgkmcnt(0)
    v_mfma_f32_32x32x16_bf16 v[64:79], v[144:147], v[164:167], v[64:79]
    s_barrier
    ds_read_b128 v[160:163], v28 offset:16384
    ds_read_b64_tr_b16 v[128:129], v24 offset:22528
    v_mfma_f32_32x32x16_bf16 v[80:95], v[148:151], v[164:167], v[80:95]
    ds_read_b64_tr_b16 v[130:131], v24 offset:23808
    ds_read_b64_tr_b16 v[132:133], v25 offset:22528
    ds_read_b64_tr_b16 v[134:135], v25 offset:23808
    v_mfma_f32_32x32x16_bf16 v[96:111], v[152:155], v[164:167], v[96:111]
    ds_read_b64_tr_b16 v[136:137], v26 offset:22528
    ds_read_b64_tr_b16 v[138:139], v26 offset:23808
    ds_read_b64_tr_b16 v[140:141], v27 offset:22528
    v_mfma_f32_32x32x16_bf16 v[112:127], v[156:159], v[164:167], v[112:127]
    ds_read_b64_tr_b16 v[142:143], v27 offset:23808
    s_waitcnt lgkmcnt(0)
    v_mfma_f32_32x32x16_bf16 v[64:79], v[128:131], v[160:163], v[64:79]
    s_barrier
    ds_read_b128 v[164:167], v28 offset:17408
    ds_read_b64_tr_b16 v[144:145], v24 offset:27648
    v_mfma_f32_32x32x16_bf16 v[80:95], v[132:135], v[160:163], v[80:95]
    ds_read_b64_tr_b16 v[146:147], v24 offset:28928
    ds_read_b64_tr_b16 v[148:149], v25 offset:27648
    ds_read_b64_tr_b16 v[150:151], v25 offset:28928
    v_mfma_f32_32x32x16_bf16 v[96:111], v[136:139], v[160:163], v[96:111]
    ds_read_b64_tr_b16 v[152:153], v26 offset:27648
    ds_read_b64_tr_b16 v[154:155], v26 offset:28928
    ds_read_b64_tr_b16 v[156:157], v27 offset:27648
    v_mfma_f32_32x32x16_bf16 v[112:127], v[140:143], v[160:163], v[112:127]
    ds_read_b64_tr_b16 v[158:159], v27 offset:28928
    s_waitcnt lgkmcnt(0)
    s_mov_b32 s67, 131072
    v_add_u32 v24, s67, v16
    v_add_u32 v25, s67, v17
    v_add_u32 v26, s67, v18
    v_add_u32 v27, s67, v19
    v_add_u32 v28, s67, v20
    v_mfma_f32_32x32x16_bf16 v[64:79], v[144:147], v[164:167], v[64:79]
    s_barrier
    ds_read_b128 v[160:163], v28 offset:10240
    ds_read_b64_tr_b16 v[128:129], v24 offset:0
    v_mfma_f32_32x32x16_bf16 v[80:95], v[148:151], v[164:167], v[80:95]
    ds_read_b64_tr_b16 v[130:131], v24 offset:1280
    ds_read_b64_tr_b16 v[132:133], v25 offset:0
    ds_read_b64_tr_b16 v[134:135], v25 offset:1280
    v_mfma_f32_32x32x16_bf16 v[96:111], v[152:155], v[164:167], v[96:111]
    ds_read_b64_tr_b16 v[136:137], v26 offset:0
    ds_read_b64_tr_b16 v[138:139], v26 offset:1280
    ds_read_b64_tr_b16 v[140:141], v27 offset:0
    v_mfma_f32_32x32x16_bf16 v[112:127], v[156:159], v[164:167], v[112:127]
    ds_read_b64_tr_b16 v[142:143], v27 offset:1280
    s_waitcnt lgkmcnt(0)
    v_mfma_f32_32x32x16_bf16 v[64:79], v[128:131], v[160:163], v[64:79]
    s_barrier
    ds_read_b128 v[164:167], v28 offset:11264
    ds_read_b64_tr_b16 v[144:145], v24 offset:5120
    v_mfma_f32_32x32x16_bf16 v[80:95], v[132:135], v[160:163], v[80:95]
    ds_read_b64_tr_b16 v[146:147], v24 offset:6400
    ds_read_b64_tr_b16 v[148:149], v25 offset:5120
    ds_read_b64_tr_b16 v[150:151], v25 offset:6400
    v_mfma_f32_32x32x16_bf16 v[96:111], v[136:139], v[160:163], v[96:111]
    ds_read_b64_tr_b16 v[152:153], v26 offset:5120
    ds_read_b64_tr_b16 v[154:155], v26 offset:6400
    ds_read_b64_tr_b16 v[156:157], v27 offset:5120
    v_mfma_f32_32x32x16_bf16 v[112:127], v[140:143], v[160:163], v[112:127]
    ds_read_b64_tr_b16 v[158:159], v27 offset:6400
    s_waitcnt lgkmcnt(0)
    v_mfma_f32_32x32x16_bf16 v[64:79], v[144:147], v[164:167], v[64:79]
    s_barrier
    s_waitcnt vmcnt(0)
    v_readfirstlane_b32 s53, v15
    s_cmp_eq_u32 s53, s69
    s_cselect_b64 vcc, -1, 0
    s_cbranch_vccz OSA24_t
    s_mov_b32 s52, 0
    buffer_store_dwordx4 v[176:179], v7, s[36:39], s52 offen offset:0
    s_mov_b32 s52, 0
    buffer_store_dwordx4 v[180:183], v7, s[36:39], s52 offen offset:1024
    s_mov_b32 s52, 6144
    buffer_store_dwordx4 v[184:187], v7, s[36:39], s52 offen offset:0
    s_mov_b32 s52, 6144
    buffer_store_dwordx4 v[188:191], v7, s[36:39], s52 offen offset:1024
    s_branch OSA24_e
OSA24_t:
    s_mov_b32 s52, 0
    buffer_store_dwordx4 v[176:179], v7, s[36:39], s52 offen offset:0 sc1
    s_mov_b32 s52, 0
    buffer_store_dwordx4 v[180:183], v7, s[36:39], s52 offen offset:1024 sc1
    s_mov_b32 s52, 6144
    buffer_store_dwordx4 v[184:187], v7, s[36:39], s52 offen offset:0 sc1
    s_mov_b32 s52, 6144
    buffer_store_dwordx4 v[188:191], v7, s[36:39], s52 offen offset:1024 sc1
OSA24_e:
    ds_read_b128 v[160:163], v28 offset:16384
    ds_read_b64_tr_b16 v[128:129], v24 offset:22528
    v_mfma_f32_32x32x16_bf16 v[80:95], v[148:151], v[164:167], v[80:95]
    ds_read_b64_tr_b16 v[130:131], v24 offset:23808
    ds_read_b64_tr_b16 v[132:133], v25 offset:22528
    ds_read_b64_tr_b16 v[134:135], v25 offset:23808
    v_mfma_f32_32x32x16_bf16 v[96:111], v[152:155], v[164:167], v[96:111]
    ds_read_b64_tr_b16 v[136:137], v26 offset:22528
    ds_read_b64_tr_b16 v[138:139], v26 offset:23808
    ds_read_b64_tr_b16 v[140:141], v27 offset:22528
    v_mfma_f32_32x32x16_bf16 v[112:127], v[156:159], v[164:167], v[112:127]
    ds_read_b64_tr_b16 v[142:143], v27 offset:23808
    s_waitcnt lgkmcnt(0)
    v_mfma_f32_32x32x16_bf16 v[64:79], v[128:131], v[160:163], v[64:79]
    s_barrier
    s_cbranch_vccz OSA25_t
    s_mov_b32 s52, 12288
    buffer_store_dwordx4 v[192:195], v7, s[36:39], s52 offen offset:0
    s_mov_b32 s52, 12288
    buffer_store_dwordx4 v[196:199], v7, s[36:39], s52 offen offset:1024
    s_mov_b32 s52, 18432
    buffer_store_dwordx4 v[200:203], v7, s[36:39], s52 offen offset:0
    s_mov_b32 s52, 18432
    buffer_store_dwordx4 v[204:207], v7, s[36:39], s52 offen offset:1024
    s_branch OSA25_e
OSA25_t:
    s_mov_b32 s52, 12288
    buffer_store_dwordx4 v[192:195], v7, s[36:39], s52 offen offset:0 sc1
    s_mov_b32 s52, 12288
    buffer_store_dwordx4 v[196:199], v7, s[36:39], s52 offen offset:1024 sc1
    s_mov_b32 s52, 18432
    buffer_store_dwordx4 v[200:203], v7, s[36:39], s52 offen offset:0 sc1
    s_mov_b32 s52, 18432
    buffer_store_dwordx4 v[204:207], v7, s[36:39], s52 offen offset:1024 sc1
OSA25_e:
    ds_read_b128 v[164:167], v28 offset:17408
    ds_read_b64_tr_b16 v[144:145], v24 offset:27648
    v_mfma_f32_32x32x16_bf16 v[80:95], v[132:135], v[160:163], v[80:95]
    ds_read_b64_tr_b16 v[146:147], v24 offset:28928
    ds_read_b64_tr_b16 v[148:149], v25 offset:27648
    ds_read_b64_tr_b16 v[150:151], v25 offset:28928
    v_mfma_f32_32x32x16_bf16 v[96:111], v[136:139], v[160:163], v[96:111]
    ds_read_b64_tr_b16 v[152:153], v26 offset:27648
    ds_read_b64_tr_b16 v[154:155], v26 offset:28928
    ds_read_b64_tr_b16 v[156:157], v27 offset:27648
    v_mfma_f32_32x32x16_bf16 v[112:127], v[140:143], v[160:163], v[112:127]
    ds_read_b64_tr_b16 v[158:159], v27 offset:28928
    s_waitcnt lgkmcnt(0)
    s_barrier
    s_lshl2_add_u32 s52, s48, s50
    s_lshl_b32 s53, s52, 18
    s_add_u32 s53, s53, 16777216
    s_lshl3_add_u32 s52, s48, s50
    s_lshl_b32 s52, s52, 11
    s_add_u32 s52, s52, 33555456
    s_add_u32 s24, s18, s53
    s_addc_u32 s25, s19, 0
    s_mov_b32 s26, 262144
    s_mov_b32 s27, 0x20000
    s_add_u32 s28, s18, s52
    s_addc_u32 s29, s19, 0
    s_mov_b32 s30, 2048
    s_mov_b32 s31, 0x20000
    s_mov_b32 s44, s14
    s_mov_b32 s45, s15
    s_mov_b32 s46, 1966080
    s_mov_b32 s47, 0x20000
    v_mov_b32 v13, s20
    v_mov_b32 v14, 1
    v_writelane_b32 v13, s21, 1
    v_writelane_b32 v13, s22, 2
    v_writelane_b32 v13, s23, 3
    s_lshl_b32 s53, s3, 7
    s_lshl2_add_u32 s52, s49, s53
    v_lshlrev_b32 v13, 9, v13
    v_add_u32 v13, s52, v13
    s_lshl_b32 s52, s49, 9
    s_add_u32 s52, s52, s53
    v_and_b32 v1, 3, v0
    v_lshlrev_b32 v1, 2, v1
    v_add_u32 v11, s52, v1
    s_lshl_b32 s52, 1, s49
    s_andn2_b32 s33, 15, s52
    s_lshl2_add_u32 s55, s49, s3
    s_lshl_b32 s20, s20, 16
    s_lshl_b32 s52, s55, 12
    s_add_u32 s20, s20, s52
    s_lshl_b32 s21, s21, 16
    s_lshl_b32 s52, s55, 12
    s_add_u32 s21, s21, s52
    s_lshl_b32 s22, s22, 16
    s_lshl_b32 s52, s55, 12
    s_add_u32 s22, s22, s52
    s_lshl_b32 s23, s23, 16
    s_lshl_b32 s52, s55, 12
    s_add_u32 s23, s23, s52
    v_and_b32 v12, 15, v0
    v_mul_u32_u24 v12, 1280, v12
    v_bfe_u32 v1, v0, 4, 1
    v_lshl_add_u32 v12, v1, 5, v12
    v_lshl_add_u32 v12, v248, 4, v12
    s_mul_i32 s32, s48, 122880
    s_mul_i32 s52, s50, 320
    s_add_u32 s32, s32, s52
    s_branch SK7
PAD7:
    s_branch BK7
SK7:
    s_mul_i32 s52, s3, 40960
    s_add_u32 s32, s32, s52
    s_lshl_b32 s52, s49, 6
    s_add_u32 s32, s32, s52
    s_mov_b64 s[34:35], 14
    s_barrier
    s_barrier
    s_waitcnt vmcnt(0)
    buffer_store_dword v8, v7, s[72:75], 0 offen sc1
    s_barrier
    s_barrier
    s_barrier
    s_barrier
    s_mov_b32 s67, 98304
    v_add_u32 v24, s67, v16
    v_add_u32 v25, s67, v17
    v_add_u32 v26, s67, v18
    v_add_u32 v27, s67, v19
    v_add_u32 v28, s67, v20
    s_mov_b32 s58, 0
OP0:
    v_mfma_f32_32x32x16_bf16 v[64:79], v[144:147], v[164:167], v[64:79]
    s_barrier
    ds_read_b128 v[160:163], v28 offset:10240
    ds_read_b64_tr_b16 v[128:129], v24 offset:0
    v_mfma_f32_32x32x16_bf16 v[80:95], v[148:151], v[164:167], v[80:95]
    ds_read_b64_tr_b16 v[130:131], v24 offset:1280
    ds_read_b64_tr_b16 v[132:133], v25 offset:0
    ds_read_b64_tr_b16 v[134:135], v25 offset:1280
    v_mfma_f32_32x32x16_bf16 v[96:111], v[152:155], v[164:167], v[96:111]
    ds_read_b64_tr_b16 v[136:137], v26 offset:0
    ds_read_b64_tr_b16 v[138:139], v26 offset:1280
    ds_read_b64_tr_b16 v[140:141], v27 offset:0
    v_mfma_f32_32x32x16_bf16 v[112:127], v[156:159], v[164:167], v[112:127]
    s_waitcnt lgkmcnt(5)
    ds_read_b64_tr_b16 v[142:143], v27 offset:1280
    ds_read_b64_tr_b16 v[144:145], v24 offset:5120
    ds_read_b64_tr_b16 v[146:147], v24 offset:6400
    v_mfma_f32_32x32x16_bf16 v[64:79], v[128:131], v[160:163], v[64:79]
    s_waitcnt lgkmcnt(6)
    ds_read_b128 v[164:167], v28 offset:11264
    ds_read_b64_tr_b16 v[148:149], v25 offset:5120
    ds_read_b64_tr_b16 v[150:151], v25 offset:6400
    v_mfma_f32_32x32x16_bf16 v[80:95], v[132:135], v[160:163], v[80:95]
    s_waitcnt lgkmcnt(7)
    ds_read_b64_tr_b16 v[152:153], v26 offset:5120
    ds_read_b64_tr_b16 v[154:155], v26 offset:6400
    ds_read_b64_tr_b16 v[156:157], v27 offset:5120
    v_mfma_f32_32x32x16_bf16 v[96:111], v[136:139], v[160:163], v[96:111]
    s_waitcnt lgkmcnt(8)
    ds_read_b64_tr_b16 v[158:159], v27 offset:6400
    ds_read_b64_tr_b16 v[128:129], v24 offset:22528
    ds_read_b64_tr_b16 v[130:131], v24 offset:23808
    v_mfma_f32_32x32x16_bf16 v[112:127], v[140:143], v[160:163], v[112:127]
    s_waitcnt lgkmcnt(8)
    ds_read_b64_tr_b16 v[132:133], v25 offset:22528
    ds_read_b64_tr_b16 v[134:135], v25 offset:23808
    ds_read_b64_tr_b16 v[136:137], v26 offset:22528
    v_mfma_f32_32x32x16_bf16 v[64:79], v[144:147], v[164:167], v[64:79]
    s_waitcnt lgkmcnt(9)
    ds_read_b128 v[160:163], v28 offset:16384
    ds_read_b64_tr_b16 v[138:139], v26 offset:23808
    ds_read_b64_tr_b16 v[140:141], v27 offset:22528
    v_mfma_f32_32x32x16_bf16 v[80:95], v[148:151], v[164:167], v[80:95]
    s_waitcnt lgkmcnt(10)
    ds_read_b64_tr_b16 v[142:143], v27 offset:23808
    ds_read_b64_tr_b16 v[144:145], v24 offset:27648
    ds_read_b64_tr_b16 v[146:147], v24 offset:28928
    v_mfma_f32_32x32x16_bf16 v[96:111], v[152:155], v[164:167], v[96:111]
    s_waitcnt lgkmcnt(11)
    ds_read_b64_tr_b16 v[148:149], v25 offset:27648
    ds_read_b64_tr_b16 v[150:151], v25 offset:28928
    v_mfma_f32_32x32x16_bf16 v[112:127], v[156:159], v[164:167], v[112:127]
    s_waitcnt lgkmcnt(7)
    ds_read_b64_tr_b16 v[152:153], v26 offset:27648
    ds_read_b64_tr_b16 v[154:155], v26 offset:28928
    v_mfma_f32_32x32x16_bf16 v[64:79], v[128:131], v[160:163], v[64:79]
    ds_read_b128 v[164:167], v28 offset:17408
    ds_read_b64_tr_b16 v[156:157], v27 offset:27648
    ds_read_b64_tr_b16 v[158:159], v27 offset:28928
    v_mfma_f32_32x32x16_bf16 v[80:95], v[132:135], v[160:163], v[80:95]
    s_waitcnt lgkmcnt(11)
    s_add_u32 s67, s67, 32768
    s_cmp_eq_u32 s67, 163840
    s_cselect_b32 s67, 0, s67
    v_add_u32 v24, s67, v16
    v_add_u32 v25, s67, v17
    v_add_u32 v26, s67, v18
    v_mfma_f32_32x32x16_bf16 v[96:111], v[136:139], v[160:163], v[96:111]
    s_waitcnt lgkmcnt(9)
    v_add_u32 v27, s67, v19
    v_add_u32 v28, s67, v20
    s_add_u32 s58, s58, 1
    s_cmp_lt_u32 s58, 14
    v_mfma_f32_32x32x16_bf16 v[112:127], v[140:143], v[160:163], v[112:127]
    s_waitcnt lgkmcnt(0)
    s_cbranch_scc1 OP0
    v_mfma_f32_32x32x16_bf16 v[80:95], v[148:151], v[164:167], v[80:95]
    v_mfma_f32_32x32x16_bf16 v[96:111], v[152:155], v[164:167], v[96:111]
    v_mfma_f32_32x32x16_bf16 v[112:127], v[156:159], v[164:167], v[112:127]
    v_mfma_f32_32x32x16_bf16 v[64:79], v[144:147], v[164:167], v[64:79]
    v_cvt_pk_bf16_f32 v184, v80, v81
    v_cvt_pk_bf16_f32 v185, v82, v83
    v_cvt_pk_bf16_f32 v186, v84, v85
    v_cvt_pk_bf16_f32 v187, v86, v87
    v_cvt_pk_bf16_f32 v188, v88, v89
    v_cvt_pk_bf16_f32 v189, v90, v91
    v_cvt_pk_bf16_f32 v190, v92, v93
    v_cvt_pk_bf16_f32 v191, v94, v95
    buffer_store_dwordx4 v[184:187], v7, s[24:27], s21 offen offset:0 sc1
    buffer_store_dwordx4 v[188:191], v7, s[24:27], s21 offen offset:1024 sc1
    v_cvt_pk_bf16_f32 v192, v96, v97
    v_cvt_pk_bf16_f32 v193, v98, v99
    v_cvt_pk_bf16_f32 v194, v100, v101
    v_cvt_pk_bf16_f32 v195, v102, v103
    v_cvt_pk_bf16_f32 v196, v104, v105
    v_cvt_pk_bf16_f32 v197, v106, v107
    v_cvt_pk_bf16_f32 v198, v108, v109
    v_cvt_pk_bf16_f32 v199, v110, v111
    buffer_store_dwordx4 v[192:195], v7, s[24:27], s22 offen offset:0 sc1
    buffer_store_dwordx4 v[196:199], v7, s[24:27], s22 offen offset:1024 sc1
    v_cvt_pk_bf16_f32 v200, v112, v113
    v_cvt_pk_bf16_f32 v201, v114, v115
    v_cvt_pk_bf16_f32 v202, v116, v117
    v_cvt_pk_bf16_f32 v203, v118, v119
    v_cvt_pk_bf16_f32 v204, v120, v121
    v_cvt_pk_bf16_f32 v205, v122, v123
    v_cvt_pk_bf16_f32 v206, v124, v125
    v_cvt_pk_bf16_f32 v207, v126, v127
    buffer_store_dwordx4 v[200:203], v7, s[24:27], s23 offen offset:0 sc1
    buffer_store_dwordx4 v[204:207], v7, s[24:27], s23 offen offset:1024 sc1
    v_mov_b32 v216, 0
    s_lshl_b32 s53, s49, 16
    s_lshl_b32 s52, s3, 12
    s_add_u32 s53, s53, s52
    s_add_u32 s52, s49, 1
    s_and_b32 s52, s52, 3
    s_lshl_b32 s52, s52, 14
    s_add_u32 s40, s52, s53
    s_add_u32 s52, s49, 2
    s_and_b32 s52, s52, 3
    s_lshl_b32 s52, s52, 14
    s_add_u32 s41, s52, s53
    s_add_u32 s52, s49, 3
    s_and_b32 s52, s52, 3
    s_lshl_b32 s52, s52, 14
    s_add_u32 s42, s52, s53
    s_mov_b32 s55, 0
    s_waitcnt vmcnt(0)
    s_mov_b64 exec, s[34:35]
    buffer_store_dword v14, v13, s[28:31], 0 offen sc1
    s_mov_b64 exec, -1
O_poll0:
    buffer_load_dword v216, v11, s[28:31], 0 offen sc1
    s_waitcnt vmcnt(0)
    v_cmp_eq_u32 vcc, 1, v216
    s_and_b32 s54, vcc_lo, s33
    s_cmp_eq_u32 s54, s33
    s_cbranch_scc1 O_poll0_done
    s_add_u32 s55, s55, 1
    s_cmp_lt_u32 s55, 200000
    s_cbranch_scc1 O_poll0
O_poll0_done:
    buffer_load_dwordx4 v[176:179], v7, s[24:27], s40 offen offset:0 sc1
    buffer_load_dwordx4 v[180:183], v7, s[24:27], s40 offen offset:1024 sc1
    buffer_load_dwordx4 v[192:195], v7, s[24:27], s41 offen offset:0 sc1
    buffer_load_dwordx4 v[196:199], v7, s[24:27], s41 offen offset:1024 sc1
    buffer_load_dwordx4 v[208:211], v7, s[24:27], s42 offen offset:0 sc1
    buffer_load_dwordx4 v[212:215], v7, s[24:27], s42 offen offset:1024 sc1
    s_waitcnt vmcnt(4)
    v_lshlrev_b32 v128, 16, v176
    v_and_b32 v129, 0xffff0000, v176
    v_lshlrev_b32 v130, 16, v177
    v_and_b32 v131, 0xffff0000, v177
    v_lshlrev_b32 v132, 16, v178
    v_and_b32 v133, 0xffff0000, v178
    v_lshlrev_b32 v134, 16, v179
    v_and_b32 v135, 0xffff0000, v179
    v_lshlrev_b32 v136, 16, v180
    v_and_b32 v137, 0xffff0000, v180
    v_lshlrev_b32 v138, 16, v181
    v_and_b32 v139, 0xffff0000, v181
    v_lshlrev_b32 v140, 16, v182
    v_and_b32 v141, 0xffff0000, v182
    v_lshlrev_b32 v142, 16, v183
    v_and_b32 v143, 0xffff0000, v183
    v_pk_add_f32 v[64:65], v[64:65], v[128:129]
    v_pk_add_f32 v[66:67], v[66:67], v[130:131]
    v_pk_add_f32 v[68:69], v[68:69], v[132:133]
    v_pk_add_f32 v[70:71], v[70:71], v[134:135]
    v_pk_add_f32 v[72:73], v[72:73], v[136:137]
    v_pk_add_f32 v[74:75], v[74:75], v[138:139]
    v_pk_add_f32 v[76:77], v[76:77], v[140:141]
    v_pk_add_f32 v[78:79], v[78:79], v[142:143]
    s_waitcnt vmcnt(2)
    v_lshlrev_b32 v128, 16, v192
    v_and_b32 v129, 0xffff0000, v192
    v_lshlrev_b32 v130, 16, v193
    v_and_b32 v131, 0xffff0000, v193
    v_lshlrev_b32 v132, 16, v194
    v_and_b32 v133, 0xffff0000, v194
    v_lshlrev_b32 v134, 16, v195
    v_and_b32 v135, 0xffff0000, v195
    v_lshlrev_b32 v136, 16, v196
    v_and_b32 v137, 0xffff0000, v196
    v_lshlrev_b32 v138, 16, v197
    v_and_b32 v139, 0xffff0000, v197
    v_lshlrev_b32 v140, 16, v198
    v_and_b32 v141, 0xffff0000, v198
    v_lshlrev_b32 v142, 16, v199
    v_and_b32 v143, 0xffff0000, v199
    v_pk_add_f32 v[64:65], v[64:65], v[128:129]
    v_pk_add_f32 v[66:67], v[66:67], v[130:131]
    v_pk_add_f32 v[68:69], v[68:69], v[132:133]
    v_pk_add_f32 v[70:71], v[70:71], v[134:135]
    v_pk_add_f32 v[72:73], v[72:73], v[136:137]
    v_pk_add_f32 v[74:75], v[74:75], v[138:139]
    v_pk_add_f32 v[76:77], v[76:77], v[140:141]
    v_pk_add_f32 v[78:79], v[78:79], v[142:143]
    s_waitcnt vmcnt(0)
    v_lshlrev_b32 v128, 16, v208
    v_and_b32 v129, 0xffff0000, v208
    v_lshlrev_b32 v130, 16, v209
    v_and_b32 v131, 0xffff0000, v209
    v_lshlrev_b32 v132, 16, v210
    v_and_b32 v133, 0xffff0000, v210
    v_lshlrev_b32 v134, 16, v211
    v_and_b32 v135, 0xffff0000, v211
    v_lshlrev_b32 v136, 16, v212
    v_and_b32 v137, 0xffff0000, v212
    v_lshlrev_b32 v138, 16, v213
    v_and_b32 v139, 0xffff0000, v213
    v_lshlrev_b32 v140, 16, v214
    v_and_b32 v141, 0xffff0000, v214
    v_lshlrev_b32 v142, 16, v215
    v_and_b32 v143, 0xffff0000, v215
    v_pk_add_f32 v[64:65], v[64:65], v[128:129]
    v_pk_add_f32 v[66:67], v[66:67], v[130:131]
    v_pk_add_f32 v[68:69], v[68:69], v[132:133]
    v_pk_add_f32 v[70:71], v[70:71], v[134:135]
    v_pk_add_f32 v[72:73], v[72:73], v[136:137]
    v_pk_add_f32 v[74:75], v[74:75], v[138:139]
    v_pk_add_f32 v[76:77], v[76:77], v[140:141]
    v_pk_add_f32 v[78:79], v[78:79], v[142:143]
    v_cvt_pk_bf16_f32 v24, v64, v65
    v_cvt_pk_bf16_f32 v25, v66, v67
    v_cvt_pk_bf16_f32 v26, v68, v69
    v_cvt_pk_bf16_f32 v27, v70, v71
    v_cvt_pk_bf16_f32 v28, v72, v73
    v_cvt_pk_bf16_f32 v29, v74, v75
    v_cvt_pk_bf16_f32 v30, v76, v77
    v_cvt_pk_bf16_f32 v31, v78, v79
    s_nop 0
    v_permlane16_swap_b32 v24, v28
    v_permlane16_swap_b32 v25, v29
    v_permlane16_swap_b32 v26, v30
    v_permlane16_swap_b32 v27, v31
    s_add_u32 s52, s32, 20480
    s_nop 0
    buffer_store_dwordx4 v[24:27], v12, s[44:47], s32 offen sc1
    buffer_store_dwordx4 v[28:31], v12, s[44:47], s52 offen sc1
    s_endpgm
PAD8:
    s_branch BK8
K_bgrp:
    s_barrier
    ds_read_b128 v[16:19], v11 offset:0
    ds_read_b128 v[20:23], v12 offset:0
    ds_read_b128 v[24:27], v13 offset:0
    ds_read_b128 v[28:31], v14 offset:0
    s_waitcnt lgkmcnt(0)
    s_barrier
    ds_read_b128 v[32:35], v11 offset:12288
    ds_read_b128 v[36:39], v12 offset:12288
    ds_read_b128 v[40:43], v13 offset:12288
    ds_read_b128 v[44:47], v14 offset:12288
    s_waitcnt lgkmcnt(0)
    s_barrier
    ds_read_b128 v[48:51], v252 offset:0
    ds_read_b128 v[52:55], v253 offset:0
    ds_read_b128 v[56:59], v254 offset:0
    ds_read_b128 v[60:63], v255 offset:0
    s_waitcnt lgkmcnt(0)
    s_barrier
    ds_read_b128 v[128:131], v252 offset:12288
    ds_read_b128 v[132:135], v253 offset:12288
    ds_read_b128 v[136:139], v254 offset:12288
    ds_read_b128 v[140:143], v255 offset:12288
    s_waitcnt lgkmcnt(0)
    s_barrier
    ds_read_b128 v[144:147], v11 offset:0
    ds_read_b128 v[148:151], v12 offset:0
    ds_read_b128 v[152:155], v13 offset:0
    ds_read_b128 v[156:159], v14 offset:0
    s_waitcnt lgkmcnt(0)
    s_barrier
    ds_read_b128 v[160:163], v11 offset:12288
    ds_read_b128 v[164:167], v12 offset:12288
    ds_read_b128 v[168:171], v13 offset:12288
    ds_read_b128 v[172:175], v14 offset:12288
    s_waitcnt lgkmcnt(0)
    s_barrier
    ds_read_b128 v[176:179], v252 offset:0
    ds_read_b128 v[180:183], v253 offset:0
    ds_read_b128 v[184:187], v254 offset:0
    ds_read_b128 v[188:191], v255 offset:0
    s_waitcnt lgkmcnt(0)
    s_barrier
    ds_read_b128 v[192:195], v252 offset:12288
    ds_read_b128 v[196:199], v253 offset:12288
    ds_read_b128 v[200:203], v254 offset:12288
    ds_read_b128 v[204:207], v255 offset:12288
    s_waitcnt lgkmcnt(0)
    s_setprio 1
    s_barrier
    s_barrier
    s_barrier
    s_barrier
    s_barrier
    ds_read_b128 v[240:243], v11 offset:0
    ds_read_b64_tr_b16 v[208:209], v10 offset:0
    ds_read_b64_tr_b16 v[210:211], v10 offset:4352
    ds_read_b64_tr_b16 v[212:213], v10 offset:64
    ds_read_b64_tr_b16 v[214:215], v10 offset:4416
    ds_read_b64_tr_b16 v[216:217], v10 offset:128
    ds_read_b64_tr_b16 v[218:219], v10 offset:4480
    ds_read_b64_tr_b16 v[220:221], v10 offset:192
    ds_read_b64_tr_b16 v[222:223], v10 offset:4544
    ds_read_b64_tr_b16 v[224:225], v10 offset:256
    ds_read_b64_tr_b16 v[226:227], v10 offset:4608
    s_waitcnt lgkmcnt(8)
    v_mfma_f32_32x32x16_bf16 v[64:79], v[208:211], v[240:243], 0
    s_waitcnt lgkmcnt(6)
    ds_read_b128 v[244:247], v12 offset:0
    ds_read_b64_tr_b16 v[228:229], v10 offset:320
    ds_read_b64_tr_b16 v[230:231], v10 offset:4672
    v_mfma_f32_32x32x16_bf16 v[80:95], v[212:215], v[240:243], 0
    s_waitcnt lgkmcnt(7)
    ds_read_b64_tr_b16 v[232:233], v10 offset:384
    ds_read_b64_tr_b16 v[234:235], v10 offset:4736
    ds_read_b64_tr_b16 v[236:237], v10 offset:448
    v_mfma_f32_32x32x16_bf16 v[96:111], v[216:219], v[240:243], 0
    s_waitcnt lgkmcnt(8)
    ds_read_b64_tr_b16 v[238:239], v10 offset:4800
    ds_read_b64_tr_b16 v[208:209], v10 offset:512
    ds_read_b64_tr_b16 v[210:211], v10 offset:4864
    v_mfma_f32_32x32x16_bf16 v[112:127], v[220:223], v[240:243], 0
    s_waitcnt lgkmcnt(8)
    ds_read_b64_tr_b16 v[212:213], v10 offset:576
    ds_read_b64_tr_b16 v[214:215], v10 offset:4928
    ds_read_b64_tr_b16 v[216:217], v10 offset:640
    v_mfma_f32_32x32x16_bf16 v[64:79], v[224:227], v[244:247], v[64:79]
    s_waitcnt lgkmcnt(9)
    ds_read_b128 v[240:243], v13 offset:0
    ds_read_b64_tr_b16 v[218:219], v10 offset:4992
    ds_read_b64_tr_b16 v[220:221], v10 offset:704
    v_mfma_f32_32x32x16_bf16 v[80:95], v[228:231], v[244:247], v[80:95]
    s_waitcnt lgkmcnt(10)
    ds_read_b64_tr_b16 v[222:223], v10 offset:5056
    ds_read_b64_tr_b16 v[224:225], v10 offset:768
    ds_read_b64_tr_b16 v[226:227], v10 offset:5120
    v_mfma_f32_32x32x16_bf16 v[96:111], v[232:235], v[244:247], v[96:111]
    s_waitcnt lgkmcnt(11)
    ds_read_b64_tr_b16 v[228:229], v10 offset:832
    ds_read_b64_tr_b16 v[230:231], v10 offset:5184
    v_mfma_f32_32x32x16_bf16 v[112:127], v[236:239], v[244:247], v[112:127]
    s_waitcnt lgkmcnt(7)
    ds_read_b64_tr_b16 v[232:233], v10 offset:896
    ds_read_b64_tr_b16 v[234:235], v10 offset:5248
    v_mfma_f32_32x32x16_bf16 v[64:79], v[208:211], v[240:243], v[64:79]
    ds_read_b128 v[244:247], v14 offset:0
    ds_read_b64_tr_b16 v[236:237], v10 offset:960
    ds_read_b64_tr_b16 v[238:239], v10 offset:5312
    v_mfma_f32_32x32x16_bf16 v[80:95], v[212:215], v[240:243], v[80:95]
    s_waitcnt lgkmcnt(11)
    v_mfma_f32_32x32x16_bf16 v[96:111], v[216:219], v[240:243], v[96:111]
    s_waitcnt lgkmcnt(9)
    v_mfma_f32_32x32x16_bf16 v[112:127], v[220:223], v[240:243], v[112:127]
    s_waitcnt lgkmcnt(0)
    v_mfma_f32_32x32x16_bf16 v[64:79], v[224:227], v[244:247], v[64:79]
    s_barrier
    ds_read_b128 v[240:243], v11 offset:12288
    ds_read_b64_tr_b16 v[208:209], v10 offset:17408
    v_mfma_f32_32x32x16_bf16 v[80:95], v[228:231], v[244:247], v[80:95]
    ds_read_b64_tr_b16 v[210:211], v10 offset:21760
    ds_read_b64_tr_b16 v[212:213], v10 offset:17472
    ds_read_b64_tr_b16 v[214:215], v10 offset:21824
    v_mfma_f32_32x32x16_bf16 v[96:111], v[232:235], v[244:247], v[96:111]
    ds_read_b64_tr_b16 v[216:217], v10 offset:17536
    ds_read_b64_tr_b16 v[218:219], v10 offset:21888
    ds_read_b64_tr_b16 v[220:221], v10 offset:17600
    v_mfma_f32_32x32x16_bf16 v[112:127], v[236:239], v[244:247], v[112:127]
    s_waitcnt lgkmcnt(5)
    ds_read_b64_tr_b16 v[222:223], v10 offset:21952
    ds_read_b64_tr_b16 v[224:225], v10 offset:17664
    ds_read_b64_tr_b16 v[226:227], v10 offset:22016
    v_mfma_f32_32x32x16_bf16 v[64:79], v[208:211], v[240:243], v[64:79]
    s_waitcnt lgkmcnt(6)
    ds_read_b128 v[244:247], v12 offset:12288
    ds_read_b64_tr_b16 v[228:229], v10 offset:17728
    ds_read_b64_tr_b16 v[230:231], v10 offset:22080
    v_mfma_f32_32x32x16_bf16 v[80:95], v[212:215], v[240:243], v[80:95]
    s_waitcnt lgkmcnt(7)
    ds_read_b64_tr_b16 v[232:233], v10 offset:17792
    ds_read_b64_tr_b16 v[234:235], v10 offset:22144
    ds_read_b64_tr_b16 v[236:237], v10 offset:17856
    v_mfma_f32_32x32x16_bf16 v[96:111], v[216:219], v[240:243], v[96:111]
    s_waitcnt lgkmcnt(8)
    ds_read_b64_tr_b16 v[238:239], v10 offset:22208
    ds_read_b64_tr_b16 v[208:209], v10 offset:17920
    ds_read_b64_tr_b16 v[210:211], v10 offset:22272
    v_mfma_f32_32x32x16_bf16 v[112:127], v[220:223], v[240:243], v[112:127]
    s_waitcnt lgkmcnt(8)
    ds_read_b64_tr_b16 v[212:213], v10 offset:17984
    ds_read_b64_tr_b16 v[214:215], v10 offset:22336
    ds_read_b64_tr_b16 v[216:217], v10 offset:18048
    v_mfma_f32_32x32x16_bf16 v[64:79], v[224:227], v[244:247], v[64:79]
    s_waitcnt lgkmcnt(9)
    ds_read_b128 v[240:243], v13 offset:12288
    ds_read_b64_tr_b16 v[218:219], v10 offset:22400
    ds_read_b64_tr_b16 v[220:221], v10 offset:18112
    v_mfma_f32_32x32x16_bf16 v[80:95], v[228:231], v[244:247], v[80:95]
    s_waitcnt lgkmcnt(10)
    ds_read_b64_tr_b16 v[222:223], v10 offset:22464
    v_mfma_f32_32x32x16_bf16 v[96:111], v[232:235], v[244:247], v[96:111]
    s_waitcnt lgkmcnt(9)
    v_mfma_f32_32x32x16_bf16 v[112:127], v[236:239], v[244:247], v[112:127]
    s_waitcnt lgkmcnt(0)
    v_mfma_f32_32x32x16_bf16 v[64:79], v[208:211], v[240:243], v[64:79]
    s_barrier
    ds_read_b128 v[244:247], v14 offset:12288
    ds_read_b64_tr_b16 v[224:225], v10 offset:18176
    v_mfma_f32_32x32x16_bf16 v[80:95], v[212:215], v[240:243], v[80:95]
    ds_read_b64_tr_b16 v[226:227], v10 offset:22528
    ds_read_b64_tr_b16 v[228:229], v10 offset:18240
    ds_read_b64_tr_b16 v[230:231], v10 offset:22592
    v_mfma_f32_32x32x16_bf16 v[96:111], v[216:219], v[240:243], v[96:111]
    ds_read_b64_tr_b16 v[232:233], v10 offset:18304
    ds_read_b64_tr_b16 v[234:235], v10 offset:22656
    ds_read_b64_tr_b16 v[236:237], v10 offset:18368
    v_mfma_f32_32x32x16_bf16 v[112:127], v[220:223], v[240:243], v[112:127]
    s_waitcnt lgkmcnt(5)
    ds_read_b64_tr_b16 v[238:239], v10 offset:22720
    ds_read_b64_tr_b16 v[208:209], v10 offset:34816
    ds_read_b64_tr_b16 v[210:211], v10 offset:39168
    v_mfma_f32_32x32x16_bf16 v[64:79], v[224:227], v[244:247], v[64:79]
    s_waitcnt lgkmcnt(6)
    ds_read_b64_tr_b16 v[212:213], v10 offset:34880
    ds_read_b64_tr_b16 v[214:215], v10 offset:39232
    v_mfma_f32_32x32x16_bf16 v[80:95], v[228:231], v[244:247], v[80:95]
    s_waitcnt lgkmcnt(6)
    ds_read_b64_tr_b16 v[216:217], v10 offset:34944
    ds_read_b64_tr_b16 v[218:219], v10 offset:39296
    ds_read_b64_tr_b16 v[220:221], v10 offset:35008
    v_mfma_f32_32x32x16_bf16 v[96:111], v[232:235], v[244:247], v[96:111]
    s_waitcnt lgkmcnt(7)
    ds_read_b64_tr_b16 v[222:223], v10 offset:39360
    ds_read_b64_tr_b16 v[224:225], v10 offset:35072
    ds_read_b64_tr_b16 v[226:227], v10 offset:39424
    v_mfma_f32_32x32x16_bf16 v[112:127], v[236:239], v[244:247], v[112:127]
    s_waitcnt lgkmcnt(8)
    ds_read_b64_tr_b16 v[228:229], v10 offset:35136
    ds_read_b64_tr_b16 v[230:231], v10 offset:39488
    ds_read_b64_tr_b16 v[232:233], v10 offset:35200
    v_mfma_f32_32x32x16_bf16 v[64:79], v[208:211], v[16:19], v[64:79]
    s_waitcnt lgkmcnt(9)
    ds_read_b64_tr_b16 v[234:235], v10 offset:39552
    ds_read_b64_tr_b16 v[236:237], v10 offset:35264
    v_mfma_f32_32x32x16_bf16 v[80:95], v[212:215], v[16:19], v[80:95]
    s_waitcnt lgkmcnt(9)
    ds_read_b64_tr_b16 v[238:239], v10 offset:39616
    v_mfma_f32_32x32x16_bf16 v[96:111], v[216:219], v[16:19], v[96:111]
    s_waitcnt lgkmcnt(8)
    v_mfma_f32_32x32x16_bf16 v[112:127], v[220:223], v[16:19], v[112:127]
    s_waitcnt lgkmcnt(0)
    v_mfma_f32_32x32x16_bf16 v[64:79], v[224:227], v[20:23], v[64:79]
    s_barrier
    ds_read_b64_tr_b16 v[208:209], v10 offset:35328
    v_mfma_f32_32x32x16_bf16 v[80:95], v[228:231], v[20:23], v[80:95]
    ds_read_b64_tr_b16 v[210:211], v10 offset:39680
    ds_read_b64_tr_b16 v[212:213], v10 offset:35392
    ds_read_b64_tr_b16 v[214:215], v10 offset:39744
    v_mfma_f32_32x32x16_bf16 v[96:111], v[232:235], v[20:23], v[96:111]
    ds_read_b64_tr_b16 v[216:217], v10 offset:35456
    ds_read_b64_tr_b16 v[218:219], v10 offset:39808
    ds_read_b64_tr_b16 v[220:221], v10 offset:35520
    v_mfma_f32_32x32x16_bf16 v[112:127], v[236:239], v[20:23], v[112:127]
    s_waitcnt lgkmcnt(5)
    ds_read_b64_tr_b16 v[222:223], v10 offset:39872
    ds_read_b64_tr_b16 v[224:225], v10 offset:35584
    ds_read_b64_tr_b16 v[226:227], v10 offset:39936
    v_mfma_f32_32x32x16_bf16 v[64:79], v[208:211], v[24:27], v[64:79]
    s_waitcnt lgkmcnt(6)
    ds_read_b64_tr_b16 v[228:229], v10 offset:35648
    ds_read_b64_tr_b16 v[230:231], v10 offset:40000
    v_mfma_f32_32x32x16_bf16 v[80:95], v[212:215], v[24:27], v[80:95]
    s_waitcnt lgkmcnt(6)
    ds_read_b64_tr_b16 v[232:233], v10 offset:35712
    ds_read_b64_tr_b16 v[234:235], v10 offset:40064
    ds_read_b64_tr_b16 v[236:237], v10 offset:35776
    v_mfma_f32_32x32x16_bf16 v[96:111], v[216:219], v[24:27], v[96:111]
    s_waitcnt lgkmcnt(7)
    ds_read_b64_tr_b16 v[238:239], v10 offset:40128
    ds_read_b64_tr_b16 v[208:209], v10 offset:0
    ds_read_b64_tr_b16 v[210:211], v10 offset:4352
    v_mfma_f32_32x32x16_bf16 v[112:127], v[220:223], v[24:27], v[112:127]
    s_waitcnt lgkmcnt(8)
    ds_read_b64_tr_b16 v[212:213], v10 offset:64
    ds_read_b64_tr_b16 v[214:215], v10 offset:4416
    ds_read_b64_tr_b16 v[216:217], v10 offset:128
    v_mfma_f32_32x32x16_bf16 v[64:79], v[224:227], v[28:31], v[64:79]
    s_waitcnt lgkmcnt(9)
    ds_read_b64_tr_b16 v[218:219], v10 offset:4480
    ds_read_b64_tr_b16 v[220:221], v10 offset:192
    v_mfma_f32_32x32x16_bf16 v[80:95], v[228:231], v[28:31], v[80:95]
    s_waitcnt lgkmcnt(9)
    ds_read_b64_tr_b16 v[222:223], v10 offset:4544
    v_mfma_f32_32x32x16_bf16 v[96:111], v[232:235], v[28:31], v[96:111]
    s_waitcnt lgkmcnt(8)
    v_mfma_f32_32x32x16_bf16 v[112:127], v[236:239], v[28:31], v[112:127]
    s_waitcnt lgkmcnt(0)
    v_mfma_f32_32x32x16_bf16 v[64:79], v[208:211], v[32:35], v[64:79]
    s_barrier
    ds_read_b64_tr_b16 v[224:225], v10 offset:256
    v_mfma_f32_32x32x16_bf16 v[80:95], v[212:215], v[32:35], v[80:95]
    ds_read_b64_tr_b16 v[226:227], v10 offset:4608
    ds_read_b64_tr_b16 v[228:229], v10 offset:320
    ds_read_b64_tr_b16 v[230:231], v10 offset:4672
    v_mfma_f32_32x32x16_bf16 v[96:111], v[216:219], v[32:35], v[96:111]
    ds_read_b64_tr_b16 v[232:233], v10 offset:384
    ds_read_b64_tr_b16 v[234:235], v10 offset:4736
    ds_read_b64_tr_b16 v[236:237], v10 offset:448
    v_mfma_f32_32x32x16_bf16 v[112:127], v[220:223], v[32:35], v[112:127]
    s_waitcnt lgkmcnt(5)
    ds_read_b64_tr_b16 v[238:239], v10 offset:4800
    ds_read_b64_tr_b16 v[208:209], v10 offset:512
    ds_read_b64_tr_b16 v[210:211], v10 offset:4864
    v_mfma_f32_32x32x16_bf16 v[64:79], v[224:227], v[36:39], v[64:79]
    s_waitcnt lgkmcnt(6)
    ds_read_b64_tr_b16 v[212:213], v10 offset:576
    ds_read_b64_tr_b16 v[214:215], v10 offset:4928
    v_mfma_f32_32x32x16_bf16 v[80:95], v[228:231], v[36:39], v[80:95]
    s_waitcnt lgkmcnt(6)
    ds_read_b64_tr_b16 v[216:217], v10 offset:640
    ds_read_b64_tr_b16 v[218:219], v10 offset:4992
    ds_read_b64_tr_b16 v[220:221], v10 offset:704
    v_mfma_f32_32x32x16_bf16 v[96:111], v[232:235], v[36:39], v[96:111]
    s_waitcnt lgkmcnt(7)
    ds_read_b64_tr_b16 v[222:223], v10 offset:5056
    ds_read_b64_tr_b16 v[224:225], v10 offset:768
    ds_read_b64_tr_b16 v[226:227], v10 offset:5120
    v_mfma_f32_32x32x16_bf16 v[112:127], v[236:239], v[36:39], v[112:127]
    s_waitcnt lgkmcnt(8)
    ds_read_b64_tr_b16 v[228:229], v10 offset:832
    ds_read_b64_tr_b16 v[230:231], v10 offset:5184
    ds_read_b64_tr_b16 v[232:233], v10 offset:896
    v_mfma_f32_32x32x16_bf16 v[64:79], v[208:211], v[40:43], v[64:79]
    s_waitcnt lgkmcnt(9)
    ds_read_b64_tr_b16 v[234:235], v10 offset:5248
    ds_read_b64_tr_b16 v[236:237], v10 offset:960
    v_mfma_f32_32x32x16_bf16 v[80:95], v[212:215], v[40:43], v[80:95]
    s_waitcnt lgkmcnt(9)
    ds_read_b64_tr_b16 v[238:239], v10 offset:5312
    v_mfma_f32_32x32x16_bf16 v[96:111], v[216:219], v[40:43], v[96:111]
    s_waitcnt lgkmcnt(8)
    v_mfma_f32_32x32x16_bf16 v[112:127], v[220:223], v[40:43], v[112:127]
    s_waitcnt lgkmcnt(0)
    v_mfma_f32_32x32x16_bf16 v[64:79], v[224:227], v[44:47], v[64:79]
    s_barrier
    ds_read_b64_tr_b16 v[208:209], v10 offset:17408
    v_mfma_f32_32x32x16_bf16 v[80:95], v[228:231], v[44:47], v[80:95]
    ds_read_b64_tr_b16 v[210:211], v10 offset:21760
    ds_read_b64_tr_b16 v[212:213], v10 offset:17472
    ds_read_b64_tr_b16 v[214:215], v10 offset:21824
    v_mfma_f32_32x32x16_bf16 v[96:111], v[232:235], v[44:47], v[96:111]
    ds_read_b64_tr_b16 v[216:217], v10 offset:17536
    ds_read_b64_tr_b16 v[218:219], v10 offset:21888
    ds_read_b64_tr_b16 v[220:221], v10 offset:17600
    v_mfma_f32_32x32x16_bf16 v[112:127], v[236:239], v[44:47], v[112:127]
    s_waitcnt lgkmcnt(5)
    ds_read_b64_tr_b16 v[222:223], v10 offset:21952
    ds_read_b64_tr_b16 v[224:225], v10 offset:17664
    ds_read_b64_tr_b16 v[226:227], v10 offset:22016
    v_mfma_f32_32x32x16_bf16 v[64:79], v[208:211], v[48:51], v[64:79]
    s_waitcnt lgkmcnt(6)
    ds_read_b64_tr_b16 v[228:229], v10 offset:17728
    ds_read_b64_tr_b16 v[230:231], v10 offset:22080
    v_mfma_f32_32x32x16_bf16 v[80:95], v[212:215], v[48:51], v[80:95]
    s_waitcnt lgkmcnt(6)
    ds_read_b64_tr_b16 v[232:233], v10 offset:17792
    ds_read_b64_tr_b16 v[234:235], v10 offset:22144
    ds_read_b64_tr_b16 v[236:237], v10 offset:17856
    v_mfma_f32_32x32x16_bf16 v[96:111], v[216:219], v[48:51], v[96:111]
    s_waitcnt lgkmcnt(7)
    ds_read_b64_tr_b16 v[238:239], v10 offset:22208
    ds_read_b64_tr_b16 v[208:209], v10 offset:17920
    ds_read_b64_tr_b16 v[210:211], v10 offset:22272
    v_mfma_f32_32x32x16_bf16 v[112:127], v[220:223], v[48:51], v[112:127]
    s_waitcnt lgkmcnt(8)
    ds_read_b64_tr_b16 v[212:213], v10 offset:17984
    ds_read_b64_tr_b16 v[214:215], v10 offset:22336
    ds_read_b64_tr_b16 v[216:217], v10 offset:18048
    v_mfma_f32_32x32x16_bf16 v[64:79], v[224:227], v[52:55], v[64:79]
    s_waitcnt lgkmcnt(9)
    ds_read_b64_tr_b16 v[218:219], v10 offset:22400
    ds_read_b64_tr_b16 v[220:221], v10 offset:18112
    v_mfma_f32_32x32x16_bf16 v[80:95], v[228:231], v[52:55], v[80:95]
    s_branch SK9
PAD9:
    s_branch BK9
SK9:
    s_waitcnt lgkmcnt(9)
    ds_read_b64_tr_b16 v[222:223], v10 offset:22464
    v_mfma_f32_32x32x16_bf16 v[96:111], v[232:235], v[52:55], v[96:111]
    s_waitcnt lgkmcnt(8)
    v_mfma_f32_32x32x16_bf16 v[112:127], v[236:239], v[52:55], v[112:127]
    s_waitcnt lgkmcnt(0)
    v_mfma_f32_32x32x16_bf16 v[64:79], v[208:211], v[56:59], v[64:79]
    s_barrier
    ds_read_b64_tr_b16 v[224:225], v10 offset:18176
    v_mfma_f32_32x32x16_bf16 v[80:95], v[212:215], v[56:59], v[80:95]
    ds_read_b64_tr_b16 v[226:227], v10 offset:22528
    ds_read_b64_tr_b16 v[228:229], v10 offset:18240
    ds_read_b64_tr_b16 v[230:231], v10 offset:22592
    v_mfma_f32_32x32x16_bf16 v[96:111], v[216:219], v[56:59], v[96:111]
    ds_read_b64_tr_b16 v[232:233], v10 offset:18304
    ds_read_b64_tr_b16 v[234:235], v10 offset:22656
    ds_read_b64_tr_b16 v[236:237], v10 offset:18368
    v_mfma_f32_32x32x16_bf16 v[112:127], v[220:223], v[56:59], v[112:127]
    s_waitcnt lgkmcnt(5)
    ds_read_b64_tr_b16 v[238:239], v10 offset:22720
    ds_read_b64_tr_b16 v[208:209], v10 offset:34816
    ds_read_b64_tr_b16 v[210:211], v10 offset:39168
    v_mfma_f32_32x32x16_bf16 v[64:79], v[224:227], v[60:63], v[64:79]
    s_waitcnt lgkmcnt(6)
    ds_read_b64_tr_b16 v[212:213], v10 offset:34880
    ds_read_b64_tr_b16 v[214:215], v10 offset:39232
    v_mfma_f32_32x32x16_bf16 v[80:95], v[228:231], v[60:63], v[80:95]
    s_waitcnt lgkmcnt(6)
    ds_read_b64_tr_b16 v[216:217], v10 offset:34944
    ds_read_b64_tr_b16 v[218:219], v10 offset:39296
    ds_read_b64_tr_b16 v[220:221], v10 offset:35008
    v_mfma_f32_32x32x16_bf16 v[96:111], v[232:235], v[60:63], v[96:111]
    s_waitcnt lgkmcnt(7)
    ds_read_b64_tr_b16 v[222:223], v10 offset:39360
    ds_read_b64_tr_b16 v[224:225], v10 offset:35072
    ds_read_b64_tr_b16 v[226:227], v10 offset:39424
    v_mfma_f32_32x32x16_bf16 v[112:127], v[236:239], v[60:63], v[112:127]
    s_waitcnt lgkmcnt(8)
    ds_read_b64_tr_b16 v[228:229], v10 offset:35136
    ds_read_b64_tr_b16 v[230:231], v10 offset:39488
    ds_read_b64_tr_b16 v[232:233], v10 offset:35200
    v_mfma_f32_32x32x16_bf16 v[64:79], v[208:211], v[128:131], v[64:79]
    s_waitcnt lgkmcnt(9)
    ds_read_b64_tr_b16 v[234:235], v10 offset:39552
    ds_read_b64_tr_b16 v[236:237], v10 offset:35264
    v_mfma_f32_32x32x16_bf16 v[80:95], v[212:215], v[128:131], v[80:95]
    s_waitcnt lgkmcnt(9)
    ds_read_b64_tr_b16 v[238:239], v10 offset:39616
    v_mfma_f32_32x32x16_bf16 v[96:111], v[216:219], v[128:131], v[96:111]
    s_waitcnt lgkmcnt(8)
    v_mfma_f32_32x32x16_bf16 v[112:127], v[220:223], v[128:131], v[112:127]
    s_waitcnt lgkmcnt(0)
    v_mfma_f32_32x32x16_bf16 v[64:79], v[224:227], v[132:135], v[64:79]
    s_barrier
    ds_read_b64_tr_b16 v[208:209], v10 offset:35328
    v_mfma_f32_32x32x16_bf16 v[80:95], v[228:231], v[132:135], v[80:95]
    ds_read_b64_tr_b16 v[210:211], v10 offset:39680
    ds_read_b64_tr_b16 v[212:213], v10 offset:35392
    ds_read_b64_tr_b16 v[214:215], v10 offset:39744
    v_mfma_f32_32x32x16_bf16 v[96:111], v[232:235], v[132:135], v[96:111]
    ds_read_b64_tr_b16 v[216:217], v10 offset:35456
    ds_read_b64_tr_b16 v[218:219], v10 offset:39808
    ds_read_b64_tr_b16 v[220:221], v10 offset:35520
    v_mfma_f32_32x32x16_bf16 v[112:127], v[236:239], v[132:135], v[112:127]
    s_waitcnt lgkmcnt(5)
    ds_read_b64_tr_b16 v[222:223], v10 offset:39872
    ds_read_b64_tr_b16 v[224:225], v10 offset:35584
    ds_read_b64_tr_b16 v[226:227], v10 offset:39936
    v_mfma_f32_32x32x16_bf16 v[64:79], v[208:211], v[136:139], v[64:79]
    s_waitcnt lgkmcnt(6)
    ds_read_b64_tr_b16 v[228:229], v10 offset:35648
    ds_read_b64_tr_b16 v[230:231], v10 offset:40000
    v_mfma_f32_32x32x16_bf16 v[80:95], v[212:215], v[136:139], v[80:95]
    s_waitcnt lgkmcnt(6)
    ds_read_b64_tr_b16 v[232:233], v10 offset:35712
    ds_read_b64_tr_b16 v[234:235], v10 offset:40064
    ds_read_b64_tr_b16 v[236:237], v10 offset:35776
    v_mfma_f32_32x32x16_bf16 v[96:111], v[216:219], v[136:139], v[96:111]
    s_waitcnt lgkmcnt(7)
    ds_read_b64_tr_b16 v[238:239], v10 offset:40128
    ds_read_b64_tr_b16 v[208:209], v10 offset:0
    ds_read_b64_tr_b16 v[210:211], v10 offset:4352
    v_mfma_f32_32x32x16_bf16 v[112:127], v[220:223], v[136:139], v[112:127]
    s_waitcnt lgkmcnt(8)
    ds_read_b64_tr_b16 v[212:213], v10 offset:64
    ds_read_b64_tr_b16 v[214:215], v10 offset:4416
    ds_read_b64_tr_b16 v[216:217], v10 offset:128
    v_mfma_f32_32x32x16_bf16 v[64:79], v[224:227], v[140:143], v[64:79]
    s_waitcnt lgkmcnt(9)
    ds_read_b64_tr_b16 v[218:219], v10 offset:4480
    ds_read_b64_tr_b16 v[220:221], v10 offset:192
    v_mfma_f32_32x32x16_bf16 v[80:95], v[228:231], v[140:143], v[80:95]
    s_waitcnt lgkmcnt(9)
    ds_read_b64_tr_b16 v[222:223], v10 offset:4544
    v_mfma_f32_32x32x16_bf16 v[96:111], v[232:235], v[140:143], v[96:111]
    s_waitcnt lgkmcnt(8)
    v_mfma_f32_32x32x16_bf16 v[112:127], v[236:239], v[140:143], v[112:127]
    s_waitcnt lgkmcnt(0)
    v_mfma_f32_32x32x16_bf16 v[64:79], v[208:211], v[144:147], v[64:79]
    s_barrier
    ds_read_b64_tr_b16 v[224:225], v10 offset:256
    v_mfma_f32_32x32x16_bf16 v[80:95], v[212:215], v[144:147], v[80:95]
    ds_read_b64_tr_b16 v[226:227], v10 offset:4608
    ds_read_b64_tr_b16 v[228:229], v10 offset:320
    ds_read_b64_tr_b16 v[230:231], v10 offset:4672
    v_mfma_f32_32x32x16_bf16 v[96:111], v[216:219], v[144:147], v[96:111]
    ds_read_b64_tr_b16 v[232:233], v10 offset:384
    ds_read_b64_tr_b16 v[234:235], v10 offset:4736
    ds_read_b64_tr_b16 v[236:237], v10 offset:448
    v_mfma_f32_32x32x16_bf16 v[112:127], v[220:223], v[144:147], v[112:127]
    s_waitcnt lgkmcnt(5)
    ds_read_b64_tr_b16 v[238:239], v10 offset:4800
    ds_read_b64_tr_b16 v[208:209], v10 offset:512
    ds_read_b64_tr_b16 v[210:211], v10 offset:4864
    v_mfma_f32_32x32x16_bf16 v[64:79], v[224:227], v[148:151], v[64:79]
    s_waitcnt lgkmcnt(6)
    ds_read_b64_tr_b16 v[212:213], v10 offset:576
    ds_read_b64_tr_b16 v[214:215], v10 offset:4928
    v_mfma_f32_32x32x16_bf16 v[80:95], v[228:231], v[148:151], v[80:95]
    s_waitcnt lgkmcnt(6)
    ds_read_b64_tr_b16 v[216:217], v10 offset:640
    ds_read_b64_tr_b16 v[218:219], v10 offset:4992
    ds_read_b64_tr_b16 v[220:221], v10 offset:704
    v_mfma_f32_32x32x16_bf16 v[96:111], v[232:235], v[148:151], v[96:111]
    s_waitcnt lgkmcnt(7)
    ds_read_b64_tr_b16 v[222:223], v10 offset:5056
    ds_read_b64_tr_b16 v[224:225], v10 offset:768
    ds_read_b64_tr_b16 v[226:227], v10 offset:5120
    v_mfma_f32_32x32x16_bf16 v[112:127], v[236:239], v[148:151], v[112:127]
    s_waitcnt lgkmcnt(8)
    ds_read_b64_tr_b16 v[228:229], v10 offset:832
    ds_read_b64_tr_b16 v[230:231], v10 offset:5184
    ds_read_b64_tr_b16 v[232:233], v10 offset:896
    v_mfma_f32_32x32x16_bf16 v[64:79], v[208:211], v[152:155], v[64:79]
    s_waitcnt lgkmcnt(9)
    ds_read_b64_tr_b16 v[234:235], v10 offset:5248
    ds_read_b64_tr_b16 v[236:237], v10 offset:960
    v_mfma_f32_32x32x16_bf16 v[80:95], v[212:215], v[152:155], v[80:95]
    s_waitcnt lgkmcnt(9)
    ds_read_b64_tr_b16 v[238:239], v10 offset:5312
    v_mfma_f32_32x32x16_bf16 v[96:111], v[216:219], v[152:155], v[96:111]
    s_waitcnt lgkmcnt(8)
    v_mfma_f32_32x32x16_bf16 v[112:127], v[220:223], v[152:155], v[112:127]
    s_waitcnt lgkmcnt(0)
    v_mfma_f32_32x32x16_bf16 v[64:79], v[224:227], v[156:159], v[64:79]
    s_barrier
    ds_read_b64_tr_b16 v[208:209], v10 offset:17408
    v_mfma_f32_32x32x16_bf16 v[80:95], v[228:231], v[156:159], v[80:95]
    ds_read_b64_tr_b16 v[210:211], v10 offset:21760
    ds_read_b64_tr_b16 v[212:213], v10 offset:17472
    ds_read_b64_tr_b16 v[214:215], v10 offset:21824
    v_mfma_f32_32x32x16_bf16 v[96:111], v[232:235], v[156:159], v[96:111]
    ds_read_b64_tr_b16 v[216:217], v10 offset:17536
    ds_read_b64_tr_b16 v[218:219], v10 offset:21888
    ds_read_b64_tr_b16 v[220:221], v10 offset:17600
    v_mfma_f32_32x32x16_bf16 v[112:127], v[236:239], v[156:159], v[112:127]
    s_waitcnt lgkmcnt(5)
    ds_read_b64_tr_b16 v[222:223], v10 offset:21952
    ds_read_b64_tr_b16 v[224:225], v10 offset:17664
    ds_read_b64_tr_b16 v[226:227], v10 offset:22016
    v_mfma_f32_32x32x16_bf16 v[64:79], v[208:211], v[160:163], v[64:79]
    s_waitcnt lgkmcnt(6)
    ds_read_b64_tr_b16 v[228:229], v10 offset:17728
    ds_read_b64_tr_b16 v[230:231], v10 offset:22080
    v_mfma_f32_32x32x16_bf16 v[80:95], v[212:215], v[160:163], v[80:95]
    s_waitcnt lgkmcnt(6)
    ds_read_b64_tr_b16 v[232:233], v10 offset:17792
    ds_read_b64_tr_b16 v[234:235], v10 offset:22144
    ds_read_b64_tr_b16 v[236:237], v10 offset:17856
    v_mfma_f32_32x32x16_bf16 v[96:111], v[216:219], v[160:163], v[96:111]
    s_waitcnt lgkmcnt(7)
    ds_read_b64_tr_b16 v[238:239], v10 offset:22208
    ds_read_b64_tr_b16 v[208:209], v10 offset:17920
    ds_read_b64_tr_b16 v[210:211], v10 offset:22272
    v_mfma_f32_32x32x16_bf16 v[112:127], v[220:223], v[160:163], v[112:127]
    s_waitcnt lgkmcnt(8)
    ds_read_b64_tr_b16 v[212:213], v10 offset:17984
    ds_read_b64_tr_b16 v[214:215], v10 offset:22336
    ds_read_b64_tr_b16 v[216:217], v10 offset:18048
    v_mfma_f32_32x32x16_bf16 v[64:79], v[224:227], v[164:167], v[64:79]
    s_waitcnt lgkmcnt(9)
    ds_read_b64_tr_b16 v[218:219], v10 offset:22400
    ds_read_b64_tr_b16 v[220:221], v10 offset:18112
    v_mfma_f32_32x32x16_bf16 v[80:95], v[228:231], v[164:167], v[80:95]
    s_waitcnt lgkmcnt(9)
    ds_read_b64_tr_b16 v[222:223], v10 offset:22464
    v_mfma_f32_32x32x16_bf16 v[96:111], v[232:235], v[164:167], v[96:111]
    s_waitcnt lgkmcnt(8)
    v_mfma_f32_32x32x16_bf16 v[112:127], v[236:239], v[164:167], v[112:127]
    s_waitcnt lgkmcnt(0)
    v_mfma_f32_32x32x16_bf16 v[64:79], v[208:211], v[168:171], v[64:79]
    s_barrier
    ds_read_b64_tr_b16 v[224:225], v10 offset:18176
    v_mfma_f32_32x32x16_bf16 v[80:95], v[212:215], v[168:171], v[80:95]
    ds_read_b64_tr_b16 v[226:227], v10 offset:22528
    ds_read_b64_tr_b16 v[228:229], v10 offset:18240
    ds_read_b64_tr_b16 v[230:231], v10 offset:22592
    v_mfma_f32_32x32x16_bf16 v[96:111], v[216:219], v[168:171], v[96:111]
    ds_read_b64_tr_b16 v[232:233], v10 offset:18304
    ds_read_b64_tr_b16 v[234:235], v10 offset:22656
    ds_read_b64_tr_b16 v[236:237], v10 offset:18368
    v_mfma_f32_32x32x16_bf16 v[112:127], v[220:223], v[168:171], v[112:127]
    s_waitcnt lgkmcnt(5)
    ds_read_b64_tr_b16 v[238:239], v10 offset:22720
    ds_read_b64_tr_b16 v[208:209], v10 offset:34816
    ds_read_b64_tr_b16 v[210:211], v10 offset:39168
    v_mfma_f32_32x32x16_bf16 v[64:79], v[224:227], v[172:175], v[64:79]
    s_waitcnt lgkmcnt(6)
    ds_read_b64_tr_b16 v[212:213], v10 offset:34880
    ds_read_b64_tr_b16 v[214:215], v10 offset:39232
    v_mfma_f32_32x32x16_bf16 v[80:95], v[228:231], v[172:175], v[80:95]
    s_waitcnt lgkmcnt(6)
    ds_read_b64_tr_b16 v[216:217], v10 offset:34944
    ds_read_b64_tr_b16 v[218:219], v10 offset:39296
    ds_read_b64_tr_b16 v[220:221], v10 offset:35008
    v_mfma_f32_32x32x16_bf16 v[96:111], v[232:235], v[172:175], v[96:111]
    s_waitcnt lgkmcnt(7)
    ds_read_b64_tr_b16 v[222:223], v10 offset:39360
    ds_read_b64_tr_b16 v[224:225], v10 offset:35072
    ds_read_b64_tr_b16 v[226:227], v10 offset:39424
    v_mfma_f32_32x32x16_bf16 v[112:127], v[236:239], v[172:175], v[112:127]
    s_waitcnt lgkmcnt(8)
    ds_read_b64_tr_b16 v[228:229], v10 offset:35136
    ds_read_b64_tr_b16 v[230:231], v10 offset:39488
    ds_read_b64_tr_b16 v[232:233], v10 offset:35200
    v_mfma_f32_32x32x16_bf16 v[64:79], v[208:211], v[176:179], v[64:79]
    s_waitcnt lgkmcnt(9)
    ds_read_b64_tr_b16 v[234:235], v10 offset:39552
    ds_read_b64_tr_b16 v[236:237], v10 offset:35264
    v_mfma_f32_32x32x16_bf16 v[80:95], v[212:215], v[176:179], v[80:95]
    s_waitcnt lgkmcnt(9)
    ds_read_b64_tr_b16 v[238:239], v10 offset:39616
    v_mfma_f32_32x32x16_bf16 v[96:111], v[216:219], v[176:179], v[96:111]
    s_waitcnt lgkmcnt(8)
    v_mfma_f32_32x32x16_bf16 v[112:127], v[220:223], v[176:179], v[112:127]
    s_waitcnt lgkmcnt(0)
    v_mfma_f32_32x32x16_bf16 v[64:79], v[224:227], v[180:183], v[64:79]
    s_barrier
    ds_read_b64_tr_b16 v[208:209], v10 offset:35328
    v_mfma_f32_32x32x16_bf16 v[80:95], v[228:231], v[180:183], v[80:95]
    ds_read_b64_tr_b16 v[210:211], v10 offset:39680
    ds_read_b64_tr_b16 v[212:213], v10 offset:35392
    ds_read_b64_tr_b16 v[214:215], v10 offset:39744
    v_mfma_f32_32x32x16_bf16 v[96:111], v[232:235], v[180:183], v[96:111]
    ds_read_b64_tr_b16 v[216:217], v10 offset:35456
    ds_read_b64_tr_b16 v[218:219], v10 offset:39808
    ds_read_b64_tr_b16 v[220:221], v10 offset:35520
    v_mfma_f32_32x32x16_bf16 v[112:127], v[236:239], v[180:183], v[112:127]
    s_waitcnt lgkmcnt(5)
    ds_read_b64_tr_b16 v[222:223], v10 offset:39872
    ds_read_b64_tr_b16 v[224:225], v10 offset:35584
    ds_read_b64_tr_b16 v[226:227], v10 offset:39936
    v_mfma_f32_32x32x16_bf16 v[64:79], v[208:211], v[184:187], v[64:79]
    s_waitcnt lgkmcnt(6)
    ds_read_b64_tr_b16 v[228:229], v10 offset:35648
    ds_read_b64_tr_b16 v[230:231], v10 offset:40000
    v_mfma_f32_32x32x16_bf16 v[80:95], v[212:215], v[184:187], v[80:95]
    s_waitcnt lgkmcnt(6)
    ds_read_b64_tr_b16 v[232:233], v10 offset:35712
    ds_read_b64_tr_b16 v[234:235], v10 offset:40064
    ds_read_b64_tr_b16 v[236:237], v10 offset:35776
    v_mfma_f32_32x32x16_bf16 v[96:111], v[216:219], v[184:187], v[96:111]
    s_waitcnt lgkmcnt(7)
    ds_read_b64_tr_b16 v[238:239], v10 offset:40128
    ds_read_b64_tr_b16 v[208:209], v10 offset:0
    ds_read_b64_tr_b16 v[210:211], v10 offset:4352
    v_mfma_f32_32x32x16_bf16 v[112:127], v[220:223], v[184:187], v[112:127]
    s_waitcnt lgkmcnt(8)
    ds_read_b64_tr_b16 v[212:213], v10 offset:64
    ds_read_b64_tr_b16 v[214:215], v10 offset:4416
    ds_read_b64_tr_b16 v[216:217], v10 offset:128
    v_mfma_f32_32x32x16_bf16 v[64:79], v[224:227], v[188:191], v[64:79]
    s_waitcnt lgkmcnt(9)
    ds_read_b64_tr_b16 v[218:219], v10 offset:4480
    ds_read_b64_tr_b16 v[220:221], v10 offset:192
    v_mfma_f32_32x32x16_bf16 v[80:95], v[228:231], v[188:191], v[80:95]
    s_waitcnt lgkmcnt(9)
    ds_read_b64_tr_b16 v[222:223], v10 offset:4544
    v_mfma_f32_32x32x16_bf16 v[96:111], v[232:235], v[188:191], v[96:111]
    s_waitcnt lgkmcnt(8)
    v_mfma_f32_32x32x16_bf16 v[112:127], v[236:239], v[188:191], v[112:127]
    s_waitcnt lgkmcnt(0)
    v_mfma_f32_32x32x16_bf16 v[64:79], v[208:211], v[192:195], v[64:79]
    s_barrier
    ds_read_b64_tr_b16 v[224:225], v10 offset:256
    v_mfma_f32_32x32x16_bf16 v[80:95], v[212:215], v[192:195], v[80:95]
    ds_read_b64_tr_b16 v[226:227], v10 offset:4608
    ds_read_b64_tr_b16 v[228:229], v10 offset:320
    ds_read_b64_tr_b16 v[230:231], v10 offset:4672
    v_mfma_f32_32x32x16_bf16 v[96:111], v[216:219], v[192:195], v[96:111]
    ds_read_b64_tr_b16 v[232:233], v10 offset:384
    ds_read_b64_tr_b16 v[234:235], v10 offset:4736
    ds_read_b64_tr_b16 v[236:237], v10 offset:448
    v_mfma_f32_32x32x16_bf16 v[112:127], v[220:223], v[192:195], v[112:127]
    s_waitcnt lgkmcnt(5)
    ds_read_b64_tr_b16 v[238:239], v10 offset:4800
    ds_read_b64_tr_b16 v[208:209], v10 offset:512
    ds_read_b64_tr_b16 v[210:211], v10 offset:4864
    v_mfma_f32_32x32x16_bf16 v[64:79], v[224:227], v[196:199], v[64:79]
    s_waitcnt lgkmcnt(6)
    ds_read_b64_tr_b16 v[212:213], v10 offset:576
    ds_read_b64_tr_b16 v[214:215], v10 offset:4928
    v_mfma_f32_32x32x16_bf16 v[80:95], v[228:231], v[196:199], v[80:95]
    s_waitcnt lgkmcnt(6)
    ds_read_b64_tr_b16 v[216:217], v10 offset:640
    ds_read_b64_tr_b16 v[218:219], v10 offset:4992
    ds_read_b64_tr_b16 v[220:221], v10 offset:704
    v_mfma_f32_32x32x16_bf16 v[96:111], v[232:235], v[196:199], v[96:111]
    s_waitcnt lgkmcnt(7)
    ds_read_b64_tr_b16 v[222:223], v10 offset:5056
    ds_read_b64_tr_b16 v[224:225], v10 offset:768
    ds_read_b64_tr_b16 v[226:227], v10 offset:5120
    v_mfma_f32_32x32x16_bf16 v[112:127], v[236:239], v[196:199], v[112:127]
    s_waitcnt lgkmcnt(8)
    ds_read_b64_tr_b16 v[228:229], v10 offset:832
    ds_read_b64_tr_b16 v[230:231], v10 offset:5184
    ds_read_b64_tr_b16 v[232:233], v10 offset:896
    v_mfma_f32_32x32x16_bf16 v[64:79], v[208:211], v[200:203], v[64:79]
    s_waitcnt lgkmcnt(9)
    ds_read_b64_tr_b16 v[234:235], v10 offset:5248
    ds_read_b64_tr_b16 v[236:237], v10 offset:960
    v_mfma_f32_32x32x16_bf16 v[80:95], v[212:215], v[200:203], v[80:95]
    s_waitcnt lgkmcnt(9)
    ds_read_b64_tr_b16 v[238:239], v10 offset:5312
    v_mfma_f32_32x32x16_bf16 v[96:111], v[216:219], v[200:203], v[96:111]
    s_waitcnt lgkmcnt(8)
    v_mfma_f32_32x32x16_bf16 v[112:127], v[220:223], v[200:203], v[112:127]
    s_waitcnt lgkmcnt(0)
    v_mfma_f32_32x32x16_bf16 v[64:79], v[224:227], v[204:207], v[64:79]
    s_barrier
    global_load_ushort v15, v15, s[16:17] offset:64 sc1
    v_mfma_f32_32x32x16_bf16 v[80:95], v[228:231], v[204:207], v[80:95]
    v_mfma_f32_32x32x16_bf16 v[96:111], v[232:235], v[204:207], v[96:111]
    v_mfma_f32_32x32x16_bf16 v[112:127], v[236:239], v[204:207], v[112:127]
    s_setprio 0
    s_nop 1
    v_pk_mul_f32 v[64:65], v[64:65], s[70:71]
    v_pk_mul_f32 v[66:67], v[66:67], s[70:71]
    v_pk_mul_f32 v[68:69], v[68:69], s[70:71]
    v_pk_mul_f32 v[70:71], v[70:71], s[70:71]
    v_cvt_pk_bf16_f32 v32, v64, v65
    v_cvt_pk_bf16_f32 v33, v66, v67
    v_cvt_pk_bf16_f32 v34, v68, v69
    v_cvt_pk_bf16_f32 v35, v70, v71
    v_pk_mul_f32 v[72:73], v[72:73], s[70:71]
    v_pk_mul_f32 v[74:75], v[74:75], s[70:71]
    v_pk_mul_f32 v[76:77], v[76:77], s[70:71]
    v_pk_mul_f32 v[78:79], v[78:79], s[70:71]
    v_cvt_pk_bf16_f32 v36, v72, v73
    v_cvt_pk_bf16_f32 v37, v74, v75
    v_cvt_pk_bf16_f32 v38, v76, v77
    v_cvt_pk_bf16_f32 v39, v78, v79
    v_pk_mul_f32 v[80:81], v[80:81], s[70:71]
    v_pk_mul_f32 v[82:83], v[82:83], s[70:71]
    v_pk_mul_f32 v[84:85], v[84:85], s[70:71]
    v_pk_mul_f32 v[86:87], v[86:87], s[70:71]
    v_cvt_pk_bf16_f32 v40, v80, v81
    v_cvt_pk_bf16_f32 v41, v82, v83
    v_cvt_pk_bf16_f32 v42, v84, v85
    v_cvt_pk_bf16_f32 v43, v86, v87
    v_pk_mul_f32 v[88:89], v[88:89], s[70:71]
    v_pk_mul_f32 v[90:91], v[90:91], s[70:71]
    v_pk_mul_f32 v[92:93], v[92:93], s[70:71]
    v_pk_mul_f32 v[94:95], v[94:95], s[70:71]
    v_cvt_pk_bf16_f32 v44, v88, v89
    v_cvt_pk_bf16_f32 v45, v90, v91
    v_cvt_pk_bf16_f32 v46, v92, v93
    v_cvt_pk_bf16_f32 v47, v94, v95
    v_pk_mul_f32 v[96:97], v[96:97], s[70:71]
    v_pk_mul_f32 v[98:99], v[98:99], s[70:71]
    v_pk_mul_f32 v[100:101], v[100:101], s[70:71]
    v_pk_mul_f32 v[102:103], v[102:103], s[70:71]
    v_cvt_pk_bf16_f32 v48, v96, v97
    v_cvt_pk_bf16_f32 v49, v98, v99
    v_cvt_pk_bf16_f32 v50, v100, v101
    v_cvt_pk_bf16_f32 v51, v102, v103
    v_pk_mul_f32 v[104:105], v[104:105], s[70:71]
    v_pk_mul_f32 v[106:107], v[106:107], s[70:71]
    v_pk_mul_f32 v[108:109], v[108:109], s[70:71]
    v_pk_mul_f32 v[110:111], v[110:111], s[70:71]
    v_cvt_pk_bf16_f32 v52, v104, v105
    v_cvt_pk_bf16_f32 v53, v106, v107
    v_cvt_pk_bf16_f32 v54, v108, v109
    v_cvt_pk_bf16_f32 v55, v110, v111
    v_pk_mul_f32 v[112:113], v[112:113], s[70:71]
    v_pk_mul_f32 v[114:115], v[114:115], s[70:71]
    v_pk_mul_f32 v[116:117], v[116:117], s[70:71]
    v_pk_mul_f32 v[118:119], v[118:119], s[70:71]
    v_cvt_pk_bf16_f32 v56, v112, v113
    v_cvt_pk_bf16_f32 v57, v114, v115
    v_cvt_pk_bf16_f32 v58, v116, v117
    v_cvt_pk_bf16_f32 v59, v118, v119
    v_pk_mul_f32 v[120:121], v[120:121], s[70:71]
    v_pk_mul_f32 v[122:123], v[122:123], s[70:71]
    v_pk_mul_f32 v[124:125], v[124:125], s[70:71]
    v_pk_mul_f32 v[126:127], v[126:127], s[70:71]
    v_cvt_pk_bf16_f32 v60, v120, v121
    v_cvt_pk_bf16_f32 v61, v122, v123
    v_cvt_pk_bf16_f32 v62, v124, v125
    v_cvt_pk_bf16_f32 v63, v126, v127
    s_setprio 1
    s_mov_b32 s64, 8448
    s_mov_b32 s65, 34816
    s_mov_b32 s66, 0
    s_barrier
    ds_read_b128 v[176:179], v2 offset:33792
    ds_read_b128 v[180:183], v2 offset:33824
    ds_read_b128 v[184:187], v2 offset:33856
    ds_read_b128 v[188:191], v2 offset:33888
    ds_read_b128 v[192:195], v2 offset:33920
    ds_read_b128 v[196:199], v2 offset:33952
    ds_read_b128 v[200:203], v2 offset:33984
    ds_read_b128 v[204:207], v2 offset:34016
    s_waitcnt lgkmcnt(0)
    s_barrier
    v_mfma_f32_32x32x16_bf16 v[128:143], v[176:179], v[32:35], 0
    v_mfma_f32_32x32x16_bf16 v[128:143], v[180:183], v[36:39], v[128:143]
    ds_read_b128 v[176:179], v2 offset:0
    v_mfma_f32_32x32x16_bf16 v[128:143], v[184:187], v[40:43], v[128:143]
    ds_read_b128 v[180:183], v2 offset:32
    v_mfma_f32_32x32x16_bf16 v[128:143], v[188:191], v[44:47], v[128:143]
    ds_read_b128 v[184:187], v2 offset:64
    v_mfma_f32_32x32x16_bf16 v[128:143], v[192:195], v[48:51], v[128:143]
    ds_read_b128 v[188:191], v2 offset:96
    v_mfma_f32_32x32x16_bf16 v[128:143], v[196:199], v[52:55], v[128:143]
    ds_read_b128 v[192:195], v2 offset:128
    v_mfma_f32_32x32x16_bf16 v[128:143], v[200:203], v[56:59], v[128:143]
    ds_read_b128 v[196:199], v2 offset:160
    v_mfma_f32_32x32x16_bf16 v[128:143], v[204:207], v[60:63], v[128:143]
    ds_read_b128 v[200:203], v2 offset:192
    v_add_u32 v10, s64, v2
    v_add_u32 v11, s65, v3
    s_nop 1
    ds_read_b128 v[204:207], v2 offset:224
    s_branch ATT
PAD10:
    s_branch BK10
K_w3:
    s_and_b32 s52, s48, 3
    s_bfe_u32 s53, s48, 0x10002
    s_lshl2_add_u32 s52, s52, s53
    s_lshl2_add_u32 s53, s49, s50
    s_cmp_eq_u32 s52, s53
    s_cselect_b32 s59, 1, 0
    s_lshl_b32 s52, s48, 14
    s_add_u32 s52, s52, 33554432
    s_waitcnt lgkmcnt(0)
    s_add_u32 s72, s18, s52
    s_addc_u32 s73, s19, 0
    s_mov_b32 s74, 16384
    s_mov_b32 s75, 0x20000
    s_mov_b32 s44, s16
    s_mov_b32 s45, s17
    s_mov_b32 s46, 256
    s_mov_b32 s47, 0x20000
    v_lshrrev_b32 v1, 2, v0
    v_and_b32 v2, 3, v0
    v_lshlrev_b32 v1, 7, v1
    v_lshl_add_u32 v1, v2, 4, v1
    v_lshlrev_b32 v2, 7, v0
    v_mov_b32 v12, 0
    v_mov_b32 v13, 0
    v_mov_b32 v14, 0
    v_mov_b32 v15, 0
    s_lshl_b32 s52, s48, 2
    v_mov_b32 v4, s52
    v_mov_b32 v3, 1
    s_cmp_eq_u32 s59, 1
    s_cbranch_scc0 W3_nc0
    buffer_store_dwordx4 v[12:15], v2, s[72:75], 0 offen offset:1024 sc1
    s_mov_b64 exec, 0xffffffff
    buffer_store_dwordx4 v[12:15], v1, s[72:75], 0 offen sc1
    s_mov_b64 exec, -1
W3_nc0:
    s_getreg_b32 s52, hwreg(HW_REG_XCC_ID, 0, 4)
    s_or_b32 s53, s52, 8
    s_cmp_lt_u32 s52, 8
    s_cselect_b32 s53, s53, 0
    s_and_b32 s52, s49, 1
    s_lshl2_add_u32 s52, s52, s50
    s_lshl_b32 s52, s52, 2
    s_lshl_b32 s53, s53, s52
    s_lshr_b32 s52, s49, 1
    s_lshl1_add_u32 s52, s48, s52
    s_lshl_b32 s52, s52, 2
    v_mov_b32 v5, s53
    v_mov_b32 v6, s52
    s_mov_b64 exec, 1
    buffer_atomic_or v5, v6, s[44:47], 0 offen offset:64 sc1
    s_mov_b64 exec, -1
    s_barrier
    s_barrier
    s_barrier
    s_cmp_eq_u32 s59, 1
    s_cbranch_scc0 W3_nc1
    s_waitcnt vmcnt(0)
    s_mov_b64 exec, 1
    buffer_store_dword v3, v4, s[44:47], 0 offen sc1
    s_mov_b64 exec, -1
W3_nc1:
    v_lshl_add_u32 v1, v248, 3, v250
    v_mul_u32_u24 v1, 320, v1
    v_add_u32 v1, v1, v251
    v_add_u32 v16, 256, v1
    s_cmp_eq_u32 s49, 3
    s_cselect_b32 s20, 0, s49
    s_lshl_b32 s52, s20, 11
    v_add_u32 v20, s52, v7
    s_add_u32 s21, s20, 1
    s_cmp_eq_u32 s21, 3
    s_cselect_b32 s21, 0, s21
    s_lshl_b32 s52, s21, 11
    v_add_u32 v21, s52, v7
    s_add_u32 s22, s21, 1
    s_cmp_eq_u32 s22, 3
    s_cselect_b32 s22, 0, s22
    s_lshl_b32 s52, s22, 11
    v_add_u32 v22, s52, v7
    s_lshl2_add_u32 s52, s48, s50
    s_lshl_b32 s53, s52, 18
    s_add_u32 s53, s53, 16777216
    s_lshl3_add_u32 s52, s48, s50
    s_lshl_b32 s52, s52, 11
    s_add_u32 s52, s52, 33555456
    s_add_u32 s24, s18, s53
    s_addc_u32 s25, s19, 0
    s_mov_b32 s26, 262144
    s_mov_b32 s27, 0x20000
    s_add_u32 s28, s18, s52
    s_addc_u32 s29, s19, 0
    s_mov_b32 s30, 2048
    s_mov_b32 s31, 0x20000
    s_mov_b32 s44, s14
    s_mov_b32 s45, s15
    s_mov_b32 s46, 1966080
    s_mov_b32 s47, 0x20000
    v_mov_b32 v13, s20
    v_mov_b32 v14, 1
    v_writelane_b32 v13, s21, 1
    v_writelane_b32 v13, s22, 2
    s_lshl_b32 s53, s3, 7
    s_lshl2_add_u32 s52, s49, s53
    v_lshlrev_b32 v13, 9, v13
    v_add_u32 v13, s52, v13
    s_lshl_b32 s52, s49, 9
    s_add_u32 s52, s52, s53
    v_and_b32 v1, 3, v0
    v_lshlrev_b32 v1, 2, v1
    v_add_u32 v11, s52, v1
    s_lshl_b32 s52, 1, s49
    s_andn2_b32 s33, 15, s52
    s_lshl2_add_u32 s55, s49, s3
    s_lshl_b32 s20, s20, 16
    s_lshl_b32 s52, s55, 12
    s_add_u32 s20, s20, s52
    s_lshl_b32 s21, s21, 16
    s_lshl_b32 s52, s55, 12
    s_add_u32 s21, s21, s52
    s_lshl_b32 s22, s22, 16
    s_lshl_b32 s52, s55, 12
    s_add_u32 s22, s22, s52
    v_and_b32 v12, 15, v0
    v_mul_u32_u24 v12, 1280, v12
    v_bfe_u32 v1, v0, 4, 1
    v_lshl_add_u32 v12, v1, 5, v12
    v_lshl_add_u32 v12, v248, 4, v12
    s_mul_i32 s32, s48, 122880
    s_mul_i32 s52, s50, 320
    s_add_u32 s32, s32, s52
    s_mul_i32 s52, s49, 40960
    s_add_u32 s32, s32, s52
    s_add_u32 s32, s32, 256
    s_cmp_eq_u32 s49, 3
    s_cselect_b64 s[34:35], 7, 6
    s_barrier
    s_barrier
    s_barrier
    s_barrier
    s_barrier
    s_barrier
    s_barrier
    s_barrier
    s_barrier
    s_barrier
    s_nop 0
    s_barrier
    s_nop 0
    s_barrier
    s_nop 0
    s_barrier
    s_branch PAD9
BK9:
    s_barrier
    s_nop 0
    s_barrier
    s_nop 0
    s_barrier
    s_nop 0
    s_barrier
    s_nop 0
    s_barrier
    s_nop 0
    s_barrier
    s_branch PAD2
BK2:
    s_barrier
    s_nop 0
    s_barrier
    s_nop 0
    s_barrier
    s_nop 0
    s_barrier
    s_branch PAD11
BK11:
    s_barrier
    s_nop 0
    s_barrier
    s_nop 0
    s_barrier
    s_nop 0
    s_barrier
    s_nop 0
    s_mov_b32 s67, 98304
    v_add_u32 v24, s67, v16
    v_add_u32 v28, s67, v20
    v_add_u32 v29, s67, v21
    v_add_u32 v30, s67, v22
    s_barrier
    s_nop 0
    ds_read_b64_tr_b16 v[128:129], v24 offset:0
    ds_read_b64_tr_b16 v[130:131], v24 offset:1280
    ds_read_b128 v[132:135], v28 offset:10240
    ds_read_b128 v[136:139], v29 offset:10240
    ds_read_b128 v[140:143], v30 offset:10240
    s_waitcnt lgkmcnt(0)
    v_mfma_f32_32x32x16_bf16 v[64:79], v[128:131], v[132:135], 0
    s_barrier
    s_nop 0
    ds_read_b64_tr_b16 v[144:145], v24 offset:5120
    s_branch SK11
PAD11:
    s_branch BK11
SK11:
    ds_read_b64_tr_b16 v[146:147], v24 offset:6400
    ds_read_b128 v[148:151], v28 offset:11264
    v_mfma_f32_32x32x16_bf16 v[80:95], v[128:131], v[136:139], 0
    ds_read_b128 v[152:155], v29 offset:11264
    v_mfma_f32_32x32x16_bf16 v[96:111], v[128:131], v[140:143], 0
    ds_read_b128 v[156:159], v30 offset:11264
    s_waitcnt lgkmcnt(0)
    v_mfma_f32_32x32x16_bf16 v[64:79], v[144:147], v[148:151], v[64:79]
    s_barrier
    s_branch PAD7
BK7:
    ds_read_b64_tr_b16 v[128:129], v24 offset:22528
    ds_read_b64_tr_b16 v[130:131], v24 offset:23808
    ds_read_b128 v[132:135], v28 offset:16384
    v_mfma_f32_32x32x16_bf16 v[80:95], v[144:147], v[152:155], v[80:95]
    ds_read_b128 v[136:139], v29 offset:16384
    v_mfma_f32_32x32x16_bf16 v[96:111], v[144:147], v[156:159], v[96:111]
    ds_read_b128 v[140:143], v30 offset:16384
    s_waitcnt lgkmcnt(0)
    v_mfma_f32_32x32x16_bf16 v[64:79], v[128:131], v[132:135], v[64:79]
    s_barrier
    s_nop 0
    ds_read_b64_tr_b16 v[144:145], v24 offset:27648
    ds_read_b64_tr_b16 v[146:147], v24 offset:28928
    ds_read_b128 v[148:151], v28 offset:17408
    v_mfma_f32_32x32x16_bf16 v[80:95], v[128:131], v[136:139], v[80:95]
    ds_read_b128 v[152:155], v29 offset:17408
    v_mfma_f32_32x32x16_bf16 v[96:111], v[128:131], v[140:143], v[96:111]
    ds_read_b128 v[156:159], v30 offset:17408
    s_waitcnt lgkmcnt(0)
    s_mov_b32 s67, 131072
    v_add_u32 v24, s67, v16
    v_add_u32 v28, s67, v20
    v_add_u32 v29, s67, v21
    v_add_u32 v30, s67, v22
    v_mfma_f32_32x32x16_bf16 v[64:79], v[144:147], v[148:151], v[64:79]
    s_barrier
    s_nop 0
    ds_read_b64_tr_b16 v[128:129], v24 offset:0
    ds_read_b64_tr_b16 v[130:131], v24 offset:1280
    ds_read_b128 v[132:135], v28 offset:10240
    v_mfma_f32_32x32x16_bf16 v[80:95], v[144:147], v[152:155], v[80:95]
    ds_read_b128 v[136:139], v29 offset:10240
    v_mfma_f32_32x32x16_bf16 v[96:111], v[144:147], v[156:159], v[96:111]
    ds_read_b128 v[140:143], v30 offset:10240
    s_waitcnt lgkmcnt(0)
    v_mfma_f32_32x32x16_bf16 v[64:79], v[128:131], v[132:135], v[64:79]
    s_barrier
    s_nop 0
    ds_read_b64_tr_b16 v[144:145], v24 offset:5120
    ds_read_b64_tr_b16 v[146:147], v24 offset:6400
    ds_read_b128 v[148:151], v28 offset:11264
    v_mfma_f32_32x32x16_bf16 v[80:95], v[128:131], v[136:139], v[80:95]
    ds_read_b128 v[152:155], v29 offset:11264
    v_mfma_f32_32x32x16_bf16 v[96:111], v[128:131], v[140:143], v[96:111]
    ds_read_b128 v[156:159], v30 offset:11264
    s_waitcnt lgkmcnt(0)
    v_mfma_f32_32x32x16_bf16 v[64:79], v[144:147], v[148:151], v[64:79]
    s_barrier
    s_nop 0
    ds_read_b64_tr_b16 v[128:129], v24 offset:22528
    ds_read_b64_tr_b16 v[130:131], v24 offset:23808
    ds_read_b128 v[132:135], v28 offset:16384
    v_mfma_f32_32x32x16_bf16 v[80:95], v[144:147], v[152:155], v[80:95]
    ds_read_b128 v[136:139], v29 offset:16384
    v_mfma_f32_32x32x16_bf16 v[96:111], v[144:147], v[156:159], v[96:111]
    ds_read_b128 v[140:143], v30 offset:16384
    s_waitcnt lgkmcnt(0)
    v_mfma_f32_32x32x16_bf16 v[64:79], v[128:131], v[132:135], v[64:79]
    s_barrier
    s_nop 0
    ds_read_b64_tr_b16 v[144:145], v24 offset:27648
    ds_read_b64_tr_b16 v[146:147], v24 offset:28928
    ds_read_b128 v[148:151], v28 offset:17408
    v_mfma_f32_32x32x16_bf16 v[80:95], v[128:131], v[136:139], v[80:95]
    ds_read_b128 v[152:155], v29 offset:17408
    v_mfma_f32_32x32x16_bf16 v[96:111], v[128:131], v[140:143], v[96:111]
    ds_read_b128 v[156:159], v30 offset:17408
    s_waitcnt lgkmcnt(0)
    s_barrier
    s_nop 0
    s_barrier
    s_branch PAD3
BK3:
    s_barrier
    s_nop 0
    s_barrier
    s_nop 0
    s_barrier
    s_nop 0
    s_barrier
    s_nop 0
    s_barrier
    s_branch PAD4
BK4:
    s_mov_b32 s67, 98304
    v_add_u32 v24, s67, v16
    v_add_u32 v28, s67, v20
    v_add_u32 v29, s67, v21
    v_add_u32 v30, s67, v22
    s_mov_b32 s58, 0
OP1:
    v_mfma_f32_32x32x16_bf16 v[64:79], v[144:147], v[148:151], v[64:79]
    s_barrier
    ds_read_b64_tr_b16 v[128:129], v24 offset:0
    ds_read_b64_tr_b16 v[130:131], v24 offset:1280
    ds_read_b128 v[132:135], v28 offset:10240
    v_mfma_f32_32x32x16_bf16 v[80:95], v[144:147], v[152:155], v[80:95]
    ds_read_b128 v[136:139], v29 offset:10240
    v_mfma_f32_32x32x16_bf16 v[96:111], v[144:147], v[156:159], v[96:111]
    ds_read_b128 v[140:143], v30 offset:10240
    s_waitcnt lgkmcnt(2)
    v_mfma_f32_32x32x16_bf16 v[64:79], v[128:131], v[132:135], v[64:79]
    ds_read_b64_tr_b16 v[144:145], v24 offset:5120
    ds_read_b64_tr_b16 v[146:147], v24 offset:6400
    ds_read_b128 v[148:151], v28 offset:11264
    s_waitcnt lgkmcnt(4)
    v_mfma_f32_32x32x16_bf16 v[80:95], v[128:131], v[136:139], v[80:95]
    ds_read_b128 v[152:155], v29 offset:11264
    s_waitcnt lgkmcnt(4)
    v_mfma_f32_32x32x16_bf16 v[96:111], v[128:131], v[140:143], v[96:111]
    ds_read_b128 v[156:159], v30 offset:11264
    s_waitcnt lgkmcnt(2)
    v_mfma_f32_32x32x16_bf16 v[64:79], v[144:147], v[148:151], v[64:79]
    ds_read_b64_tr_b16 v[128:129], v24 offset:22528
    ds_read_b64_tr_b16 v[130:131], v24 offset:23808
    ds_read_b128 v[132:135], v28 offset:16384
    s_waitcnt lgkmcnt(4)
    v_mfma_f32_32x32x16_bf16 v[80:95], v[144:147], v[152:155], v[80:95]
    ds_read_b128 v[136:139], v29 offset:16384
    s_waitcnt lgkmcnt(4)
    v_mfma_f32_32x32x16_bf16 v[96:111], v[144:147], v[156:159], v[96:111]
    ds_read_b128 v[140:143], v30 offset:16384
    s_waitcnt lgkmcnt(2)
    v_mfma_f32_32x32x16_bf16 v[64:79], v[128:131], v[132:135], v[64:79]
    ds_read_b64_tr_b16 v[144:145], v24 offset:27648
    ds_read_b64_tr_b16 v[146:147], v24 offset:28928
    ds_read_b128 v[148:151], v28 offset:17408
    s_waitcnt lgkmcnt(4)
    v_mfma_f32_32x32x16_bf16 v[80:95], v[128:131], v[136:139], v[80:95]
    ds_read_b128 v[152:155], v29 offset:17408
    s_waitcnt lgkmcnt(4)
    v_mfma_f32_32x32x16_bf16 v[96:111], v[128:131], v[140:143], v[96:111]
    ds_read_b128 v[156:159], v30 offset:17408
    s_add_u32 s67, s67, 32768
    s_cmp_eq_u32 s67, 163840
    s_cselect_b32 s67, 0, s67
    v_add_u32 v24, s67, v16
    v_add_u32 v28, s67, v20
    v_add_u32 v29, s67, v21
    v_add_u32 v30, s67, v22
    s_add_u32 s58, s58, 1
    s_cmp_lt_u32 s58, 14
    s_waitcnt lgkmcnt(0)
    s_cbranch_scc1 OP1
    v_mfma_f32_32x32x16_bf16 v[80:95], v[144:147], v[152:155], v[80:95]
    v_mfma_f32_32x32x16_bf16 v[96:111], v[144:147], v[156:159], v[96:111]
    v_mfma_f32_32x32x16_bf16 v[64:79], v[144:147], v[148:151], v[64:79]
    s_nop 3
    v_cvt_pk_bf16_f32 v184, v80, v81
    v_cvt_pk_bf16_f32 v185, v82, v83
    v_cvt_pk_bf16_f32 v186, v84, v85
    v_cvt_pk_bf16_f32 v187, v86, v87
    v_cvt_pk_bf16_f32 v188, v88, v89
    v_cvt_pk_bf16_f32 v189, v90, v91
    v_cvt_pk_bf16_f32 v190, v92, v93
    v_cvt_pk_bf16_f32 v191, v94, v95
    buffer_store_dwordx4 v[184:187], v7, s[24:27], s21 offen offset:0 sc1
    buffer_store_dwordx4 v[188:191], v7, s[24:27], s21 offen offset:1024 sc1
    v_cvt_pk_bf16_f32 v192, v96, v97
    v_cvt_pk_bf16_f32 v193, v98, v99
    v_cvt_pk_bf16_f32 v194, v100, v101
    v_cvt_pk_bf16_f32 v195, v102, v103
    v_cvt_pk_bf16_f32 v196, v104, v105
    v_cvt_pk_bf16_f32 v197, v106, v107
    v_cvt_pk_bf16_f32 v198, v108, v109
    v_cvt_pk_bf16_f32 v199, v110, v111
    buffer_store_dwordx4 v[192:195], v7, s[24:27], s22 offen offset:0 sc1
    buffer_store_dwordx4 v[196:199], v7, s[24:27], s22 offen offset:1024 sc1
    s_cmp_eq_u32 s49, 3
    s_cbranch_scc0 O_s0
    s_nop 3
    v_cvt_pk_bf16_f32 v176, v64, v65
    v_cvt_pk_bf16_f32 v177, v66, v67
    v_cvt_pk_bf16_f32 v178, v68, v69
    v_cvt_pk_bf16_f32 v179, v70, v71
    v_cvt_pk_bf16_f32 v180, v72, v73
    v_cvt_pk_bf16_f32 v181, v74, v75
    v_cvt_pk_bf16_f32 v182, v76, v77
    v_cvt_pk_bf16_f32 v183, v78, v79
    buffer_store_dwordx4 v[176:179], v7, s[24:27], s20 offen offset:0 sc1
    buffer_store_dwordx4 v[180:183], v7, s[24:27], s20 offen offset:1024 sc1
O_s0:
    v_mov_b32 v216, 0
    s_lshl_b32 s53, s49, 16
    s_lshl_b32 s52, s3, 12
    s_add_u32 s53, s53, s52
    s_add_u32 s52, s49, 1
    s_and_b32 s52, s52, 3
    s_lshl_b32 s52, s52, 14
    s_add_u32 s40, s52, s53
    s_add_u32 s52, s49, 2
    s_and_b32 s52, s52, 3
    s_lshl_b32 s52, s52, 14
    s_add_u32 s41, s52, s53
    s_add_u32 s52, s49, 3
    s_and_b32 s52, s52, 3
    s_lshl_b32 s52, s52, 14
    s_add_u32 s42, s52, s53
    s_mov_b32 s55, 0
    s_waitcnt vmcnt(0)
    s_mov_b64 exec, s[34:35]
    buffer_store_dword v14, v13, s[28:31], 0 offen sc1
    s_mov_b64 exec, -1
    s_cmp_eq_u32 s49, 3
    s_cbranch_scc0 O_rcv
    s_endpgm
O_rcv:
O_poll1:
    buffer_load_dword v216, v11, s[28:31], 0 offen sc1
    s_waitcnt vmcnt(0)
    v_cmp_eq_u32 vcc, 1, v216
    s_and_b32 s54, vcc_lo, s33
    s_cmp_eq_u32 s54, s33
    s_cbranch_scc1 O_poll1_done
    s_add_u32 s55, s55, 1
    s_cmp_lt_u32 s55, 200000
    s_cbranch_scc1 O_poll1
O_poll1_done:
    buffer_load_dwordx4 v[176:179], v7, s[24:27], s40 offen offset:0 sc1
    buffer_load_dwordx4 v[180:183], v7, s[24:27], s40 offen offset:1024 sc1
    buffer_load_dwordx4 v[192:195], v7, s[24:27], s41 offen offset:0 sc1
    buffer_load_dwordx4 v[196:199], v7, s[24:27], s41 offen offset:1024 sc1
    buffer_load_dwordx4 v[208:211], v7, s[24:27], s42 offen offset:0 sc1
    buffer_load_dwordx4 v[212:215], v7, s[24:27], s42 offen offset:1024 sc1
    s_waitcnt vmcnt(4)
    v_lshlrev_b32 v128, 16, v176
    v_and_b32 v129, 0xffff0000, v176
    v_lshlrev_b32 v130, 16, v177
    v_and_b32 v131, 0xffff0000, v177
    v_lshlrev_b32 v132, 16, v178
    v_and_b32 v133, 0xffff0000, v178
    v_lshlrev_b32 v134, 16, v179
    v_and_b32 v135, 0xffff0000, v179
    v_lshlrev_b32 v136, 16, v180
    v_and_b32 v137, 0xffff0000, v180
    v_lshlrev_b32 v138, 16, v181
    v_and_b32 v139, 0xffff0000, v181
    v_lshlrev_b32 v140, 16, v182
    v_and_b32 v141, 0xffff0000, v182
    v_lshlrev_b32 v142, 16, v183
    v_and_b32 v143, 0xffff0000, v183
    v_pk_add_f32 v[64:65], v[64:65], v[128:129]
    v_pk_add_f32 v[66:67], v[66:67], v[130:131]
    v_pk_add_f32 v[68:69], v[68:69], v[132:133]
    v_pk_add_f32 v[70:71], v[70:71], v[134:135]
    v_pk_add_f32 v[72:73], v[72:73], v[136:137]
    v_pk_add_f32 v[74:75], v[74:75], v[138:139]
    v_pk_add_f32 v[76:77], v[76:77], v[140:141]
    v_pk_add_f32 v[78:79], v[78:79], v[142:143]
    s_waitcnt vmcnt(2)
    v_lshlrev_b32 v128, 16, v192
    v_and_b32 v129, 0xffff0000, v192
    v_lshlrev_b32 v130, 16, v193
    v_and_b32 v131, 0xffff0000, v193
    v_lshlrev_b32 v132, 16, v194
    v_and_b32 v133, 0xffff0000, v194
    v_lshlrev_b32 v134, 16, v195
    v_and_b32 v135, 0xffff0000, v195
    v_lshlrev_b32 v136, 16, v196
    v_and_b32 v137, 0xffff0000, v196
    v_lshlrev_b32 v138, 16, v197
    v_and_b32 v139, 0xffff0000, v197
    v_lshlrev_b32 v140, 16, v198
    v_and_b32 v141, 0xffff0000, v198
    v_lshlrev_b32 v142, 16, v199
    v_and_b32 v143, 0xffff0000, v199
    v_pk_add_f32 v[64:65], v[64:65], v[128:129]
    v_pk_add_f32 v[66:67], v[66:67], v[130:131]
    v_pk_add_f32 v[68:69], v[68:69], v[132:133]
    v_pk_add_f32 v[70:71], v[70:71], v[134:135]
    v_pk_add_f32 v[72:73], v[72:73], v[136:137]
    v_pk_add_f32 v[74:75], v[74:75], v[138:139]
    v_pk_add_f32 v[76:77], v[76:77], v[140:141]
    v_pk_add_f32 v[78:79], v[78:79], v[142:143]
    s_waitcnt vmcnt(0)
    v_lshlrev_b32 v128, 16, v208
    v_and_b32 v129, 0xffff0000, v208
    v_lshlrev_b32 v130, 16, v209
    v_and_b32 v131, 0xffff0000, v209
    v_lshlrev_b32 v132, 16, v210
    v_and_b32 v133, 0xffff0000, v210
    v_lshlrev_b32 v134, 16, v211
    v_and_b32 v135, 0xffff0000, v211
    v_lshlrev_b32 v136, 16, v212
    v_and_b32 v137, 0xffff0000, v212
    v_lshlrev_b32 v138, 16, v213
    v_and_b32 v139, 0xffff0000, v213
    v_lshlrev_b32 v140, 16, v214
    v_and_b32 v141, 0xffff0000, v214
    v_lshlrev_b32 v142, 16, v215
    v_and_b32 v143, 0xffff0000, v215
    v_pk_add_f32 v[64:65], v[64:65], v[128:129]
    v_pk_add_f32 v[66:67], v[66:67], v[130:131]
    v_pk_add_f32 v[68:69], v[68:69], v[132:133]
    v_pk_add_f32 v[70:71], v[70:71], v[134:135]
    v_pk_add_f32 v[72:73], v[72:73], v[136:137]
    v_pk_add_f32 v[74:75], v[74:75], v[138:139]
    v_pk_add_f32 v[76:77], v[76:77], v[140:141]
    v_pk_add_f32 v[78:79], v[78:79], v[142:143]
    v_cvt_pk_bf16_f32 v24, v64, v65
    v_cvt_pk_bf16_f32 v25, v66, v67
    v_cvt_pk_bf16_f32 v26, v68, v69
    v_cvt_pk_bf16_f32 v27, v70, v71
    v_cvt_pk_bf16_f32 v28, v72, v73
    v_cvt_pk_bf16_f32 v29, v74, v75
    v_cvt_pk_bf16_f32 v30, v76, v77
    v_cvt_pk_bf16_f32 v31, v78, v79
    s_nop 0
    v_permlane16_swap_b32 v24, v28
    v_permlane16_swap_b32 v25, v29
    v_permlane16_swap_b32 v26, v30
    v_permlane16_swap_b32 v27, v31
    s_add_u32 s52, s32, 20480
    s_nop 0
    buffer_store_dwordx4 v[24:27], v12, s[44:47], s32 offen sc1
    buffer_store_dwordx4 v[28:31], v12, s[44:47], s52 offen sc1
    s_endpgm
R0_0:
    s_mov_b32 s59, 0
    s_branch RH0
RH0:
    v_max3_f32 v8, v128, v129, 0
    v_max3_f32 v8, v8, v130, v131
    v_max3_f32 v8, v8, v132, v133
    v_max3_f32 v8, v8, v134, v135
    v_max3_f32 v8, v8, v136, v137
    v_max3_f32 v8, v8, v138, v139
    v_max3_f32 v8, v8, v140, v141
    v_max3_f32 v8, v8, v142, v143
    v_mov_b32 v9, v8
    s_nop 1
    v_permlane32_swap_b32 v9, v8
    s_nop 1
    v_max_f32 v8, v8, v9
    v_sub_f32 v9, 0, v8
    v_exp_f32 v9, v9
    s_nop 7
    s_nop 7
    v_sub_f32 v128, v128, v8
    v_sub_f32 v129, v129, v8
    v_sub_f32 v130, v130, v8
    v_sub_f32 v131, v131, v8
    v_sub_f32 v132, v132, v8
    v_sub_f32 v133, v133, v8
    v_sub_f32 v134, v134, v8
    v_sub_f32 v135, v135, v8
    v_sub_f32 v136, v136, v8
    v_sub_f32 v137, v137, v8
    v_sub_f32 v138, v138, v8
    v_sub_f32 v139, v139, v8
    v_sub_f32 v140, v140, v8
    v_sub_f32 v141, v141, v8
    v_sub_f32 v142, v142, v8
    v_sub_f32 v143, v143, v8
    v_sub_f32 v160, v160, v8
    v_sub_f32 v161, v161, v8
    v_sub_f32 v162, v162, v8
    v_sub_f32 v163, v163, v8
    v_sub_f32 v164, v164, v8
    v_sub_f32 v165, v165, v8
    v_sub_f32 v166, v166, v8
    v_sub_f32 v167, v167, v8
    v_sub_f32 v168, v168, v8
    v_sub_f32 v169, v169, v8
    v_sub_f32 v170, v170, v8
    v_sub_f32 v171, v171, v8
    v_sub_f32 v172, v172, v8
    v_sub_f32 v173, v173, v8
    v_sub_f32 v174, v174, v8
    v_sub_f32 v175, v175, v8
    v_sub_f32 v144, v144, v8
    v_sub_f32 v145, v145, v8
    v_sub_f32 v146, v146, v8
    v_sub_f32 v147, v147, v8
    v_sub_f32 v148, v148, v8
    v_sub_f32 v149, v149, v8
    v_sub_f32 v150, v150, v8
    v_sub_f32 v151, v151, v8
    v_sub_f32 v152, v152, v8
    v_sub_f32 v153, v153, v8
    v_sub_f32 v154, v154, v8
    v_sub_f32 v155, v155, v8
    v_sub_f32 v156, v156, v8
    v_sub_f32 v157, v157, v8
    v_sub_f32 v158, v158, v8
    v_sub_f32 v159, v159, v8
    v_mul_f32 v4, v9, v4
    v_mul_f32 v64, v9, v64
    v_mul_f32 v65, v9, v65
    v_mul_f32 v66, v9, v66
    v_mul_f32 v67, v9, v67
    v_mul_f32 v68, v9, v68
    v_mul_f32 v69, v9, v69
    v_mul_f32 v70, v9, v70
    v_mul_f32 v71, v9, v71
    v_mul_f32 v72, v9, v72
    v_mul_f32 v73, v9, v73
    v_mul_f32 v74, v9, v74
    v_mul_f32 v75, v9, v75
    v_mul_f32 v76, v9, v76
    v_mul_f32 v77, v9, v77
    v_mul_f32 v78, v9, v78
    v_mul_f32 v79, v9, v79
    v_mul_f32 v80, v9, v80
    v_mul_f32 v81, v9, v81
    v_mul_f32 v82, v9, v82
    v_mul_f32 v83, v9, v83
    v_mul_f32 v84, v9, v84
    v_mul_f32 v85, v9, v85
    v_mul_f32 v86, v9, v86
    v_mul_f32 v87, v9, v87
    v_mul_f32 v88, v9, v88
    v_mul_f32 v89, v9, v89
    v_mul_f32 v90, v9, v90
    v_mul_f32 v91, v9, v91
    v_mul_f32 v92, v9, v92
    v_mul_f32 v93, v9, v93
    v_mul_f32 v94, v9, v94
    v_mul_f32 v95, v9, v95
    v_mul_f32 v96, v9, v96
    v_mul_f32 v97, v9, v97
    v_mul_f32 v98, v9, v98
    v_mul_f32 v99, v9, v99
    v_mul_f32 v100, v9, v100
    v_mul_f32 v101, v9, v101
    v_mul_f32 v102, v9, v102
    v_mul_f32 v103, v9, v103
    v_mul_f32 v104, v9, v104
    v_mul_f32 v105, v9, v105
    v_mul_f32 v106, v9, v106
    v_mul_f32 v107, v9, v107
    v_mul_f32 v108, v9, v108
    v_mul_f32 v109, v9, v109
    v_mul_f32 v110, v9, v110
    v_mul_f32 v111, v9, v111
    v_mul_f32 v112, v9, v112
    v_mul_f32 v113, v9, v113
    v_mul_f32 v114, v9, v114
    v_mul_f32 v115, v9, v115
    v_mul_f32 v116, v9, v116
    v_mul_f32 v117, v9, v117
    v_mul_f32 v118, v9, v118
    v_mul_f32 v119, v9, v119
    v_mul_f32 v120, v9, v120
    v_mul_f32 v121, v9, v121
    v_mul_f32 v122, v9, v122
    v_mul_f32 v123, v9, v123
    v_mul_f32 v124, v9, v124
    v_mul_f32 v125, v9, v125
    v_mul_f32 v126, v9, v126
    v_mul_f32 v127, v9, v127
    v_exp_f32 v16, v128
    v_exp_f32 v17, v129
    s_nop 0
    v_exp_f32 v18, v130
    s_nop 0
    v_add_f32 v6, v16, v17
    s_nop 0
    v_cvt_pk_bf16_f32 v24, v16, v17
    s_nop 0
    v_exp_f32 v19, v131
    s_nop 0
    v_add_f32 v6, v6, v18
    s_nop 0
    v_exp_f32 v20, v132
    s_nop 0
    v_add_f32 v6, v6, v19
    s_nop 0
    v_cvt_pk_bf16_f32 v25, v18, v19
    s_nop 0
    v_exp_f32 v21, v133
    s_nop 0
    v_add_f32 v6, v6, v20
    s_nop 0
    v_exp_f32 v22, v134
    s_nop 0
    v_add_f32 v6, v6, v21
    s_nop 0
    v_cvt_pk_bf16_f32 v26, v20, v21
    s_nop 0
    v_exp_f32 v23, v135
    s_nop 0
    v_add_f32 v6, v6, v22
    s_nop 0
    v_exp_f32 v16, v136
    s_nop 0
    v_add_f32 v6, v6, v23
    s_nop 0
    v_cvt_pk_bf16_f32 v27, v22, v23
    s_nop 0
    v_exp_f32 v17, v137
    s_nop 0
    v_add_f32 v6, v6, v16
    s_nop 0
    v_exp_f32 v18, v138
    s_nop 0
    v_add_f32 v6, v6, v17
    s_nop 0
    v_cvt_pk_bf16_f32 v28, v16, v17
    s_nop 0
    v_exp_f32 v19, v139
    s_nop 0
    v_add_f32 v6, v6, v18
    s_nop 0
    v_exp_f32 v20, v140
    s_nop 0
    v_add_f32 v6, v6, v19
    s_nop 0
    v_cvt_pk_bf16_f32 v29, v18, v19
    s_nop 0
    v_exp_f32 v21, v141
    s_nop 0
    v_add_f32 v6, v6, v20
    s_nop 0
    v_exp_f32 v22, v142
    s_nop 0
    v_add_f32 v6, v6, v21
    s_nop 0
    v_cvt_pk_bf16_f32 v30, v20, v21
    s_nop 0
    v_exp_f32 v23, v143
    s_nop 0
    v_add_f32 v6, v6, v22
    s_nop 0
    v_add_f32 v6, v6, v23
    s_nop 0
    v_cvt_pk_bf16_f32 v31, v22, v23
    s_nop 0
    s_nop 1
    s_branch R0_0_back
R1_0:
    s_mov_b32 s59, 0
    s_branch RH1
R1_1:
    s_mov_b32 s59, 1
    s_branch RH1
R1_2:
    s_mov_b32 s59, 2
    s_branch RH1
RH1:
    v_max3_f32 v8, v144, v145, 0
    v_max3_f32 v8, v8, v146, v147
    v_max3_f32 v8, v8, v148, v149
    v_max3_f32 v8, v8, v150, v151
    v_max3_f32 v8, v8, v152, v153
    v_max3_f32 v8, v8, v154, v155
    v_max3_f32 v8, v8, v156, v157
    v_max3_f32 v8, v8, v158, v159
    v_mov_b32 v9, v8
    s_nop 1
    v_permlane32_swap_b32 v9, v8
    s_nop 1
    v_max_f32 v8, v8, v9
    v_sub_f32 v9, 0, v8
    v_exp_f32 v9, v9
    s_nop 7
    s_nop 7
    v_sub_f32 v144, v144, v8
    v_sub_f32 v145, v145, v8
    v_sub_f32 v146, v146, v8
    v_sub_f32 v147, v147, v8
    v_sub_f32 v148, v148, v8
    v_sub_f32 v149, v149, v8
    v_sub_f32 v150, v150, v8
    v_sub_f32 v151, v151, v8
    v_sub_f32 v152, v152, v8
    v_sub_f32 v153, v153, v8
    v_sub_f32 v154, v154, v8
    v_sub_f32 v155, v155, v8
    v_sub_f32 v156, v156, v8
    v_sub_f32 v157, v157, v8
    v_sub_f32 v158, v158, v8
    v_sub_f32 v159, v159, v8
    v_sub_f32 v160, v160, v8
    v_sub_f32 v161, v161, v8
    v_sub_f32 v162, v162, v8
    v_sub_f32 v163, v163, v8
    v_sub_f32 v164, v164, v8
    v_sub_f32 v165, v165, v8
    v_sub_f32 v166, v166, v8
    v_sub_f32 v167, v167, v8
    v_sub_f32 v168, v168, v8
    v_sub_f32 v169, v169, v8
    v_sub_f32 v170, v170, v8
    v_sub_f32 v171, v171, v8
    v_sub_f32 v172, v172, v8
    v_sub_f32 v173, v173, v8
    v_sub_f32 v174, v174, v8
    v_sub_f32 v175, v175, v8
    v_sub_f32 v128, v128, v8
    v_sub_f32 v129, v129, v8
    v_sub_f32 v130, v130, v8
    v_sub_f32 v131, v131, v8
    v_sub_f32 v132, v132, v8
    v_sub_f32 v133, v133, v8
    v_sub_f32 v134, v134, v8
    v_sub_f32 v135, v135, v8
    v_sub_f32 v136, v136, v8
    v_sub_f32 v137, v137, v8
    v_sub_f32 v138, v138, v8
    v_sub_f32 v139, v139, v8
    v_sub_f32 v140, v140, v8
    v_sub_f32 v141, v141, v8
    v_sub_f32 v142, v142, v8
    v_sub_f32 v143, v143, v8
    v_mul_f32 v4, v9, v4
    v_mul_f32 v64, v9, v64
    v_mul_f32 v65, v9, v65
    v_mul_f32 v66, v9, v66
    v_mul_f32 v67, v9, v67
    v_mul_f32 v68, v9, v68
    v_mul_f32 v69, v9, v69
    v_mul_f32 v70, v9, v70
    v_mul_f32 v71, v9, v71
    v_mul_f32 v72, v9, v72
    v_mul_f32 v73, v9, v73
    v_mul_f32 v74, v9, v74
    v_mul_f32 v75, v9, v75
    v_mul_f32 v76, v9, v76
    v_mul_f32 v77, v9, v77
    v_mul_f32 v78, v9, v78
    v_mul_f32 v79, v9, v79
    v_mul_f32 v80, v9, v80
    v_mul_f32 v81, v9, v81
    v_mul_f32 v82, v9, v82
    v_mul_f32 v83, v9, v83
    v_mul_f32 v84, v9, v84
    v_mul_f32 v85, v9, v85
    v_mul_f32 v86, v9, v86
    v_mul_f32 v87, v9, v87
    v_mul_f32 v88, v9, v88
    v_mul_f32 v89, v9, v89
    v_mul_f32 v90, v9, v90
    v_mul_f32 v91, v9, v91
    v_mul_f32 v92, v9, v92
    v_mul_f32 v93, v9, v93
    v_mul_f32 v94, v9, v94
    v_mul_f32 v95, v9, v95
    v_mul_f32 v96, v9, v96
    v_mul_f32 v97, v9, v97
    v_mul_f32 v98, v9, v98
    v_mul_f32 v99, v9, v99
    v_mul_f32 v100, v9, v100
    v_mul_f32 v101, v9, v101
    v_mul_f32 v102, v9, v102
    v_mul_f32 v103, v9, v103
    v_mul_f32 v104, v9, v104
    v_mul_f32 v105, v9, v105
    v_mul_f32 v106, v9, v106
    v_mul_f32 v107, v9, v107
    v_mul_f32 v108, v9, v108
    v_mul_f32 v109, v9, v109
    v_mul_f32 v110, v9, v110
    v_mul_f32 v111, v9, v111
    v_mul_f32 v112, v9, v112
    v_mul_f32 v113, v9, v113
    v_mul_f32 v114, v9, v114
    v_mul_f32 v115, v9, v115
    v_mul_f32 v116, v9, v116
    v_mul_f32 v117, v9, v117
    v_mul_f32 v118, v9, v118
    v_mul_f32 v119, v9, v119
    v_mul_f32 v120, v9, v120
    v_mul_f32 v121, v9, v121
    v_mul_f32 v122, v9, v122
    v_mul_f32 v123, v9, v123
    v_mul_f32 v124, v9, v124
    v_mul_f32 v125, v9, v125
    v_mul_f32 v126, v9, v126
    v_mul_f32 v127, v9, v127
    v_exp_f32 v16, v144
    v_exp_f32 v17, v145
    s_nop 0
    v_exp_f32 v18, v146
    s_nop 0
    v_add_f32 v6, v16, v17
    s_nop 0
    v_cvt_pk_bf16_f32 v240, v16, v17
    s_nop 0
    v_exp_f32 v19, v147
    s_nop 0
    v_add_f32 v6, v6, v18
    s_nop 0
    v_exp_f32 v20, v148
    s_nop 0
    v_add_f32 v6, v6, v19
    s_nop 0
    v_cvt_pk_bf16_f32 v241, v18, v19
    s_nop 0
    v_exp_f32 v21, v149
    s_nop 0
    v_add_f32 v6, v6, v20
    s_nop 0
    v_exp_f32 v22, v150
    s_nop 0
    v_add_f32 v6, v6, v21
    s_nop 0
    v_cvt_pk_bf16_f32 v242, v20, v21
    s_nop 0
    v_exp_f32 v23, v151
    s_nop 0
    v_add_f32 v6, v6, v22
    s_nop 0
    v_exp_f32 v16, v152
    s_nop 0
    v_add_f32 v6, v6, v23
    s_nop 0
    v_cvt_pk_bf16_f32 v243, v22, v23
    s_nop 0
    v_exp_f32 v17, v153
    s_nop 0
    v_add_f32 v6, v6, v16
    s_nop 0
    v_exp_f32 v18, v154
    s_nop 0
    v_add_f32 v6, v6, v17
    s_nop 0
    v_cvt_pk_bf16_f32 v244, v16, v17
    s_nop 0
    v_exp_f32 v19, v155
    s_nop 0
    v_add_f32 v6, v6, v18
    s_nop 0
    v_exp_f32 v20, v156
    s_nop 0
    v_add_f32 v6, v6, v19
    s_nop 0
    v_cvt_pk_bf16_f32 v245, v18, v19
    s_nop 0
    v_exp_f32 v21, v157
    s_nop 0
    v_add_f32 v6, v6, v20
    s_nop 0
    v_exp_f32 v22, v158
    s_nop 0
    v_add_f32 v6, v6, v21
    s_nop 0
    v_cvt_pk_bf16_f32 v246, v20, v21
    s_nop 0
    v_exp_f32 v23, v159
    s_nop 0
    v_add_f32 v6, v6, v22
    s_nop 0
    v_add_f32 v6, v6, v23
    s_nop 0
    v_cvt_pk_bf16_f32 v247, v22, v23
    s_nop 0
    s_nop 1
    s_cmp_eq_u32 s59, 0
    s_cbranch_scc1 R1_0_back
    s_cmp_eq_u32 s59, 1
    s_cbranch_scc1 R1_1_back
    s_branch R1_2_back
.section .rodata,"a"
.p2align 6
.amdhsa_kernel standalone__gqa_block_cached__near_ridge_kernel
.amdhsa_next_free_vgpr 256
.amdhsa_next_free_sgpr 100
.amdhsa_accum_offset 256
.amdhsa_group_segment_fixed_size 0
.amdhsa_kernarg_size 64
.amdhsa_user_sgpr_count 2
.amdhsa_user_sgpr_kernarg_segment_ptr 1
.amdhsa_system_sgpr_workgroup_id_x 1
.end_amdhsa_kernel
```
